```python
import torch

def _softmax(x, axis=-1):
    return torch.softmax(x, dim=axis)
def _gelu(x):
    return torch.nn.functional.gelu(x, approximate="tanh")
def _silu(x):
    return torch.nn.functional.silu(x)
def _sigmoid(x):
    return torch.sigmoid(x)
def _layernorm(x, axis=-1, eps=1e-5):
    m = x.mean(dim=axis, keepdim=True)
    v = x.var(dim=axis, keepdim=True, unbiased=False)
    return (x - m) / torch.sqrt(v + eps)
def _scatter_add(tgt, idx, src, axis=0):
    return tgt.clone().index_add_(axis, idx, src)
def _segment_sum(src, seg, n):
    out = torch.zeros((n,) + src.shape[1:], dtype=src.dtype)
    return out.index_add_(0, seg, src)
def _pad(x, pw):
    flat = tuple(v for pair in reversed(pw) for v in pair)
    return torch.nn.functional.pad(x, flat)

kernel_name = 'sequential_preLN__grouped_kv_mqa__dense_activation_silu__prompt'

def setup_inputs():

    _w = (lambda a: (lambda t: t.to(torch.bfloat16) if t.is_floating_point() else t)(torch.as_tensor(a)))
    def _A_setup():
        B, S, D, H = 1, 2048, 640, 32
        Dh = D // H
        return {
            "x": _w((lambda *s: torch.randn(*s, dtype=torch.bfloat16) * 0.05)(B, S, D)),
            "wq": _w((lambda *s: torch.randn(*s, dtype=torch.bfloat16) * 0.05)(D, H * Dh)),
            "wk": _w((lambda *s: torch.randn(*s, dtype=torch.bfloat16) * 0.05)(D, Dh)),
            "wv": _w((lambda *s: torch.randn(*s, dtype=torch.bfloat16) * 0.05)(D, Dh)),
            "wo": _w((lambda *s: torch.randn(*s, dtype=torch.bfloat16) * 0.05)(H * Dh, D)),
        }
    _A_in = _A_setup()

    def _B_setup():
        B, S, D, F = 1, 2048, 640, 1728
        return {
            "x": _w((lambda *s: torch.randn(*s, dtype=torch.bfloat16) * 0.05)(B, S, D)),
            "w1": _w((lambda *s: torch.randn(*s, dtype=torch.bfloat16) * 0.8)(D, F) * (D ** -0.5)),
            "w2": _w((lambda *s: torch.randn(*s, dtype=torch.bfloat16) * 0.8)(F, D) * (F ** -0.5)),
        }
    _B_in = _B_setup()

    return {
        "A_x": _A_in["x"],
        "A_wq": _A_in["wq"],
        "A_wk": _A_in["wk"],
        "A_wv": _A_in["wv"],
        "A_wo": _A_in["wo"],
        "B_x": _B_in["x"],
        "B_w1": _B_in["w1"],
        "B_w2": _B_in["w2"],
    }

def reference(A_x, A_wq, A_wk, A_wv, A_wo, B_x, B_w1, B_w2):
    def _A_ref(x, wq, wk, wv, wo):
        B, S, D = x.shape
        H = 32
        Dh = D // H
        q = (lambda x, *d: x.permute(*d))((x @ wq).reshape(B, S, H, Dh), 0, 2, 1, 3)
        k = x @ wk
        v = x @ wv
        scores = torch.einsum("bhqd,bkd->bhqk", q, k) * (Dh ** -0.5)
        p = _softmax(scores, axis=-1)
        o = torch.einsum("bhqk,bkd->bhqd", p, v)
        return (lambda x, *d: x.permute(*d))(o, 0, 2, 1, 3).reshape(B, S, H * Dh) @ wo

    def _B_ref(x, w1, w2):
        h = torch.einsum("bsd,df->bsf", x, w1)
        h = _silu(h)
        out = torch.einsum("bsf,fd->bsd", h, w2)
        return out

    x = A_x
    h = x + _A_ref(_layernorm(x, axis=-1), A_wq, A_wk, A_wv, A_wo)
    h2 = h + _B_ref(_layernorm(h, axis=-1), B_w1, B_w2)
    return h2
```

```asm
; @launch grid=(256,1,1) block=(512,1,1) lds=163840
.amdgcn_target "amdgcn-amd-amdhsa--gfx950"
.text
.globl sequential_preLN__grouped_kv_mqa__dense_activation_silu__prompt_kernel
.p2align 8
.type sequential_preLN__grouped_kv_mqa__dense_activation_silu__prompt_kernel,@function
sequential_preLN__grouped_kv_mqa__dense_activation_silu__prompt_kernel:
    s_cmp_ge_u32 s2, 256
    s_cbranch_scc1 sequential_preLN__grouped_kv_mqa__dense_activation_silu__prompt_kernel_end
    s_load_dwordx8 s[24:31], s[0:1], 0
    s_load_dwordx2 s[12:13], s[0:1], 80
    s_load_dwordx4 s[8:11], s[0:1], 48
    s_load_dwordx4 s[32:35], s[0:1], 64
    s_load_dwordx2 s[74:75], s[0:1], 32
    v_and_b32 v1, 63, v0
    v_lshrrev_b32 v2, 6, v0
    v_lshlrev_b32 v112, 4, v1
    v_readfirstlane_b32 s36, v2

    s_and_b32 s40, s2, 7
    s_lshr_b32 s41, s2, 3
    s_lshr_b32 s42, s40, 1
    s_lshl_b32 s42, s42, 3
    s_lshr_b32 s43, s41, 2
    s_add_u32 s37, s42, s43
    s_and_b32 s42, s40, 1
    s_lshl_b32 s42, s42, 2
    s_and_b32 s43, s41, 3
    s_add_u32 s38, s42, s43

    s_lshr_b32 s42, s41, 2
    s_and_b32 s43, s41, 3
    s_mul_i32 s43, s43, 3
    s_add_u32 s60, s42, s43
    s_sub_u32 s42, s60, 10
    s_cmp_ge_u32 s60, 10
    s_cselect_b32 s60, s42, s60
    s_lshl_b32 s14, s37, 7
    s_add_u32 s14, s14, 9895936
    s_mov_b32 s15, 9908224
    s_cmp_ge_u32 s36, 4
    s_waitcnt lgkmcnt(0)
    s_mov_b32 s4, s24
    s_mov_b32 s5, s25
    s_cbranch_scc0 sequential_preLN__grouped_kv_mqa__dense_activation_silu__prompt_kernel_c1
    s_cmp_ge_u32 s36, 6
    s_cbranch_scc1 sequential_preLN__grouped_kv_mqa__dense_activation_silu__prompt_kernel_lw

    s_mov_b32 s20, s24
    s_and_b32 s21, s25, 0xffff
    s_mov_b32 s22, 0x280000
    s_mov_b32 s23, 0x00020000
    v_lshrrev_b32 v4, 3, v1
    v_and_b32 v5, 7, v1
    v_xor_b32 v5, v5, v4
    v_mul_u32_u24 v4, 1280, v4
    v_lshl_add_u32 v10, v5, 4, v4
    v_add_u32 v11, 10240, v10
    v_add_u32 v12, 20480, v10
    v_add_u32 v13, 30720, v10
    s_sub_u32 s42, s36, 4
    s_lshl_b32 s61, s42, 12
    s_mul_i32 s62, s37, 81920
    s_mul_i32 s42, s42, 40960
    s_add_u32 s62, s62, s42
    s_lshl_b32 s42, s60, 7
    s_add_u32 s62, s62, s42
    s_movk_i32 s63, 128

    s_add_u32 m0, s61, 0
    s_add_u32 s60, s60, 1
    buffer_load_dwordx4 v10, s[20:23], s62 offen lds
    s_add_u32 m0, s61, 1024
    s_nop 0
    buffer_load_dwordx4 v11, s[20:23], s62 offen lds
    s_add_u32 m0, s61, 2048
    s_nop 0
    buffer_load_dwordx4 v12, s[20:23], s62 offen lds
    s_add_u32 m0, s61, 3072
    s_nop 0
    buffer_load_dwordx4 v13, s[20:23], s62 offen lds
    s_cmp_eq_u32 s60, 10
    s_cselect_b32 s42, -1152, s63
    s_add_u32 s62, s62, s42
    s_add_u32 m0, s61, 8192
    s_add_u32 s60, s60, 1
    buffer_load_dwordx4 v10, s[20:23], s62 offen lds
    s_add_u32 m0, s61, 9216
    s_nop 0
    buffer_load_dwordx4 v11, s[20:23], s62 offen lds
    s_add_u32 m0, s61, 10240
    s_nop 0
    buffer_load_dwordx4 v12, s[20:23], s62 offen lds
    s_add_u32 m0, s61, 11264
    s_nop 0
    buffer_load_dwordx4 v13, s[20:23], s62 offen lds
    s_cmp_eq_u32 s60, 10
    s_cselect_b32 s42, -1152, s63
    s_add_u32 s62, s62, s42
    s_add_u32 m0, s61, 16384
    s_add_u32 s60, s60, 1
    buffer_load_dwordx4 v10, s[20:23], s62 offen lds
    s_add_u32 m0, s61, 17408
    s_nop 0
    buffer_load_dwordx4 v11, s[20:23], s62 offen lds
    s_add_u32 m0, s61, 18432
    s_nop 0
    buffer_load_dwordx4 v12, s[20:23], s62 offen lds
    s_add_u32 m0, s61, 19456
    s_nop 0
    buffer_load_dwordx4 v13, s[20:23], s62 offen lds
    s_cmp_eq_u32 s60, 10
    s_cselect_b32 s42, -1152, s63
    s_add_u32 s62, s62, s42
    s_waitcnt vmcnt(8)
    s_barrier
    s_add_u32 m0, s61, 24576
    s_add_u32 s60, s60, 1
    buffer_load_dwordx4 v10, s[20:23], s62 offen lds
    s_add_u32 m0, s61, 25600
    s_nop 0
    buffer_load_dwordx4 v11, s[20:23], s62 offen lds
    s_add_u32 m0, s61, 26624
    s_nop 0
    buffer_load_dwordx4 v12, s[20:23], s62 offen lds
    s_add_u32 m0, s61, 27648
    s_nop 0
    buffer_load_dwordx4 v13, s[20:23], s62 offen lds
    s_cmp_eq_u32 s60, 10
    s_cselect_b32 s42, -1152, s63
    s_add_u32 s62, s62, s42
    s_add_u32 m0, s61, 32768
    s_add_u32 s60, s60, 1
    buffer_load_dwordx4 v10, s[20:23], s62 offen lds
    s_add_u32 m0, s61, 33792
    s_nop 0
    buffer_load_dwordx4 v11, s[20:23], s62 offen lds
    s_add_u32 m0, s61, 34816
    s_nop 0
    buffer_load_dwordx4 v12, s[20:23], s62 offen lds
    s_add_u32 m0, s61, 35840
    s_nop 0
    buffer_load_dwordx4 v13, s[20:23], s62 offen lds
    s_cmp_eq_u32 s60, 10
    s_cselect_b32 s42, -1152, s63
    s_add_u32 s62, s62, s42
    s_waitcnt vmcnt(12)
    s_barrier
    s_add_u32 m0, s61, 40960
    s_add_u32 s60, s60, 1
    buffer_load_dwordx4 v10, s[20:23], s62 offen lds
    s_add_u32 m0, s61, 41984
    s_nop 0
    buffer_load_dwordx4 v11, s[20:23], s62 offen lds
    s_add_u32 m0, s61, 43008
    s_nop 0
    buffer_load_dwordx4 v12, s[20:23], s62 offen lds
    s_add_u32 m0, s61, 44032
    s_nop 0
    buffer_load_dwordx4 v13, s[20:23], s62 offen lds
    s_cmp_eq_u32 s60, 10
    s_cselect_b32 s42, -1152, s63
    s_add_u32 s62, s62, s42
    s_add_u32 m0, s61, 49152
    s_add_u32 s60, s60, 1
    buffer_load_dwordx4 v10, s[20:23], s62 offen lds
    s_add_u32 m0, s61, 50176
    s_nop 0
    buffer_load_dwordx4 v11, s[20:23], s62 offen lds
    s_add_u32 m0, s61, 51200
    s_nop 0
    buffer_load_dwordx4 v12, s[20:23], s62 offen lds
    s_add_u32 m0, s61, 52224
    s_nop 0
    buffer_load_dwordx4 v13, s[20:23], s62 offen lds
    s_cmp_eq_u32 s60, 10
    s_cselect_b32 s42, -1152, s63
    s_add_u32 s62, s62, s42
    s_waitcnt vmcnt(16)
    s_barrier
    s_add_u32 m0, s61, 57344
    s_add_u32 s60, s60, 1
    buffer_load_dwordx4 v10, s[20:23], s62 offen lds
    s_add_u32 m0, s61, 58368
    s_nop 0
    buffer_load_dwordx4 v11, s[20:23], s62 offen lds
    s_add_u32 m0, s61, 59392
    s_nop 0
    buffer_load_dwordx4 v12, s[20:23], s62 offen lds
    s_add_u32 m0, s61, 60416
    s_nop 0
    buffer_load_dwordx4 v13, s[20:23], s62 offen lds
    s_cmp_eq_u32 s60, 10
    s_cselect_b32 s42, -1152, s63
    s_add_u32 s62, s62, s42
    s_add_u32 m0, s61, 65536
    s_add_u32 s60, s60, 1
    buffer_load_dwordx4 v10, s[20:23], s62 offen lds
    s_add_u32 m0, s61, 66560
    s_nop 0
    buffer_load_dwordx4 v11, s[20:23], s62 offen lds
    s_add_u32 m0, s61, 67584
    s_nop 0
    buffer_load_dwordx4 v12, s[20:23], s62 offen lds
    s_add_u32 m0, s61, 68608
    s_nop 0
    buffer_load_dwordx4 v13, s[20:23], s62 offen lds
    s_cmp_eq_u32 s60, 10
    s_cselect_b32 s42, -1152, s63
    s_add_u32 s62, s62, s42
    s_waitcnt vmcnt(20)
    s_barrier
    s_add_u32 m0, s61, 73728
    s_add_u32 s60, s60, 1
    buffer_load_dwordx4 v10, s[20:23], s62 offen lds
    s_add_u32 m0, s61, 74752
    s_nop 0
    buffer_load_dwordx4 v11, s[20:23], s62 offen lds
    s_add_u32 m0, s61, 75776
    s_nop 0
    buffer_load_dwordx4 v12, s[20:23], s62 offen lds
    s_add_u32 m0, s61, 76800
    s_nop 0
    buffer_load_dwordx4 v13, s[20:23], s62 offen lds
    s_cmp_eq_u32 s60, 10
    s_cselect_b32 s42, -1152, s63
    s_add_u32 s62, s62, s42
    s_waitcnt vmcnt(20)
    s_barrier
    s_waitcnt vmcnt(16)
    s_barrier
    s_waitcnt vmcnt(12)
    s_barrier
    s_waitcnt vmcnt(8)
    s_barrier
    s_waitcnt vmcnt(4)
    s_barrier
    s_waitcnt vmcnt(0)
    s_barrier
    s_getpc_b64 s[52:53]
    s_add_u32 s52, s52, sequential_preLN__grouped_kv_mqa__dense_activation_silu__prompt_kernel_qrd - .
    s_addc_u32 s53, s53, 0
    s_lshr_b32 s54, s2, 3
    s_lshl_b32 s54, s54, 1
    s_add_u32 s54, s54, s36
    s_sub_u32 s54, s54, 4
    s_lshl_b32 s54, s54, 10
    v_add_u32 v4, s54, v112
    v_cmp_gt_u32 vcc, code_end - sequential_preLN__grouped_kv_mqa__dense_activation_silu__prompt_kernel_qrd - 16, v4
    s_and_saveexec_b64 s[56:57], vcc
    s_cbranch_execz sequential_preLN__grouped_kv_mqa__dense_activation_silu__prompt_kernel_nopf
    global_load_dwordx4 v[24:27], v4, s[52:53]

sequential_preLN__grouped_kv_mqa__dense_activation_silu__prompt_kernel_nopf:
    s_mov_b64 exec, -1
    s_mov_b32 s20, s34
    s_and_b32 s21, s35, 0xffff
    s_mov_b32 s22, 0x100
    s_mov_b32 s23, 0x00020000
    v_mov_b32 v250, 0
    s_barrier
    s_barrier
    s_barrier
    s_barrier
    s_barrier
    s_cmp_lt_u32 s38, 2
    s_cbranch_scc0 sequential_preLN__grouped_kv_mqa__dense_activation_silu__prompt_kernel_nopub
    s_cmp_eq_u32 s36, 5
    s_cbranch_scc0 sequential_preLN__grouped_kv_mqa__dense_activation_silu__prompt_kernel_nopub
    v_mov_b32 v250, 0
    v_mov_b32 v251, 1
    s_mov_b64 exec, 1
    buffer_atomic_add v251, v250, s[20:23], 0 offen sc0 sc1

sequential_preLN__grouped_kv_mqa__dense_activation_silu__prompt_kernel_nopub:
    s_mov_b64 exec, -1
    s_barrier
    s_barrier
    s_cmp_lt_u32 s38, 2
    s_cbranch_scc0 sequential_preLN__grouped_kv_mqa__dense_activation_silu__prompt_kernel_nopub2
    s_cmp_eq_u32 s36, 5
    s_cbranch_scc0 sequential_preLN__grouped_kv_mqa__dense_activation_silu__prompt_kernel_nopub2
    s_waitcnt vmcnt(0)
    v_readfirstlane_b32 s72, v251
    v_mov_b32 v251, 1
    s_cmp_eq_u32 s72, 63
    s_cbranch_scc0 sequential_preLN__grouped_kv_mqa__dense_activation_silu__prompt_kernel_nopub2
    s_mov_b64 exec, 1
    buffer_store_dword v251, v250, s[20:23], 0 offen offset:128 sc1
    s_mov_b64 exec, -1

sequential_preLN__grouped_kv_mqa__dense_activation_silu__prompt_kernel_nopub2:
    s_barrier
    s_barrier
    s_barrier
    s_branch sequential_preLN__grouped_kv_mqa__dense_activation_silu__prompt_kernel_ldone
sequential_preLN__grouped_kv_mqa__dense_activation_silu__prompt_kernel_lw:
    s_mov_b32 s20, s26
    s_and_b32 s21, s27, 0xffff
    s_mov_b32 s22, 0xc8000
    s_mov_b32 s23, 0x00020000
    s_cmp_eq_u32 s38, 0
    s_cselect_b32 s24, s28, s30
    s_cselect_b32 s25, s29, s31
    s_and_b32 s25, s25, 0xffff
    s_cmp_lt_u32 s38, 2
    s_cselect_b32 s26, 25600, 0
    s_mov_b32 s27, 0x00020000
    s_sub_u32 s50, s36, 6
    s_mul_i32 s42, s60, 5
    s_lshr_b32 s42, s42, 1
    s_add_u32 s42, s42, s50
    s_lshl_b32 s42, s42, 10
    s_cmp_lt_u32 s38, 2
    s_cbranch_scc0 sequential_preLN__grouped_kv_mqa__dense_activation_silu__prompt_kernel_nokv

    s_sub_u32 s43, s42, 25600
    s_cmp_ge_u32 s42, 25600
    s_cselect_b32 s42, s43, s42
    s_add_u32 m0, s42, 81920
    s_nop 0
    buffer_load_dwordx4 v112, s[24:27], s42 offen lds
    s_add_u32 s42, s42, 2048

    s_sub_u32 s43, s42, 25600
    s_cmp_ge_u32 s42, 25600
    s_cselect_b32 s42, s43, s42
    s_add_u32 m0, s42, 81920
    s_nop 0
    buffer_load_dwordx4 v112, s[24:27], s42 offen lds
    s_add_u32 s42, s42, 2048

    s_sub_u32 s43, s42, 25600
    s_cmp_ge_u32 s42, 25600
    s_cselect_b32 s42, s43, s42
    s_add_u32 m0, s42, 81920
    s_nop 0
    buffer_load_dwordx4 v112, s[24:27], s42 offen lds
    s_add_u32 s42, s42, 2048

    s_sub_u32 s43, s42, 25600
    s_cmp_ge_u32 s42, 25600
    s_cselect_b32 s42, s43, s42
    s_add_u32 m0, s42, 81920
    s_nop 0
    buffer_load_dwordx4 v112, s[24:27], s42 offen lds
    s_add_u32 s42, s42, 2048

    s_sub_u32 s43, s42, 25600
    s_cmp_ge_u32 s42, 25600
    s_cselect_b32 s42, s43, s42
    s_add_u32 m0, s42, 81920
    s_nop 0
    buffer_load_dwordx4 v112, s[24:27], s42 offen lds
    s_add_u32 s42, s42, 2048

    s_sub_u32 s43, s42, 25600
    s_cmp_ge_u32 s42, 25600
    s_cselect_b32 s42, s43, s42
    s_add_u32 m0, s42, 81920
    s_nop 0
    buffer_load_dwordx4 v112, s[24:27], s42 offen lds
    s_add_u32 s42, s42, 2048

    s_sub_u32 s43, s42, 25600
    s_cmp_ge_u32 s42, 25600
    s_cselect_b32 s42, s43, s42
    s_add_u32 m0, s42, 81920
    s_nop 0
    buffer_load_dwordx4 v112, s[24:27], s42 offen lds
    s_add_u32 s42, s42, 2048

    s_sub_u32 s43, s42, 25600
    s_cmp_ge_u32 s42, 25600
    s_cselect_b32 s42, s43, s42
    s_add_u32 m0, s42, 81920
    s_nop 0
    buffer_load_dwordx4 v112, s[24:27], s42 offen lds
    s_add_u32 s42, s42, 2048

    s_sub_u32 s43, s42, 25600
    s_cmp_ge_u32 s42, 25600
    s_cselect_b32 s42, s43, s42
    s_add_u32 m0, s42, 81920
    s_nop 0
    buffer_load_dwordx4 v112, s[24:27], s42 offen lds
    s_add_u32 s42, s42, 2048

    s_sub_u32 s43, s42, 25600
    s_cmp_ge_u32 s42, 25600
    s_cselect_b32 s42, s43, s42
    s_add_u32 m0, s42, 81920
    s_nop 0
    buffer_load_dwordx4 v112, s[24:27], s42 offen lds
    s_add_u32 s42, s42, 2048

    s_sub_u32 s43, s42, 25600
    s_cmp_ge_u32 s42, 25600
    s_cselect_b32 s42, s43, s42
    s_add_u32 m0, s42, 81920
    s_nop 0
    buffer_load_dwordx4 v112, s[24:27], s42 offen lds
    s_add_u32 s42, s42, 2048

    s_sub_u32 s43, s42, 25600
    s_cmp_ge_u32 s42, 25600
    s_cselect_b32 s42, s43, s42
    s_add_u32 m0, s42, 81920
    s_nop 0
    buffer_load_dwordx4 v112, s[24:27], s42 offen lds
    s_add_u32 s42, s42, 2048

    s_sub_u32 s43, s42, 25600
    s_cmp_ge_u32 s42, 25600
    s_cselect_b32 s42, s43, s42
    s_add_u32 m0, s42, 81920
    s_nop 0
    buffer_load_dwordx4 v112, s[24:27], s42 offen lds
    s_add_u32 s42, s42, 2048

sequential_preLN__grouped_kv_mqa__dense_activation_silu__prompt_kernel_nokv:
    v_add_u32 v4, 0, v1
    v_mul_u32_u24 v5, 6554, v4
    v_lshrrev_b32 v5, 16, v5
    v_mul_u32_u24 v7, 10, v5
    v_sub_u32 v6, v4, v7

    v_bfe_u32 v7, v5, 2, 2
    v_lshlrev_b32 v7, 3, v7
    v_lshrrev_b32 v8, 4, v5
    v_lshl_add_u32 v7, v8, 2, v7
    v_and_b32 v8, 3, v5
    v_add_u32 v7, v7, v8
    v_mul_u32_u24 v7, 1280, v7
    v_lshl_add_u32 v10, v6, 4, v7

    v_add_u32 v4, 64, v1
    v_mul_u32_u24 v5, 6554, v4
    v_lshrrev_b32 v5, 16, v5
    v_mul_u32_u24 v7, 10, v5
    v_sub_u32 v6, v4, v7

    v_bfe_u32 v7, v5, 2, 2
    v_lshlrev_b32 v7, 3, v7
    v_lshrrev_b32 v8, 4, v5
    v_lshl_add_u32 v7, v8, 2, v7
    v_and_b32 v8, 3, v5
    v_add_u32 v7, v7, v8
    v_mul_u32_u24 v7, 1280, v7
    v_lshl_add_u32 v11, v6, 4, v7

    v_add_u32 v4, 128, v1
    v_mul_u32_u24 v5, 6554, v4
    v_lshrrev_b32 v5, 16, v5
    v_mul_u32_u24 v7, 10, v5
    v_sub_u32 v6, v4, v7

    v_bfe_u32 v7, v5, 2, 2
    v_lshlrev_b32 v7, 3, v7
    v_lshrrev_b32 v8, 4, v5
    v_lshl_add_u32 v7, v8, 2, v7
    v_and_b32 v8, 3, v5
    v_add_u32 v7, v7, v8
    v_mul_u32_u24 v7, 1280, v7
    v_lshl_add_u32 v12, v6, 4, v7

    v_add_u32 v4, 192, v1
    v_mul_u32_u24 v5, 6554, v4
    v_lshrrev_b32 v5, 16, v5
    v_mul_u32_u24 v7, 10, v5
    v_sub_u32 v6, v4, v7

    v_bfe_u32 v7, v5, 2, 2
    v_lshlrev_b32 v7, 3, v7
    v_lshrrev_b32 v8, 4, v5
    v_lshl_add_u32 v7, v8, 2, v7
    v_and_b32 v8, 3, v5
    v_add_u32 v7, v7, v8
    v_mul_u32_u24 v7, 1280, v7
    v_lshl_add_u32 v13, v6, 4, v7

    v_add_u32 v4, 256, v1
    v_mul_u32_u24 v5, 6554, v4
    v_lshrrev_b32 v5, 16, v5
    v_mul_u32_u24 v7, 10, v5
    v_sub_u32 v6, v4, v7

    v_bfe_u32 v7, v5, 2, 2
    v_lshlrev_b32 v7, 3, v7
    v_lshrrev_b32 v8, 4, v5
    v_lshl_add_u32 v7, v8, 2, v7
    v_and_b32 v8, 3, v5
    v_add_u32 v7, v7, v8
    v_mul_u32_u24 v7, 1280, v7
    v_lshl_add_u32 v14, v6, 4, v7

    s_mul_i32 s61, s50, 5120
    s_add_u32 s61, s61, 108544
    s_mul_i32 s62, s38, 160
    s_mul_i32 s42, s50, 40960
    s_add_u32 s62, s62, s42
    s_mul_i32 s42, s60, 81920
    s_add_u32 s62, s62, s42
    s_mov_b32 s63, 81920

    s_waitcnt vmcnt(10)
    s_barrier
    s_waitcnt vmcnt(9)
    s_barrier
    s_waitcnt vmcnt(7)
    s_barrier
    s_waitcnt vmcnt(6)
    s_barrier
    s_waitcnt vmcnt(5)
    s_barrier
    s_add_u32 m0, s61, 0
    s_add_u32 s60, s60, 1
    buffer_load_dwordx4 v10, s[20:23], s62 offen lds
    s_add_u32 m0, s61, 1024
    s_nop 0
    buffer_load_dwordx4 v11, s[20:23], s62 offen lds
    s_add_u32 m0, s61, 2048
    s_nop 0
    buffer_load_dwordx4 v12, s[20:23], s62 offen lds
    s_add_u32 m0, s61, 3072
    s_nop 0
    buffer_load_dwordx4 v13, s[20:23], s62 offen lds
    s_add_u32 m0, s61, 4096
    s_nop 0
    buffer_load_dwordx4 v14, s[20:23], s62 offen lds
    s_cmp_eq_u32 s60, 10
    s_cselect_b32 s42, -737280, s63
    s_add_u32 s62, s62, s42
    s_waitcnt vmcnt(9)
    s_barrier
    s_add_u32 m0, s61, 10240
    s_add_u32 s60, s60, 1
    buffer_load_dwordx4 v10, s[20:23], s62 offen lds
    s_add_u32 m0, s61, 11264
    s_nop 0
    buffer_load_dwordx4 v11, s[20:23], s62 offen lds
    s_add_u32 m0, s61, 12288
    s_nop 0
    buffer_load_dwordx4 v12, s[20:23], s62 offen lds
    s_add_u32 m0, s61, 13312
    s_nop 0
    buffer_load_dwordx4 v13, s[20:23], s62 offen lds
    s_add_u32 m0, s61, 14336
    s_nop 0
    buffer_load_dwordx4 v14, s[20:23], s62 offen lds
    s_cmp_eq_u32 s60, 10
    s_cselect_b32 s42, -737280, s63
    s_add_u32 s62, s62, s42
    s_waitcnt vmcnt(12)
    s_barrier
    s_add_u32 m0, s61, 20480
    s_add_u32 s60, s60, 1
    buffer_load_dwordx4 v10, s[20:23], s62 offen lds
    s_add_u32 m0, s61, 21504
    s_nop 0
    buffer_load_dwordx4 v11, s[20:23], s62 offen lds
    s_add_u32 m0, s61, 22528
    s_nop 0
    buffer_load_dwordx4 v12, s[20:23], s62 offen lds
    s_add_u32 m0, s61, 23552
    s_nop 0
    buffer_load_dwordx4 v13, s[20:23], s62 offen lds
    s_add_u32 m0, s61, 24576
    s_nop 0
    buffer_load_dwordx4 v14, s[20:23], s62 offen lds
    s_cmp_eq_u32 s60, 10
    s_cselect_b32 s42, -737280, s63
    s_add_u32 s62, s62, s42
    s_waitcnt vmcnt(16)
    s_barrier
    s_add_u32 m0, s61, 30720
    s_add_u32 s60, s60, 1
    buffer_load_dwordx4 v10, s[20:23], s62 offen lds
    s_add_u32 m0, s61, 31744
    s_nop 0
    buffer_load_dwordx4 v11, s[20:23], s62 offen lds
    s_add_u32 m0, s61, 32768
    s_nop 0
    buffer_load_dwordx4 v12, s[20:23], s62 offen lds
    s_add_u32 m0, s61, 33792
    s_nop 0
    buffer_load_dwordx4 v13, s[20:23], s62 offen lds
    s_add_u32 m0, s61, 34816
    s_nop 0
    buffer_load_dwordx4 v14, s[20:23], s62 offen lds
    s_cmp_eq_u32 s60, 10
    s_cselect_b32 s42, -737280, s63
    s_add_u32 s62, s62, s42
    s_waitcnt vmcnt(20)
    s_barrier
    s_waitcnt vmcnt(20)
    s_barrier
    s_waitcnt vmcnt(15)
    s_barrier
    s_waitcnt vmcnt(10)
    s_barrier
    s_add_u32 m0, s61, 0
    s_add_u32 s60, s60, 1
    buffer_load_dwordx4 v10, s[20:23], s62 offen lds
    s_add_u32 m0, s61, 1024
    s_nop 0
    buffer_load_dwordx4 v11, s[20:23], s62 offen lds
    s_add_u32 m0, s61, 2048
    s_nop 0
    buffer_load_dwordx4 v12, s[20:23], s62 offen lds
    s_add_u32 m0, s61, 3072
    s_nop 0
    buffer_load_dwordx4 v13, s[20:23], s62 offen lds
    s_add_u32 m0, s61, 4096
    s_nop 0
    buffer_load_dwordx4 v14, s[20:23], s62 offen lds
    s_cmp_eq_u32 s60, 10
    s_cselect_b32 s42, -737280, s63
    s_add_u32 s62, s62, s42
    s_waitcnt vmcnt(10)
    s_barrier
    s_add_u32 m0, s61, 10240
    s_add_u32 s60, s60, 1
    buffer_load_dwordx4 v10, s[20:23], s62 offen lds
    s_add_u32 m0, s61, 11264
    s_nop 0
    buffer_load_dwordx4 v11, s[20:23], s62 offen lds
    s_add_u32 m0, s61, 12288
    s_nop 0
    buffer_load_dwordx4 v12, s[20:23], s62 offen lds
    s_add_u32 m0, s61, 13312
    s_nop 0
    buffer_load_dwordx4 v13, s[20:23], s62 offen lds
    s_add_u32 m0, s61, 14336
    s_nop 0
    buffer_load_dwordx4 v14, s[20:23], s62 offen lds
    s_cmp_eq_u32 s60, 10
    s_cselect_b32 s42, -737280, s63
    s_add_u32 s62, s62, s42
    s_waitcnt vmcnt(10)
    s_barrier
    s_add_u32 m0, s61, 20480
    s_add_u32 s60, s60, 1
    buffer_load_dwordx4 v10, s[20:23], s62 offen lds
    s_add_u32 m0, s61, 21504
    s_nop 0
    buffer_load_dwordx4 v11, s[20:23], s62 offen lds
    s_add_u32 m0, s61, 22528
    s_nop 0
    buffer_load_dwordx4 v12, s[20:23], s62 offen lds
    s_add_u32 m0, s61, 23552
    s_nop 0
    buffer_load_dwordx4 v13, s[20:23], s62 offen lds
    s_add_u32 m0, s61, 24576
    s_nop 0
    buffer_load_dwordx4 v14, s[20:23], s62 offen lds
    s_cmp_eq_u32 s60, 10
    s_cselect_b32 s42, -737280, s63
    s_add_u32 s62, s62, s42
    s_waitcnt vmcnt(10)
    s_barrier
    s_add_u32 m0, s61, 30720
    s_add_u32 s60, s60, 1
    buffer_load_dwordx4 v10, s[20:23], s62 offen lds
    s_add_u32 m0, s61, 31744
    s_nop 0
    buffer_load_dwordx4 v11, s[20:23], s62 offen lds
    s_add_u32 m0, s61, 32768
    s_nop 0
    buffer_load_dwordx4 v12, s[20:23], s62 offen lds
    s_add_u32 m0, s61, 33792
    s_nop 0
    buffer_load_dwordx4 v13, s[20:23], s62 offen lds
    s_add_u32 m0, s61, 34816
    s_nop 0
    buffer_load_dwordx4 v14, s[20:23], s62 offen lds
    s_cmp_eq_u32 s60, 10
    s_cselect_b32 s42, -737280, s63
    s_add_u32 s62, s62, s42
    s_waitcnt vmcnt(10)
    s_barrier
    s_add_u32 m0, s61, 0
    s_add_u32 s60, s60, 1
    buffer_load_dwordx4 v10, s[20:23], s62 offen lds
    s_add_u32 m0, s61, 1024
    s_nop 0
    buffer_load_dwordx4 v11, s[20:23], s62 offen lds
    s_add_u32 m0, s61, 2048
    s_nop 0
    buffer_load_dwordx4 v12, s[20:23], s62 offen lds
    s_add_u32 m0, s61, 3072
    s_nop 0
    buffer_load_dwordx4 v13, s[20:23], s62 offen lds
    s_add_u32 m0, s61, 4096
    s_nop 0
    buffer_load_dwordx4 v14, s[20:23], s62 offen lds
    s_cmp_eq_u32 s60, 10
    s_cselect_b32 s42, -737280, s63
    s_add_u32 s62, s62, s42
    s_waitcnt vmcnt(10)
    s_barrier
    s_add_u32 m0, s61, 10240
    s_add_u32 s60, s60, 1
    buffer_load_dwordx4 v10, s[20:23], s62 offen lds
    s_add_u32 m0, s61, 11264
    s_nop 0
    buffer_load_dwordx4 v11, s[20:23], s62 offen lds
    s_add_u32 m0, s61, 12288
    s_nop 0
    buffer_load_dwordx4 v12, s[20:23], s62 offen lds
    s_add_u32 m0, s61, 13312
    s_nop 0
    buffer_load_dwordx4 v13, s[20:23], s62 offen lds
    s_add_u32 m0, s61, 14336
    s_nop 0
    buffer_load_dwordx4 v14, s[20:23], s62 offen lds
    s_cmp_eq_u32 s60, 10
    s_cselect_b32 s42, -737280, s63
    s_add_u32 s62, s62, s42
    s_waitcnt vmcnt(10)
    s_barrier
    s_waitcnt vmcnt(5)
    s_barrier
    s_waitcnt vmcnt(0)
    s_barrier
sequential_preLN__grouped_kv_mqa__dense_activation_silu__prompt_kernel_ldone:
    s_cmp_eq_u32 s36, 4
    s_cbranch_scc0 sequential_preLN__grouped_kv_mqa__dense_activation_silu__prompt_kernel_nokp
    s_mov_b32 s16, s34
    s_and_b32 s17, s35, 0xffff
    s_mov_b32 s18, 0x100
    s_mov_b32 s19, 0x00020000
    v_mov_b32 v250, 0
    s_mov_b32 s71, 0

sequential_preLN__grouped_kv_mqa__dense_activation_silu__prompt_kernel_poll1:
    buffer_load_dword v251, v250, s[16:19], 0 offen offset:128 sc1
    s_add_u32 s71, s71, 1
    s_waitcnt vmcnt(0)
    v_readfirstlane_b32 s72, v251
    s_cmp_ge_u32 s72, 1
    s_cbranch_scc1 sequential_preLN__grouped_kv_mqa__dense_activation_silu__prompt_kernel_poll1_ok
    s_sleep 2
    s_cmp_lt_u32 s71, 200000
    s_cbranch_scc1 sequential_preLN__grouped_kv_mqa__dense_activation_silu__prompt_kernel_poll1

sequential_preLN__grouped_kv_mqa__dense_activation_silu__prompt_kernel_poll1_ok:
sequential_preLN__grouped_kv_mqa__dense_activation_silu__prompt_kernel_nokp:
    s_barrier
    s_branch sequential_preLN__grouped_kv_mqa__dense_activation_silu__prompt_kernel_qrd
sequential_preLN__grouped_kv_mqa__dense_activation_silu__prompt_kernel_c1:
    s_mov_b32 s16, s12
    s_and_b32 s17, s13, 0xffff
    s_mov_b32 s18, 0x1900000
    s_mov_b32 s19, 0x00020000
    s_lshl_b32 s39, s37, 2
    s_add_u32 s39, s39, s36
    v_and_b32 v2, 15, v1
    v_lshrrev_b32 v3, 4, v1
    s_lshl_b32 s42, s36, 4
    v_add_u32 v4, s42, v2
    v_lshlrev_b32 v4, 7, v4
    v_and_b32 v5, 7, v2
    v_xor_b32 v6, v3, v5
    v_lshl_add_u32 v184, v6, 4, v4
    v_xor_b32 v6, 4, v6
    v_lshl_add_u32 v185, v6, 4, v4
    v_add_u32 v202, 40960, v184
    v_add_u32 v203, 40960, v185
    v_lshrrev_b32 v4, 2, v1
    v_mul_u32_u24 v4, 160, v4
    v_and_b32 v5, 3, v1
    v_lshl_add_u32 v186, v5, 3, v4
    v_add_u32 v186, 108544, v186
    s_lshl_b32 s42, s36, 5
    v_add_u32 v187, s42, v186
    v_lshlrev_b32 v4, 3, v3
    v_bfe_u32 v6, v1, 2, 2
    v_add_u32 v4, v4, v6
    v_mul_u32_u24 v4, 40, v4
    v_lshl_add_u32 v4, v5, 3, v4
    v_add_u32 v204, 81920, v4
    v_lshlrev_b32 v4, 4, v3
    v_add_u32 v189, 149504, v4
    v_mov_b32 v4, 149904
    v_mov_b32 v5, 0
    ds_write_b32 v4, v5
    v_and_b32 v4, 3, v1
    v_cmp_eq_u32 s[52:53], 1, v4
    v_cmp_eq_u32 s[54:55], 2, v4
    v_cmp_eq_u32 s[56:57], 3, v4
    v_lshrrev_b32 v12, 2, v2
    v_lshl_add_u32 v12, v12, 4, v2
    v_lshlrev_b32 v12, 2, v12
    s_lshr_b32 s46, s39, 4
    s_mul_i32 s46, s46, 20480
    s_add_u32 s46, s46, 2621440
    s_lshr_b32 s47, s39, 1
    s_and_b32 s47, s47, 7
    s_and_b32 s48, s39, 1

    v_mov_b32 v152, 0x3f803f80
    v_mov_b32 v153, 0x3f803f80
    v_mov_b32 v154, 0x3f803f80
    v_mov_b32 v155, 0x3f803f80
    v_add_u32 v4, 0, v3
    v_mul_u32_u24 v5, 13108, v4
    v_lshrrev_b32 v5, 16, v5
    v_mul_u32_u24 v7, 5, v5
    v_sub_u32 v6, v4, v7

    s_and_b32 s42, s36, 1
    s_lshl_b32 s42, s42, 4
    v_add_u32 v7, s42, v2
    v_lshrrev_b32 v8, 1, v6
    v_lshl_add_u32 v8, v8, 5, v7
    v_lshlrev_b32 v8, 4, v8
    v_and_b32 v9, 1, v6
    v_lshl_add_u32 v8, v9, 3, v8
    v_lshlrev_b32 v9, 3, v7
    v_add_u32 v9, 1024, v9
    v_cmp_eq_u32 vcc, 4, v6
    v_mul_u32_u24 v7, 2560, v5
    s_lshr_b32 s42, s36, 1
    s_mul_i32 s42, s42, 1280
    s_add_u32 s42, s42, 153600
    v_cndmask_b32 v8, v8, v9, vcc
    v_add3_u32 v190, v8, v7, s42

    v_add_u32 v4, 4, v3
    v_mul_u32_u24 v5, 13108, v4
    v_lshrrev_b32 v5, 16, v5
    v_mul_u32_u24 v7, 5, v5
    v_sub_u32 v6, v4, v7

    s_and_b32 s42, s36, 1
    s_lshl_b32 s42, s42, 4
    v_add_u32 v7, s42, v2
    v_lshrrev_b32 v8, 1, v6
    v_lshl_add_u32 v8, v8, 5, v7
    v_lshlrev_b32 v8, 4, v8
    v_and_b32 v9, 1, v6
    v_lshl_add_u32 v8, v9, 3, v8
    v_lshlrev_b32 v9, 3, v7
    v_add_u32 v9, 1024, v9
    v_cmp_eq_u32 vcc, 4, v6
    v_mul_u32_u24 v7, 2560, v5
    s_lshr_b32 s42, s36, 1
    s_mul_i32 s42, s42, 1280
    s_add_u32 s42, s42, 153600
    v_cndmask_b32 v8, v8, v9, vcc
    v_add3_u32 v191, v8, v7, s42

    v_add_u32 v4, 8, v3
    v_mul_u32_u24 v5, 13108, v4
    v_lshrrev_b32 v5, 16, v5
    v_mul_u32_u24 v7, 5, v5
    v_sub_u32 v6, v4, v7

    s_and_b32 s42, s36, 1
    s_lshl_b32 s42, s42, 4
    v_add_u32 v7, s42, v2
    v_lshrrev_b32 v8, 1, v6
    v_lshl_add_u32 v8, v8, 5, v7
    v_lshlrev_b32 v8, 4, v8
    v_and_b32 v9, 1, v6
    v_lshl_add_u32 v8, v9, 3, v8
    v_lshlrev_b32 v9, 3, v7
    v_add_u32 v9, 1024, v9
    v_cmp_eq_u32 vcc, 4, v6
    v_mul_u32_u24 v7, 2560, v5
    s_lshr_b32 s42, s36, 1
    s_mul_i32 s42, s42, 1280
    s_add_u32 s42, s42, 153600
    v_cndmask_b32 v8, v8, v9, vcc
    v_add3_u32 v192, v8, v7, s42

    v_add_u32 v4, 12, v3
    v_mul_u32_u24 v5, 13108, v4
    v_lshrrev_b32 v5, 16, v5
    v_mul_u32_u24 v7, 5, v5
    v_sub_u32 v6, v4, v7

    s_and_b32 s42, s36, 1
    s_lshl_b32 s42, s42, 4
    v_add_u32 v7, s42, v2
    v_lshrrev_b32 v8, 1, v6
    v_lshl_add_u32 v8, v8, 5, v7
    v_lshlrev_b32 v8, 4, v8
    v_and_b32 v9, 1, v6
    v_lshl_add_u32 v8, v9, 3, v8
    v_lshlrev_b32 v9, 3, v7
    v_add_u32 v9, 1024, v9
    v_cmp_eq_u32 vcc, 4, v6
    v_mul_u32_u24 v7, 2560, v5
    s_lshr_b32 s42, s36, 1
    s_mul_i32 s42, s42, 1280
    s_add_u32 s42, s42, 153600
    v_cndmask_b32 v8, v8, v9, vcc
    v_add3_u32 v193, v8, v7, s42

    v_add_u32 v4, 16, v3
    v_mul_u32_u24 v5, 13108, v4
    v_lshrrev_b32 v5, 16, v5
    v_mul_u32_u24 v7, 5, v5
    v_sub_u32 v6, v4, v7

    s_and_b32 s42, s36, 1
    s_lshl_b32 s42, s42, 4
    v_add_u32 v7, s42, v2
    v_lshrrev_b32 v8, 1, v6
    v_lshl_add_u32 v8, v8, 5, v7
    v_lshlrev_b32 v8, 4, v8
    v_and_b32 v9, 1, v6
    v_lshl_add_u32 v8, v9, 3, v8
    v_lshlrev_b32 v9, 3, v7
    v_add_u32 v9, 1024, v9
    v_cmp_eq_u32 vcc, 4, v6
    v_mul_u32_u24 v7, 2560, v5
    s_lshr_b32 s42, s36, 1
    s_mul_i32 s42, s42, 1280
    s_add_u32 s42, s42, 153600
    v_cndmask_b32 v8, v8, v9, vcc
    v_add3_u32 v194, v8, v7, s42

    s_cmp_eq_u32 s38, 0
    s_cbranch_scc1 sequential_preLN__grouped_kv_mqa__dense_activation_silu__prompt_kernel_aK
    s_cmp_eq_u32 s38, 1
    s_cbranch_scc1 sequential_preLN__grouped_kv_mqa__dense_activation_silu__prompt_kernel_aV

sequential_preLN__grouped_kv_mqa__dense_activation_silu__prompt_kernel_aN:
    s_waitcnt lgkmcnt(0)
    s_barrier
    ds_read_b128 v[16:19], v184 offset:0
    ds_read_b128 v[44:47], v185 offset:0
    s_waitcnt lgkmcnt(0)
    s_barrier
    ds_read_b128 v[72:75], v184 offset:8192
    v_mfma_f32_16x16x32_bf16 v[132:135], v[16:19], v[16:19], 0
    ds_read_b128 v[100:103], v185 offset:8192
    v_mfma_f32_16x16x32_bf16 v[128:131], v[152:155], v[16:19], 0
    v_mfma_f32_16x16x32_bf16 v[132:135], v[44:47], v[44:47], v[132:135]
    v_mfma_f32_16x16x32_bf16 v[128:131], v[152:155], v[44:47], v[128:131]
    s_waitcnt lgkmcnt(0)
    s_barrier
    ds_read_b128 v[16:19], v184 offset:16384
    v_mfma_f32_16x16x32_bf16 v[132:135], v[72:75], v[72:75], v[132:135]
    ds_read_b128 v[44:47], v185 offset:16384
    v_mfma_f32_16x16x32_bf16 v[128:131], v[152:155], v[72:75], v[128:131]
    v_mfma_f32_16x16x32_bf16 v[132:135], v[100:103], v[100:103], v[132:135]
    v_mfma_f32_16x16x32_bf16 v[128:131], v[152:155], v[100:103], v[128:131]
    s_waitcnt lgkmcnt(0)
    s_barrier
    ds_read_b128 v[72:75], v184 offset:24576
    v_mfma_f32_16x16x32_bf16 v[132:135], v[16:19], v[16:19], v[132:135]
    ds_read_b128 v[100:103], v185 offset:24576
    v_mfma_f32_16x16x32_bf16 v[128:131], v[152:155], v[16:19], v[128:131]
    v_mfma_f32_16x16x32_bf16 v[132:135], v[44:47], v[44:47], v[132:135]
    v_mfma_f32_16x16x32_bf16 v[128:131], v[152:155], v[44:47], v[128:131]
    s_waitcnt lgkmcnt(0)
    s_barrier
    ds_read_b128 v[16:19], v184 offset:32768
    v_mfma_f32_16x16x32_bf16 v[132:135], v[72:75], v[72:75], v[132:135]
    ds_read_b128 v[44:47], v185 offset:32768
    v_mfma_f32_16x16x32_bf16 v[128:131], v[152:155], v[72:75], v[128:131]
    v_mfma_f32_16x16x32_bf16 v[132:135], v[100:103], v[100:103], v[132:135]
    v_mfma_f32_16x16x32_bf16 v[128:131], v[152:155], v[100:103], v[128:131]
    s_waitcnt lgkmcnt(0)
    s_barrier
    ds_read_b128 v[72:75], v202 offset:0
    v_mfma_f32_16x16x32_bf16 v[132:135], v[16:19], v[16:19], v[132:135]
    ds_read_b128 v[100:103], v203 offset:0
    v_mfma_f32_16x16x32_bf16 v[128:131], v[152:155], v[16:19], v[128:131]
    v_mfma_f32_16x16x32_bf16 v[132:135], v[44:47], v[44:47], v[132:135]
    v_mfma_f32_16x16x32_bf16 v[128:131], v[152:155], v[44:47], v[128:131]
    s_waitcnt lgkmcnt(0)
    s_barrier
    ds_read_b128 v[16:19], v202 offset:8192
    v_mfma_f32_16x16x32_bf16 v[132:135], v[72:75], v[72:75], v[132:135]
    ds_read_b128 v[44:47], v203 offset:8192
    v_mfma_f32_16x16x32_bf16 v[128:131], v[152:155], v[72:75], v[128:131]
    v_mfma_f32_16x16x32_bf16 v[132:135], v[100:103], v[100:103], v[132:135]
    v_mfma_f32_16x16x32_bf16 v[128:131], v[152:155], v[100:103], v[128:131]
    s_waitcnt lgkmcnt(0)
    s_barrier
    ds_read_b128 v[72:75], v202 offset:16384
    v_mfma_f32_16x16x32_bf16 v[132:135], v[16:19], v[16:19], v[132:135]
    ds_read_b128 v[100:103], v203 offset:16384
    v_mfma_f32_16x16x32_bf16 v[128:131], v[152:155], v[16:19], v[128:131]
    v_mfma_f32_16x16x32_bf16 v[132:135], v[44:47], v[44:47], v[132:135]
    v_mfma_f32_16x16x32_bf16 v[128:131], v[152:155], v[44:47], v[128:131]
    s_waitcnt lgkmcnt(0)
    s_barrier
    ds_read_b128 v[16:19], v202 offset:24576
    v_mfma_f32_16x16x32_bf16 v[132:135], v[72:75], v[72:75], v[132:135]
    ds_read_b128 v[44:47], v203 offset:24576
    v_mfma_f32_16x16x32_bf16 v[128:131], v[152:155], v[72:75], v[128:131]
    v_mfma_f32_16x16x32_bf16 v[132:135], v[100:103], v[100:103], v[132:135]
    v_mfma_f32_16x16x32_bf16 v[128:131], v[152:155], v[100:103], v[128:131]
    s_waitcnt lgkmcnt(0)
    s_barrier
    ds_read_b128 v[72:75], v202 offset:32768
    v_mfma_f32_16x16x32_bf16 v[132:135], v[16:19], v[16:19], v[132:135]
    ds_read_b128 v[100:103], v203 offset:32768
    v_mfma_f32_16x16x32_bf16 v[128:131], v[152:155], v[16:19], v[128:131]
    v_mfma_f32_16x16x32_bf16 v[132:135], v[44:47], v[44:47], v[132:135]
    v_mfma_f32_16x16x32_bf16 v[128:131], v[152:155], v[44:47], v[128:131]
    s_waitcnt lgkmcnt(0)
    s_barrier
    ds_read_b128 v[16:19], v184 offset:0
    ds_read_b64_tr_b16 v[20:21], v186 offset:0
    ds_read_b64_tr_b16 v[22:23], v186 offset:2560
    ds_read_b64_tr_b16 v[24:25], v186 offset:32
    ds_read_b64_tr_b16 v[26:27], v186 offset:2592
    ds_read_b64_tr_b16 v[28:29], v186 offset:64
    ds_read_b64_tr_b16 v[30:31], v186 offset:2624
    ds_read_b64_tr_b16 v[32:33], v186 offset:96
    ds_read_b64_tr_b16 v[34:35], v186 offset:2656
    ds_read_b64_tr_b16 v[36:37], v186 offset:128
    ds_read_b64_tr_b16 v[38:39], v186 offset:2688
    ds_read_b64_tr_b16 v[40:41], v187 offset:0
    ds_read_b64_tr_b16 v[42:43], v187 offset:2560
    v_mfma_f32_16x16x32_bf16 v[132:135], v[72:75], v[72:75], v[132:135]
    ds_read_b128 v[44:47], v185 offset:0
    ds_read_b64_tr_b16 v[48:49], v186 offset:5120
    ds_read_b64_tr_b16 v[50:51], v186 offset:7680
    ds_read_b64_tr_b16 v[52:53], v186 offset:5152
    ds_read_b64_tr_b16 v[54:55], v186 offset:7712
    ds_read_b64_tr_b16 v[56:57], v186 offset:5184
    ds_read_b64_tr_b16 v[58:59], v186 offset:7744
    ds_read_b64_tr_b16 v[60:61], v186 offset:5216
    ds_read_b64_tr_b16 v[62:63], v186 offset:7776
    ds_read_b64_tr_b16 v[64:65], v186 offset:5248
    ds_read_b64_tr_b16 v[66:67], v186 offset:7808
    ds_read_b64_tr_b16 v[68:69], v187 offset:5120
    ds_read_b64_tr_b16 v[70:71], v187 offset:7680
    v_mfma_f32_16x16x32_bf16 v[128:131], v[152:155], v[72:75], v[128:131]
    v_mfma_f32_16x16x32_bf16 v[132:135], v[100:103], v[100:103], v[132:135]
    v_mfma_f32_16x16x32_bf16 v[128:131], v[152:155], v[100:103], v[128:131]
    s_nop 7
    v_cndmask_b32 v5, v132, v133, s[52:53]
    v_cndmask_b32 v5, v5, v134, s[54:55]
    v_cndmask_b32 v5, v5, v135, s[56:57]
    ds_bpermute_b32 v7, v12, v5
    v_mul_f32 v200, 0x3acccccd, v128
    s_waitcnt lgkmcnt(0)
    s_barrier
    v_mul_f32 v7, 0x3acccccd, v7
    v_fma_f32 v7, -v200, v200, v7
    v_max_f32 v7, 0, v7
    v_add_f32 v7, 0x3727c5ac, v7
    v_rsq_f32 v201, v7
    s_nop 0
    ds_read_b128 v[72:75], v184 offset:8192
    ds_read_b64_tr_b16 v[76:77], v186 offset:10240
    v_mfma_f32_16x16x32_bf16 v[156:159], v[20:23], v[16:19], 0
    ds_read_b64_tr_b16 v[78:79], v186 offset:12800
    ds_read_b64_tr_b16 v[80:81], v186 offset:10272
    v_mfma_f32_16x16x32_bf16 v[160:163], v[24:27], v[16:19], 0
    ds_read_b64_tr_b16 v[82:83], v186 offset:12832
    ds_read_b64_tr_b16 v[84:85], v186 offset:10304
    v_mfma_f32_16x16x32_bf16 v[164:167], v[28:31], v[16:19], 0
    ds_read_b64_tr_b16 v[86:87], v186 offset:12864
    ds_read_b64_tr_b16 v[88:89], v186 offset:10336
    v_mfma_f32_16x16x32_bf16 v[168:171], v[32:35], v[16:19], 0
    ds_read_b64_tr_b16 v[90:91], v186 offset:12896
    ds_read_b64_tr_b16 v[92:93], v186 offset:10368
    v_mfma_f32_16x16x32_bf16 v[172:175], v[36:39], v[16:19], 0
    ds_read_b64_tr_b16 v[94:95], v186 offset:12928
    ds_read_b64_tr_b16 v[96:97], v187 offset:10240
    ds_read_b64_tr_b16 v[98:99], v187 offset:12800
    v_mfma_f32_16x16x32_bf16 v[180:183], v[36:39], v[152:155], 0
    ds_read_b128 v[100:103], v185 offset:8192
    ds_read_b64_tr_b16 v[104:105], v186 offset:15360
    v_mfma_f32_16x16x32_bf16 v[176:179], v[40:43], v[152:155], 0
    ds_read_b64_tr_b16 v[106:107], v186 offset:17920
    ds_read_b64_tr_b16 v[108:109], v186 offset:15392
    v_mfma_f32_16x16x32_bf16 v[156:159], v[48:51], v[44:47], v[156:159]
    ds_read_b64_tr_b16 v[110:111], v186 offset:17952
    ds_read_b64_tr_b16 v[112:113], v186 offset:15424
    v_mfma_f32_16x16x32_bf16 v[160:163], v[52:55], v[44:47], v[160:163]
    ds_read_b64_tr_b16 v[114:115], v186 offset:17984
    ds_read_b64_tr_b16 v[116:117], v186 offset:15456
    v_mfma_f32_16x16x32_bf16 v[164:167], v[56:59], v[44:47], v[164:167]
    ds_read_b64_tr_b16 v[118:119], v186 offset:18016
    ds_read_b64_tr_b16 v[120:121], v186 offset:15488
    v_mfma_f32_16x16x32_bf16 v[168:171], v[60:63], v[44:47], v[168:171]
    ds_read_b64_tr_b16 v[122:123], v186 offset:18048
    ds_read_b64_tr_b16 v[124:125], v187 offset:15360
    ds_read_b64_tr_b16 v[126:127], v187 offset:17920
    v_mfma_f32_16x16x32_bf16 v[172:175], v[64:67], v[44:47], v[172:175]
    v_mfma_f32_16x16x32_bf16 v[180:183], v[64:67], v[152:155], v[180:183]
    v_mfma_f32_16x16x32_bf16 v[176:179], v[68:71], v[152:155], v[176:179]
    s_waitcnt lgkmcnt(0)
    s_barrier
    ds_read_b128 v[16:19], v184 offset:16384
    ds_read_b64_tr_b16 v[20:21], v186 offset:20480
    v_mfma_f32_16x16x32_bf16 v[156:159], v[76:79], v[72:75], v[156:159]
    ds_read_b64_tr_b16 v[22:23], v186 offset:23040
    ds_read_b64_tr_b16 v[24:25], v186 offset:20512
    v_mfma_f32_16x16x32_bf16 v[160:163], v[80:83], v[72:75], v[160:163]
    ds_read_b64_tr_b16 v[26:27], v186 offset:23072
    ds_read_b64_tr_b16 v[28:29], v186 offset:20544
    v_mfma_f32_16x16x32_bf16 v[164:167], v[84:87], v[72:75], v[164:167]
    ds_read_b64_tr_b16 v[30:31], v186 offset:23104
    ds_read_b64_tr_b16 v[32:33], v186 offset:20576
    v_mfma_f32_16x16x32_bf16 v[168:171], v[88:91], v[72:75], v[168:171]
    ds_read_b64_tr_b16 v[34:35], v186 offset:23136
    ds_read_b64_tr_b16 v[36:37], v186 offset:20608
    v_mfma_f32_16x16x32_bf16 v[172:175], v[92:95], v[72:75], v[172:175]
    ds_read_b64_tr_b16 v[38:39], v186 offset:23168
    ds_read_b64_tr_b16 v[40:41], v187 offset:20480
    ds_read_b64_tr_b16 v[42:43], v187 offset:23040
    v_mfma_f32_16x16x32_bf16 v[180:183], v[92:95], v[152:155], v[180:183]
    ds_read_b128 v[44:47], v185 offset:16384
    ds_read_b64_tr_b16 v[48:49], v186 offset:25600
    v_mfma_f32_16x16x32_bf16 v[176:179], v[96:99], v[152:155], v[176:179]
    ds_read_b64_tr_b16 v[50:51], v186 offset:28160
    ds_read_b64_tr_b16 v[52:53], v186 offset:25632
    v_mfma_f32_16x16x32_bf16 v[156:159], v[104:107], v[100:103], v[156:159]
    ds_read_b64_tr_b16 v[54:55], v186 offset:28192
    ds_read_b64_tr_b16 v[56:57], v186 offset:25664
    v_mfma_f32_16x16x32_bf16 v[160:163], v[108:111], v[100:103], v[160:163]
    ds_read_b64_tr_b16 v[58:59], v186 offset:28224
    ds_read_b64_tr_b16 v[60:61], v186 offset:25696
    v_mfma_f32_16x16x32_bf16 v[164:167], v[112:115], v[100:103], v[164:167]
    ds_read_b64_tr_b16 v[62:63], v186 offset:28256
    ds_read_b64_tr_b16 v[64:65], v186 offset:25728
    v_mfma_f32_16x16x32_bf16 v[168:171], v[116:119], v[100:103], v[168:171]
    ds_read_b64_tr_b16 v[66:67], v186 offset:28288
    ds_read_b64_tr_b16 v[68:69], v187 offset:25600
    ds_read_b64_tr_b16 v[70:71], v187 offset:28160
    v_mfma_f32_16x16x32_bf16 v[172:175], v[120:123], v[100:103], v[172:175]
    v_mfma_f32_16x16x32_bf16 v[180:183], v[120:123], v[152:155], v[180:183]
    v_mfma_f32_16x16x32_bf16 v[176:179], v[124:127], v[152:155], v[176:179]
    s_waitcnt lgkmcnt(0)
    s_branch sequential_preLN__grouped_kv_mqa__dense_activation_silu__prompt_kernel_pB
sequential_preLN__grouped_kv_mqa__dense_activation_silu__prompt_kernel_aK:
    s_lshl_b32 s49, s48, 4
    v_add_u32 v4, s49, v2
    v_lshrrev_b32 v5, 1, v3
    v_lshl_add_u32 v5, v5, 5, v4
    v_lshlrev_b32 v5, 4, v5
    v_and_b32 v6, 1, v3
    v_lshl_add_u32 v5, v6, 3, v5
    s_lshl_b32 s49, s47, 10
    v_add_u32 v196, s49, v5
    s_lshr_b32 s49, s47, 2
    s_lshl_b32 s49, s49, 10
    s_add_u32 s49, s49, 8192
    s_bfe_u32 s50, s47, 0x10001
    s_lshl_b32 s50, s50, 9
    s_add_u32 s49, s49, s50
    s_and_b32 s50, s47, 1
    s_lshl_b32 s50, s50, 3
    s_add_u32 s49, s49, s50
    v_lshlrev_b32 v6, 4, v4
    v_add_u32 v6, s49, v6
    v_cmp_eq_u32 vcc, 0, v3
    v_mov_b32 v7, 0x7fffff00
    s_nop 1
    v_cndmask_b32 v197, v7, v6, vcc

    s_lshl_b32 s42, s37, 1
    s_add_u32 s42, s42, s38
    s_mul_i32 s42, s42, 384
    s_add_u32 s42, s42, 9895936
    s_cmp_eq_u32 s36, 0
    s_cselect_b32 s42, s42, 0x7f000000
    v_lshlrev_b32 v4, 7, v1
    v_mov_b32 v5, 0
    s_mov_b64 exec, 7
    buffer_store_dword v5, v4, s[16:19], s42 offen sc1
    s_mov_b64 exec, -1

    s_waitcnt lgkmcnt(0)
    s_barrier
    s_mul_i32 s42, s60, 2560
    v_add_u32 v188, s42, v204
    s_add_u32 s60, s60, 1
    s_cmp_eq_u32 s60, 10
    s_cselect_b32 s60, 0, s60
    ds_read_b128 v[16:19], v184 offset:0
    ds_read_b64_tr_b16 v[20:21], v188 offset:0
    ds_read_b64_tr_b16 v[22:23], v188 offset:160
    ds_read_b64_tr_b16 v[24:25], v188 offset:32
    ds_read_b64_tr_b16 v[26:27], v188 offset:192
    ds_read_b128 v[44:47], v185 offset:0
    ds_read_b64_tr_b16 v[48:49], v188 offset:1280
    ds_read_b64_tr_b16 v[50:51], v188 offset:1440
    ds_read_b64_tr_b16 v[52:53], v188 offset:1312
    ds_read_b64_tr_b16 v[54:55], v188 offset:1472
    s_waitcnt lgkmcnt(0)
    s_barrier
    s_mul_i32 s42, s60, 2560
    v_mfma_f32_16x16x32_bf16 v[132:135], v[16:19], v[16:19], 0
    v_add_u32 v188, s42, v204
    s_add_u32 s60, s60, 1
    v_mfma_f32_16x16x32_bf16 v[128:131], v[152:155], v[16:19], 0
    s_cmp_eq_u32 s60, 10
    v_mfma_f32_16x16x32_bf16 v[136:139], v[20:23], v[16:19], 0
    s_cselect_b32 s60, 0, s60
    ds_read_b128 v[72:75], v184 offset:8192
    v_mfma_f32_16x16x32_bf16 v[144:147], v[20:23], v[152:155], 0
    ds_read_b64_tr_b16 v[76:77], v188 offset:0
    v_mfma_f32_16x16x32_bf16 v[140:143], v[24:27], v[16:19], 0
    ds_read_b64_tr_b16 v[78:79], v188 offset:160
    ds_read_b64_tr_b16 v[80:81], v188 offset:32
    v_mfma_f32_16x16x32_bf16 v[148:151], v[24:27], v[152:155], 0
    ds_read_b64_tr_b16 v[82:83], v188 offset:192
    v_mfma_f32_16x16x32_bf16 v[132:135], v[44:47], v[44:47], v[132:135]
    ds_read_b128 v[100:103], v185 offset:8192
    ds_read_b64_tr_b16 v[104:105], v188 offset:1280
    v_mfma_f32_16x16x32_bf16 v[128:131], v[152:155], v[44:47], v[128:131]
    ds_read_b64_tr_b16 v[106:107], v188 offset:1440
    v_mfma_f32_16x16x32_bf16 v[136:139], v[48:51], v[44:47], v[136:139]
    ds_read_b64_tr_b16 v[108:109], v188 offset:1312
    ds_read_b64_tr_b16 v[110:111], v188 offset:1472
    v_mfma_f32_16x16x32_bf16 v[144:147], v[48:51], v[152:155], v[144:147]
    v_mfma_f32_16x16x32_bf16 v[140:143], v[52:55], v[44:47], v[140:143]
    v_mfma_f32_16x16x32_bf16 v[148:151], v[52:55], v[152:155], v[148:151]
    s_waitcnt lgkmcnt(0)
    s_barrier
    s_mul_i32 s42, s60, 2560
    v_mfma_f32_16x16x32_bf16 v[132:135], v[72:75], v[72:75], v[132:135]
    v_add_u32 v188, s42, v204
    s_add_u32 s60, s60, 1
    v_mfma_f32_16x16x32_bf16 v[128:131], v[152:155], v[72:75], v[128:131]
    s_cmp_eq_u32 s60, 10
    v_mfma_f32_16x16x32_bf16 v[136:139], v[76:79], v[72:75], v[136:139]
    s_cselect_b32 s60, 0, s60
    ds_read_b128 v[16:19], v184 offset:16384
    v_mfma_f32_16x16x32_bf16 v[144:147], v[76:79], v[152:155], v[144:147]
    ds_read_b64_tr_b16 v[20:21], v188 offset:0
    v_mfma_f32_16x16x32_bf16 v[140:143], v[80:83], v[72:75], v[140:143]
    ds_read_b64_tr_b16 v[22:23], v188 offset:160
    ds_read_b64_tr_b16 v[24:25], v188 offset:32
    v_mfma_f32_16x16x32_bf16 v[148:151], v[80:83], v[152:155], v[148:151]
    ds_read_b64_tr_b16 v[26:27], v188 offset:192
    v_mfma_f32_16x16x32_bf16 v[132:135], v[100:103], v[100:103], v[132:135]
    ds_read_b128 v[44:47], v185 offset:16384
    ds_read_b64_tr_b16 v[48:49], v188 offset:1280
    v_mfma_f32_16x16x32_bf16 v[128:131], v[152:155], v[100:103], v[128:131]
    ds_read_b64_tr_b16 v[50:51], v188 offset:1440
    v_mfma_f32_16x16x32_bf16 v[136:139], v[104:107], v[100:103], v[136:139]
    ds_read_b64_tr_b16 v[52:53], v188 offset:1312
    ds_read_b64_tr_b16 v[54:55], v188 offset:1472
    v_mfma_f32_16x16x32_bf16 v[144:147], v[104:107], v[152:155], v[144:147]
    v_mfma_f32_16x16x32_bf16 v[140:143], v[108:111], v[100:103], v[140:143]
    v_mfma_f32_16x16x32_bf16 v[148:151], v[108:111], v[152:155], v[148:151]
    s_waitcnt lgkmcnt(0)
    s_barrier
    s_mul_i32 s42, s60, 2560
    v_mfma_f32_16x16x32_bf16 v[132:135], v[16:19], v[16:19], v[132:135]
    v_add_u32 v188, s42, v204
    s_add_u32 s60, s60, 1
    v_mfma_f32_16x16x32_bf16 v[128:131], v[152:155], v[16:19], v[128:131]
    s_cmp_eq_u32 s60, 10
    v_mfma_f32_16x16x32_bf16 v[136:139], v[20:23], v[16:19], v[136:139]
    s_cselect_b32 s60, 0, s60
    ds_read_b128 v[72:75], v184 offset:24576
    v_mfma_f32_16x16x32_bf16 v[144:147], v[20:23], v[152:155], v[144:147]
    ds_read_b64_tr_b16 v[76:77], v188 offset:0
    v_mfma_f32_16x16x32_bf16 v[140:143], v[24:27], v[16:19], v[140:143]
    ds_read_b64_tr_b16 v[78:79], v188 offset:160
    ds_read_b64_tr_b16 v[80:81], v188 offset:32
    v_mfma_f32_16x16x32_bf16 v[148:151], v[24:27], v[152:155], v[148:151]
    ds_read_b64_tr_b16 v[82:83], v188 offset:192
    v_mfma_f32_16x16x32_bf16 v[132:135], v[44:47], v[44:47], v[132:135]
    ds_read_b128 v[100:103], v185 offset:24576
    ds_read_b64_tr_b16 v[104:105], v188 offset:1280
    v_mfma_f32_16x16x32_bf16 v[128:131], v[152:155], v[44:47], v[128:131]
    ds_read_b64_tr_b16 v[106:107], v188 offset:1440
    v_mfma_f32_16x16x32_bf16 v[136:139], v[48:51], v[44:47], v[136:139]
    ds_read_b64_tr_b16 v[108:109], v188 offset:1312
    ds_read_b64_tr_b16 v[110:111], v188 offset:1472
    v_mfma_f32_16x16x32_bf16 v[144:147], v[48:51], v[152:155], v[144:147]
    v_mfma_f32_16x16x32_bf16 v[140:143], v[52:55], v[44:47], v[140:143]
    v_mfma_f32_16x16x32_bf16 v[148:151], v[52:55], v[152:155], v[148:151]
    s_waitcnt lgkmcnt(0)
    s_barrier
    s_mul_i32 s42, s60, 2560
    v_mfma_f32_16x16x32_bf16 v[132:135], v[72:75], v[72:75], v[132:135]
    v_add_u32 v188, s42, v204
    s_add_u32 s60, s60, 1
    v_mfma_f32_16x16x32_bf16 v[128:131], v[152:155], v[72:75], v[128:131]
    s_cmp_eq_u32 s60, 10
    v_mfma_f32_16x16x32_bf16 v[136:139], v[76:79], v[72:75], v[136:139]
    s_cselect_b32 s60, 0, s60
    ds_read_b128 v[16:19], v184 offset:32768
    v_mfma_f32_16x16x32_bf16 v[144:147], v[76:79], v[152:155], v[144:147]
    ds_read_b64_tr_b16 v[20:21], v188 offset:0
    v_mfma_f32_16x16x32_bf16 v[140:143], v[80:83], v[72:75], v[140:143]
    ds_read_b64_tr_b16 v[22:23], v188 offset:160
    ds_read_b64_tr_b16 v[24:25], v188 offset:32
    v_mfma_f32_16x16x32_bf16 v[148:151], v[80:83], v[152:155], v[148:151]
    ds_read_b64_tr_b16 v[26:27], v188 offset:192
    v_mfma_f32_16x16x32_bf16 v[132:135], v[100:103], v[100:103], v[132:135]
    ds_read_b128 v[44:47], v185 offset:32768
    ds_read_b64_tr_b16 v[48:49], v188 offset:1280
    v_mfma_f32_16x16x32_bf16 v[128:131], v[152:155], v[100:103], v[128:131]
    ds_read_b64_tr_b16 v[50:51], v188 offset:1440
    v_mfma_f32_16x16x32_bf16 v[136:139], v[104:107], v[100:103], v[136:139]
    ds_read_b64_tr_b16 v[52:53], v188 offset:1312
    ds_read_b64_tr_b16 v[54:55], v188 offset:1472
    v_mfma_f32_16x16x32_bf16 v[144:147], v[104:107], v[152:155], v[144:147]
    v_mfma_f32_16x16x32_bf16 v[140:143], v[108:111], v[100:103], v[140:143]
    v_mfma_f32_16x16x32_bf16 v[148:151], v[108:111], v[152:155], v[148:151]
    s_waitcnt lgkmcnt(0)
    s_barrier
    s_mul_i32 s42, s60, 2560
    v_mfma_f32_16x16x32_bf16 v[132:135], v[16:19], v[16:19], v[132:135]
    v_add_u32 v188, s42, v204
    s_add_u32 s60, s60, 1
    v_mfma_f32_16x16x32_bf16 v[128:131], v[152:155], v[16:19], v[128:131]
    s_cmp_eq_u32 s60, 10
    v_mfma_f32_16x16x32_bf16 v[136:139], v[20:23], v[16:19], v[136:139]
    s_cselect_b32 s60, 0, s60
    ds_read_b128 v[72:75], v202 offset:0
    v_mfma_f32_16x16x32_bf16 v[144:147], v[20:23], v[152:155], v[144:147]
    ds_read_b64_tr_b16 v[76:77], v188 offset:0
    v_mfma_f32_16x16x32_bf16 v[140:143], v[24:27], v[16:19], v[140:143]
    ds_read_b64_tr_b16 v[78:79], v188 offset:160
    ds_read_b64_tr_b16 v[80:81], v188 offset:32
    v_mfma_f32_16x16x32_bf16 v[148:151], v[24:27], v[152:155], v[148:151]
    ds_read_b64_tr_b16 v[82:83], v188 offset:192
    v_mfma_f32_16x16x32_bf16 v[132:135], v[44:47], v[44:47], v[132:135]
    ds_read_b128 v[100:103], v203 offset:0
    ds_read_b64_tr_b16 v[104:105], v188 offset:1280
    v_mfma_f32_16x16x32_bf16 v[128:131], v[152:155], v[44:47], v[128:131]
    ds_read_b64_tr_b16 v[106:107], v188 offset:1440
    v_mfma_f32_16x16x32_bf16 v[136:139], v[48:51], v[44:47], v[136:139]
    ds_read_b64_tr_b16 v[108:109], v188 offset:1312
    ds_read_b64_tr_b16 v[110:111], v188 offset:1472
    v_mfma_f32_16x16x32_bf16 v[144:147], v[48:51], v[152:155], v[144:147]
    v_mfma_f32_16x16x32_bf16 v[140:143], v[52:55], v[44:47], v[140:143]
    v_mfma_f32_16x16x32_bf16 v[148:151], v[52:55], v[152:155], v[148:151]
    s_waitcnt lgkmcnt(0)
    s_barrier
    s_mul_i32 s42, s60, 2560
    v_mfma_f32_16x16x32_bf16 v[132:135], v[72:75], v[72:75], v[132:135]
    v_add_u32 v188, s42, v204
    s_add_u32 s60, s60, 1
    v_mfma_f32_16x16x32_bf16 v[128:131], v[152:155], v[72:75], v[128:131]
    s_cmp_eq_u32 s60, 10
    v_mfma_f32_16x16x32_bf16 v[136:139], v[76:79], v[72:75], v[136:139]
    s_cselect_b32 s60, 0, s60
    ds_read_b128 v[16:19], v202 offset:8192
    v_mfma_f32_16x16x32_bf16 v[144:147], v[76:79], v[152:155], v[144:147]
    ds_read_b64_tr_b16 v[20:21], v188 offset:0
    v_mfma_f32_16x16x32_bf16 v[140:143], v[80:83], v[72:75], v[140:143]
    ds_read_b64_tr_b16 v[22:23], v188 offset:160
    ds_read_b64_tr_b16 v[24:25], v188 offset:32
    v_mfma_f32_16x16x32_bf16 v[148:151], v[80:83], v[152:155], v[148:151]
    ds_read_b64_tr_b16 v[26:27], v188 offset:192
    v_mfma_f32_16x16x32_bf16 v[132:135], v[100:103], v[100:103], v[132:135]
    ds_read_b128 v[44:47], v203 offset:8192
    ds_read_b64_tr_b16 v[48:49], v188 offset:1280
    v_mfma_f32_16x16x32_bf16 v[128:131], v[152:155], v[100:103], v[128:131]
    ds_read_b64_tr_b16 v[50:51], v188 offset:1440
    v_mfma_f32_16x16x32_bf16 v[136:139], v[104:107], v[100:103], v[136:139]
    ds_read_b64_tr_b16 v[52:53], v188 offset:1312
    ds_read_b64_tr_b16 v[54:55], v188 offset:1472
    v_mfma_f32_16x16x32_bf16 v[144:147], v[104:107], v[152:155], v[144:147]
    v_mfma_f32_16x16x32_bf16 v[140:143], v[108:111], v[100:103], v[140:143]
    v_mfma_f32_16x16x32_bf16 v[148:151], v[108:111], v[152:155], v[148:151]
    s_waitcnt lgkmcnt(0)
    s_barrier
    s_mul_i32 s42, s60, 2560
    v_mfma_f32_16x16x32_bf16 v[132:135], v[16:19], v[16:19], v[132:135]
    v_add_u32 v188, s42, v204
    s_add_u32 s60, s60, 1
    v_mfma_f32_16x16x32_bf16 v[128:131], v[152:155], v[16:19], v[128:131]
    s_cmp_eq_u32 s60, 10
    v_mfma_f32_16x16x32_bf16 v[136:139], v[20:23], v[16:19], v[136:139]
    s_cselect_b32 s60, 0, s60
    ds_read_b128 v[72:75], v202 offset:16384
    v_mfma_f32_16x16x32_bf16 v[144:147], v[20:23], v[152:155], v[144:147]
    ds_read_b64_tr_b16 v[76:77], v188 offset:0
    v_mfma_f32_16x16x32_bf16 v[140:143], v[24:27], v[16:19], v[140:143]
    ds_read_b64_tr_b16 v[78:79], v188 offset:160
    ds_read_b64_tr_b16 v[80:81], v188 offset:32
    v_mfma_f32_16x16x32_bf16 v[148:151], v[24:27], v[152:155], v[148:151]
    ds_read_b64_tr_b16 v[82:83], v188 offset:192
    v_mfma_f32_16x16x32_bf16 v[132:135], v[44:47], v[44:47], v[132:135]
    ds_read_b128 v[100:103], v203 offset:16384
    ds_read_b64_tr_b16 v[104:105], v188 offset:1280
    v_mfma_f32_16x16x32_bf16 v[128:131], v[152:155], v[44:47], v[128:131]
    ds_read_b64_tr_b16 v[106:107], v188 offset:1440
    v_mfma_f32_16x16x32_bf16 v[136:139], v[48:51], v[44:47], v[136:139]
    ds_read_b64_tr_b16 v[108:109], v188 offset:1312
    ds_read_b64_tr_b16 v[110:111], v188 offset:1472
    v_mfma_f32_16x16x32_bf16 v[144:147], v[48:51], v[152:155], v[144:147]
    v_mfma_f32_16x16x32_bf16 v[140:143], v[52:55], v[44:47], v[140:143]
    v_mfma_f32_16x16x32_bf16 v[148:151], v[52:55], v[152:155], v[148:151]
    s_waitcnt lgkmcnt(0)
    s_barrier
    s_mul_i32 s42, s60, 2560
    v_mfma_f32_16x16x32_bf16 v[132:135], v[72:75], v[72:75], v[132:135]
    v_add_u32 v188, s42, v204
    s_add_u32 s60, s60, 1
    v_mfma_f32_16x16x32_bf16 v[128:131], v[152:155], v[72:75], v[128:131]
    s_cmp_eq_u32 s60, 10
    v_mfma_f32_16x16x32_bf16 v[136:139], v[76:79], v[72:75], v[136:139]
    s_cselect_b32 s60, 0, s60
    ds_read_b128 v[16:19], v202 offset:24576
    v_mfma_f32_16x16x32_bf16 v[144:147], v[76:79], v[152:155], v[144:147]
    ds_read_b64_tr_b16 v[20:21], v188 offset:0
    v_mfma_f32_16x16x32_bf16 v[140:143], v[80:83], v[72:75], v[140:143]
    ds_read_b64_tr_b16 v[22:23], v188 offset:160
    ds_read_b64_tr_b16 v[24:25], v188 offset:32
    v_mfma_f32_16x16x32_bf16 v[148:151], v[80:83], v[152:155], v[148:151]
    ds_read_b64_tr_b16 v[26:27], v188 offset:192
    v_mfma_f32_16x16x32_bf16 v[132:135], v[100:103], v[100:103], v[132:135]
    ds_read_b128 v[44:47], v203 offset:24576
    ds_read_b64_tr_b16 v[48:49], v188 offset:1280
    v_mfma_f32_16x16x32_bf16 v[128:131], v[152:155], v[100:103], v[128:131]
    ds_read_b64_tr_b16 v[50:51], v188 offset:1440
    v_mfma_f32_16x16x32_bf16 v[136:139], v[104:107], v[100:103], v[136:139]
    ds_read_b64_tr_b16 v[52:53], v188 offset:1312
    ds_read_b64_tr_b16 v[54:55], v188 offset:1472
    v_mfma_f32_16x16x32_bf16 v[144:147], v[104:107], v[152:155], v[144:147]
    v_mfma_f32_16x16x32_bf16 v[140:143], v[108:111], v[100:103], v[140:143]
    v_mfma_f32_16x16x32_bf16 v[148:151], v[108:111], v[152:155], v[148:151]
    s_waitcnt lgkmcnt(0)
    s_barrier
    s_mul_i32 s42, s60, 2560
    v_mfma_f32_16x16x32_bf16 v[132:135], v[16:19], v[16:19], v[132:135]
    v_add_u32 v188, s42, v204
    s_add_u32 s60, s60, 1
    v_mfma_f32_16x16x32_bf16 v[128:131], v[152:155], v[16:19], v[128:131]
    s_cmp_eq_u32 s60, 10
    v_mfma_f32_16x16x32_bf16 v[136:139], v[20:23], v[16:19], v[136:139]
    s_cselect_b32 s60, 0, s60
    ds_read_b128 v[72:75], v202 offset:32768
    v_mfma_f32_16x16x32_bf16 v[144:147], v[20:23], v[152:155], v[144:147]
    ds_read_b64_tr_b16 v[76:77], v188 offset:0
    v_mfma_f32_16x16x32_bf16 v[140:143], v[24:27], v[16:19], v[140:143]
    ds_read_b64_tr_b16 v[78:79], v188 offset:160
    ds_read_b64_tr_b16 v[80:81], v188 offset:32
    v_mfma_f32_16x16x32_bf16 v[148:151], v[24:27], v[152:155], v[148:151]
    ds_read_b64_tr_b16 v[82:83], v188 offset:192
    v_mfma_f32_16x16x32_bf16 v[132:135], v[44:47], v[44:47], v[132:135]
    ds_read_b128 v[100:103], v203 offset:32768
    ds_read_b64_tr_b16 v[104:105], v188 offset:1280
    v_mfma_f32_16x16x32_bf16 v[128:131], v[152:155], v[44:47], v[128:131]
    ds_read_b64_tr_b16 v[106:107], v188 offset:1440
    v_mfma_f32_16x16x32_bf16 v[136:139], v[48:51], v[44:47], v[136:139]
    ds_read_b64_tr_b16 v[108:109], v188 offset:1312
    ds_read_b64_tr_b16 v[110:111], v188 offset:1472
    v_mfma_f32_16x16x32_bf16 v[144:147], v[48:51], v[152:155], v[144:147]
    v_mfma_f32_16x16x32_bf16 v[140:143], v[52:55], v[44:47], v[140:143]
    v_mfma_f32_16x16x32_bf16 v[148:151], v[52:55], v[152:155], v[148:151]
    s_waitcnt lgkmcnt(0)
    s_barrier
    ds_read_b128 v[16:19], v184 offset:0
    ds_read_b64_tr_b16 v[20:21], v186 offset:0
    v_mfma_f32_16x16x32_bf16 v[132:135], v[72:75], v[72:75], v[132:135]
    ds_read_b64_tr_b16 v[22:23], v186 offset:2560
    ds_read_b64_tr_b16 v[24:25], v186 offset:32
    ds_read_b64_tr_b16 v[26:27], v186 offset:2592
    v_mfma_f32_16x16x32_bf16 v[128:131], v[152:155], v[72:75], v[128:131]
    ds_read_b64_tr_b16 v[28:29], v186 offset:64
    ds_read_b64_tr_b16 v[30:31], v186 offset:2624
    v_mfma_f32_16x16x32_bf16 v[136:139], v[76:79], v[72:75], v[136:139]
    ds_read_b64_tr_b16 v[32:33], v186 offset:96
    ds_read_b64_tr_b16 v[34:35], v186 offset:2656
    ds_read_b64_tr_b16 v[36:37], v186 offset:128
    v_mfma_f32_16x16x32_bf16 v[144:147], v[76:79], v[152:155], v[144:147]
    ds_read_b64_tr_b16 v[38:39], v186 offset:2688
    ds_read_b64_tr_b16 v[40:41], v187 offset:0
    ds_read_b64_tr_b16 v[42:43], v187 offset:2560
    v_mfma_f32_16x16x32_bf16 v[140:143], v[80:83], v[72:75], v[140:143]
    ds_read_b128 v[44:47], v185 offset:0
    ds_read_b64_tr_b16 v[48:49], v186 offset:5120
    v_mfma_f32_16x16x32_bf16 v[148:151], v[80:83], v[152:155], v[148:151]
    ds_read_b64_tr_b16 v[50:51], v186 offset:7680
    ds_read_b64_tr_b16 v[52:53], v186 offset:5152
    ds_read_b64_tr_b16 v[54:55], v186 offset:7712
    v_mfma_f32_16x16x32_bf16 v[132:135], v[100:103], v[100:103], v[132:135]
    ds_read_b64_tr_b16 v[56:57], v186 offset:5184
    ds_read_b64_tr_b16 v[58:59], v186 offset:7744
    v_mfma_f32_16x16x32_bf16 v[128:131], v[152:155], v[100:103], v[128:131]
    ds_read_b64_tr_b16 v[60:61], v186 offset:5216
    ds_read_b64_tr_b16 v[62:63], v186 offset:7776
    ds_read_b64_tr_b16 v[64:65], v186 offset:5248
    v_mfma_f32_16x16x32_bf16 v[136:139], v[104:107], v[100:103], v[136:139]
    ds_read_b64_tr_b16 v[66:67], v186 offset:7808
    ds_read_b64_tr_b16 v[68:69], v187 offset:5120
    ds_read_b64_tr_b16 v[70:71], v187 offset:7680
    v_mfma_f32_16x16x32_bf16 v[144:147], v[104:107], v[152:155], v[144:147]
    v_mfma_f32_16x16x32_bf16 v[140:143], v[108:111], v[100:103], v[140:143]
    v_mfma_f32_16x16x32_bf16 v[148:151], v[108:111], v[152:155], v[148:151]
    s_nop 7
    v_cndmask_b32 v5, v132, v133, s[52:53]
    v_cndmask_b32 v5, v5, v134, s[54:55]
    v_cndmask_b32 v5, v5, v135, s[56:57]
    ds_bpermute_b32 v7, v12, v5
    v_mul_f32 v200, 0x3acccccd, v128
    s_waitcnt lgkmcnt(0)
    s_barrier
    v_mul_f32 v7, 0x3acccccd, v7
    v_fma_f32 v7, -v200, v200, v7
    v_max_f32 v7, 0, v7
    v_add_f32 v7, 0x3727c5ac, v7
    v_rsq_f32 v201, v7
    s_nop 0
    v_fma_f32 v136, -v200, v144, v136
    v_fma_f32 v137, -v200, v145, v137
    v_fma_f32 v138, -v200, v146, v138
    v_fma_f32 v139, -v200, v147, v139
    v_mul_f32 v136, v201, v136
    v_mul_f32 v137, v201, v137
    v_mul_f32 v138, v201, v138
    v_mul_f32 v139, v201, v139
    v_cvt_pk_bf16_f32 v144, v136, v137
    v_cvt_pk_bf16_f32 v145, v138, v139
    buffer_store_dwordx2 v[144:145], v196, s[16:19], s46 offen sc1
    v_fma_f32 v140, -v200, v148, v140
    v_fma_f32 v141, -v200, v149, v141
    v_fma_f32 v142, -v200, v150, v142
    v_fma_f32 v143, -v200, v151, v143
    v_mul_f32 v140, v201, v140
    v_mul_f32 v141, v201, v141
    v_mul_f32 v142, v201, v142
    v_mul_f32 v143, v201, v143
    v_cvt_pk_bf16_f32 v148, v140, v141
    v_cvt_pk_bf16_f32 v149, v142, v143
    buffer_store_dwordx2 v[148:149], v197, s[16:19], s46 offen sc1
    ds_read_b128 v[72:75], v184 offset:8192
    ds_read_b64_tr_b16 v[76:77], v186 offset:10240
    v_mfma_f32_16x16x32_bf16 v[156:159], v[20:23], v[16:19], 0
    ds_read_b64_tr_b16 v[78:79], v186 offset:12800
    ds_read_b64_tr_b16 v[80:81], v186 offset:10272
    v_mfma_f32_16x16x32_bf16 v[160:163], v[24:27], v[16:19], 0
    ds_read_b64_tr_b16 v[82:83], v186 offset:12832
    ds_read_b64_tr_b16 v[84:85], v186 offset:10304
    v_mfma_f32_16x16x32_bf16 v[164:167], v[28:31], v[16:19], 0
    ds_read_b64_tr_b16 v[86:87], v186 offset:12864
    ds_read_b64_tr_b16 v[88:89], v186 offset:10336
    v_mfma_f32_16x16x32_bf16 v[168:171], v[32:35], v[16:19], 0
    ds_read_b64_tr_b16 v[90:91], v186 offset:12896
    ds_read_b64_tr_b16 v[92:93], v186 offset:10368
    v_mfma_f32_16x16x32_bf16 v[172:175], v[36:39], v[16:19], 0
    ds_read_b64_tr_b16 v[94:95], v186 offset:12928
    ds_read_b64_tr_b16 v[96:97], v187 offset:10240
    ds_read_b64_tr_b16 v[98:99], v187 offset:12800
    v_mfma_f32_16x16x32_bf16 v[180:183], v[36:39], v[152:155], 0
    ds_read_b128 v[100:103], v185 offset:8192
    ds_read_b64_tr_b16 v[104:105], v186 offset:15360
    v_mfma_f32_16x16x32_bf16 v[176:179], v[40:43], v[152:155], 0
    ds_read_b64_tr_b16 v[106:107], v186 offset:17920
    ds_read_b64_tr_b16 v[108:109], v186 offset:15392
    v_mfma_f32_16x16x32_bf16 v[156:159], v[48:51], v[44:47], v[156:159]
    ds_read_b64_tr_b16 v[110:111], v186 offset:17952
    ds_read_b64_tr_b16 v[112:113], v186 offset:15424
    v_mfma_f32_16x16x32_bf16 v[160:163], v[52:55], v[44:47], v[160:163]
    ds_read_b64_tr_b16 v[114:115], v186 offset:17984
    ds_read_b64_tr_b16 v[116:117], v186 offset:15456
    v_mfma_f32_16x16x32_bf16 v[164:167], v[56:59], v[44:47], v[164:167]
    ds_read_b64_tr_b16 v[118:119], v186 offset:18016
    ds_read_b64_tr_b16 v[120:121], v186 offset:15488
    v_mfma_f32_16x16x32_bf16 v[168:171], v[60:63], v[44:47], v[168:171]
    ds_read_b64_tr_b16 v[122:123], v186 offset:18048
    ds_read_b64_tr_b16 v[124:125], v187 offset:15360
    ds_read_b64_tr_b16 v[126:127], v187 offset:17920
    v_mfma_f32_16x16x32_bf16 v[172:175], v[64:67], v[44:47], v[172:175]
    v_mfma_f32_16x16x32_bf16 v[180:183], v[64:67], v[152:155], v[180:183]
    v_mfma_f32_16x16x32_bf16 v[176:179], v[68:71], v[152:155], v[176:179]
    s_waitcnt lgkmcnt(0)
    s_barrier
    ds_read_b128 v[16:19], v184 offset:16384
    ds_read_b64_tr_b16 v[20:21], v186 offset:20480
    v_mfma_f32_16x16x32_bf16 v[156:159], v[76:79], v[72:75], v[156:159]
    ds_read_b64_tr_b16 v[22:23], v186 offset:23040
    ds_read_b64_tr_b16 v[24:25], v186 offset:20512
    v_mfma_f32_16x16x32_bf16 v[160:163], v[80:83], v[72:75], v[160:163]
    ds_read_b64_tr_b16 v[26:27], v186 offset:23072
    ds_read_b64_tr_b16 v[28:29], v186 offset:20544
    v_mfma_f32_16x16x32_bf16 v[164:167], v[84:87], v[72:75], v[164:167]
    ds_read_b64_tr_b16 v[30:31], v186 offset:23104
    ds_read_b64_tr_b16 v[32:33], v186 offset:20576
    v_mfma_f32_16x16x32_bf16 v[168:171], v[88:91], v[72:75], v[168:171]
    ds_read_b64_tr_b16 v[34:35], v186 offset:23136
    ds_read_b64_tr_b16 v[36:37], v186 offset:20608
    v_mfma_f32_16x16x32_bf16 v[172:175], v[92:95], v[72:75], v[172:175]
    ds_read_b64_tr_b16 v[38:39], v186 offset:23168
    ds_read_b64_tr_b16 v[40:41], v187 offset:20480
    ds_read_b64_tr_b16 v[42:43], v187 offset:23040
    v_mfma_f32_16x16x32_bf16 v[180:183], v[92:95], v[152:155], v[180:183]
    ds_read_b128 v[44:47], v185 offset:16384
    ds_read_b64_tr_b16 v[48:49], v186 offset:25600
    v_mfma_f32_16x16x32_bf16 v[176:179], v[96:99], v[152:155], v[176:179]
    ds_read_b64_tr_b16 v[50:51], v186 offset:28160
    ds_read_b64_tr_b16 v[52:53], v186 offset:25632
    v_mfma_f32_16x16x32_bf16 v[156:159], v[104:107], v[100:103], v[156:159]
    ds_read_b64_tr_b16 v[54:55], v186 offset:28192
    ds_read_b64_tr_b16 v[56:57], v186 offset:25664
    v_mfma_f32_16x16x32_bf16 v[160:163], v[108:111], v[100:103], v[160:163]
    ds_read_b64_tr_b16 v[58:59], v186 offset:28224
    ds_read_b64_tr_b16 v[60:61], v186 offset:25696
    v_mfma_f32_16x16x32_bf16 v[164:167], v[112:115], v[100:103], v[164:167]
    ds_read_b64_tr_b16 v[62:63], v186 offset:28256
    ds_read_b64_tr_b16 v[64:65], v186 offset:25728
    v_mfma_f32_16x16x32_bf16 v[168:171], v[116:119], v[100:103], v[168:171]
    ds_read_b64_tr_b16 v[66:67], v186 offset:28288
    ds_read_b64_tr_b16 v[68:69], v187 offset:25600
    ds_read_b64_tr_b16 v[70:71], v187 offset:28160
    v_mfma_f32_16x16x32_bf16 v[172:175], v[120:123], v[100:103], v[172:175]
    v_mfma_f32_16x16x32_bf16 v[180:183], v[120:123], v[152:155], v[180:183]
    v_mfma_f32_16x16x32_bf16 v[176:179], v[124:127], v[152:155], v[176:179]
    s_waitcnt lgkmcnt(0)
    s_branch sequential_preLN__grouped_kv_mqa__dense_activation_silu__prompt_kernel_pB
sequential_preLN__grouped_kv_mqa__dense_activation_silu__prompt_kernel_aV:
    s_lshl_b32 s49, s47, 1
    s_add_u32 s49, s49, s48
    s_mul_i32 s49, s49, 640
    s_add_u32 s46, s46, s49
    s_add_u32 s46, s46, 10240
    v_and_b32 v4, 1, v3
    v_mul_u32_u24 v4, 20, v4
    v_add_u32 v4, v4, v2
    v_lshlrev_b32 v4, 4, v4
    v_lshrrev_b32 v5, 1, v3
    v_lshl_add_u32 v196, v5, 3, v4
    v_add_u32 v6, 256, v196
    v_cmp_gt_u32 vcc, 4, v2
    v_mov_b32 v7, 0x7fffff00
    s_lshl_b32 s49, s36, 7
    s_add_u32 s49, s49, 150016
    v_cndmask_b32 v197, v7, v6, vcc
    v_lshl_add_u32 v198, v3, 5, s49
    v_lshl_add_u32 v199, v2, 3, s49

    s_lshl_b32 s42, s37, 1
    s_add_u32 s42, s42, s38
    s_mul_i32 s42, s42, 384
    s_add_u32 s42, s42, 9895936
    s_cmp_eq_u32 s36, 0
    s_cselect_b32 s42, s42, 0x7f000000
    v_lshlrev_b32 v4, 7, v1
    v_mov_b32 v5, 0
    s_mov_b64 exec, 7
    buffer_store_dword v5, v4, s[16:19], s42 offen sc1
    s_mov_b64 exec, -1

    s_waitcnt lgkmcnt(0)
    s_barrier
    s_mul_i32 s42, s60, 2560
    v_add_u32 v188, s42, v204
    s_add_u32 s60, s60, 1
    s_cmp_eq_u32 s60, 10
    s_cselect_b32 s60, 0, s60
    ds_read_b128 v[16:19], v184 offset:0
    ds_read_b64_tr_b16 v[20:21], v188 offset:0
    ds_read_b64_tr_b16 v[22:23], v188 offset:160
    ds_read_b64_tr_b16 v[24:25], v188 offset:32
    ds_read_b64_tr_b16 v[26:27], v188 offset:192
    ds_read_b128 v[44:47], v185 offset:0
    ds_read_b64_tr_b16 v[48:49], v188 offset:1280
    ds_read_b64_tr_b16 v[50:51], v188 offset:1440
    ds_read_b64_tr_b16 v[52:53], v188 offset:1312
    ds_read_b64_tr_b16 v[54:55], v188 offset:1472
    s_waitcnt lgkmcnt(0)
    s_barrier
    s_mul_i32 s42, s60, 2560
    v_mfma_f32_16x16x32_bf16 v[132:135], v[16:19], v[16:19], 0
    v_add_u32 v188, s42, v204
    s_add_u32 s60, s60, 1
    v_mfma_f32_16x16x32_bf16 v[128:131], v[152:155], v[16:19], 0
    s_cmp_eq_u32 s60, 10
    v_mfma_f32_16x16x32_bf16 v[136:139], v[16:19], v[20:23], 0
    s_cselect_b32 s60, 0, s60
    ds_read_b128 v[72:75], v184 offset:8192
    v_mfma_f32_16x16x32_bf16 v[144:147], v[152:155], v[20:23], 0
    ds_read_b64_tr_b16 v[76:77], v188 offset:0
    v_mfma_f32_16x16x32_bf16 v[140:143], v[16:19], v[24:27], 0
    ds_read_b64_tr_b16 v[78:79], v188 offset:160
    ds_read_b64_tr_b16 v[80:81], v188 offset:32
    v_mfma_f32_16x16x32_bf16 v[148:151], v[152:155], v[24:27], 0
    ds_read_b64_tr_b16 v[82:83], v188 offset:192
    v_mfma_f32_16x16x32_bf16 v[132:135], v[44:47], v[44:47], v[132:135]
    ds_read_b128 v[100:103], v185 offset:8192
    ds_read_b64_tr_b16 v[104:105], v188 offset:1280
    v_mfma_f32_16x16x32_bf16 v[128:131], v[152:155], v[44:47], v[128:131]
    ds_read_b64_tr_b16 v[106:107], v188 offset:1440
    v_mfma_f32_16x16x32_bf16 v[136:139], v[44:47], v[48:51], v[136:139]
    ds_read_b64_tr_b16 v[108:109], v188 offset:1312
    ds_read_b64_tr_b16 v[110:111], v188 offset:1472
    v_mfma_f32_16x16x32_bf16 v[144:147], v[152:155], v[48:51], v[144:147]
    v_mfma_f32_16x16x32_bf16 v[140:143], v[44:47], v[52:55], v[140:143]
    v_mfma_f32_16x16x32_bf16 v[148:151], v[152:155], v[52:55], v[148:151]
    s_waitcnt lgkmcnt(0)
    s_barrier
    s_mul_i32 s42, s60, 2560
    v_mfma_f32_16x16x32_bf16 v[132:135], v[72:75], v[72:75], v[132:135]
    v_add_u32 v188, s42, v204
    s_add_u32 s60, s60, 1
    v_mfma_f32_16x16x32_bf16 v[128:131], v[152:155], v[72:75], v[128:131]
    s_cmp_eq_u32 s60, 10
    v_mfma_f32_16x16x32_bf16 v[136:139], v[72:75], v[76:79], v[136:139]
    s_cselect_b32 s60, 0, s60
    ds_read_b128 v[16:19], v184 offset:16384
    v_mfma_f32_16x16x32_bf16 v[144:147], v[152:155], v[76:79], v[144:147]
    ds_read_b64_tr_b16 v[20:21], v188 offset:0
    v_mfma_f32_16x16x32_bf16 v[140:143], v[72:75], v[80:83], v[140:143]
    ds_read_b64_tr_b16 v[22:23], v188 offset:160
    ds_read_b64_tr_b16 v[24:25], v188 offset:32
    v_mfma_f32_16x16x32_bf16 v[148:151], v[152:155], v[80:83], v[148:151]
    ds_read_b64_tr_b16 v[26:27], v188 offset:192
    v_mfma_f32_16x16x32_bf16 v[132:135], v[100:103], v[100:103], v[132:135]
    ds_read_b128 v[44:47], v185 offset:16384
    ds_read_b64_tr_b16 v[48:49], v188 offset:1280
    v_mfma_f32_16x16x32_bf16 v[128:131], v[152:155], v[100:103], v[128:131]
    ds_read_b64_tr_b16 v[50:51], v188 offset:1440
    v_mfma_f32_16x16x32_bf16 v[136:139], v[100:103], v[104:107], v[136:139]
    ds_read_b64_tr_b16 v[52:53], v188 offset:1312
    ds_read_b64_tr_b16 v[54:55], v188 offset:1472
    v_mfma_f32_16x16x32_bf16 v[144:147], v[152:155], v[104:107], v[144:147]
    v_mfma_f32_16x16x32_bf16 v[140:143], v[100:103], v[108:111], v[140:143]
    v_mfma_f32_16x16x32_bf16 v[148:151], v[152:155], v[108:111], v[148:151]
    s_waitcnt lgkmcnt(0)
    s_barrier
    s_mul_i32 s42, s60, 2560
    v_mfma_f32_16x16x32_bf16 v[132:135], v[16:19], v[16:19], v[132:135]
    v_add_u32 v188, s42, v204
    s_add_u32 s60, s60, 1
    v_mfma_f32_16x16x32_bf16 v[128:131], v[152:155], v[16:19], v[128:131]
    s_cmp_eq_u32 s60, 10
    v_mfma_f32_16x16x32_bf16 v[136:139], v[16:19], v[20:23], v[136:139]
    s_cselect_b32 s60, 0, s60
    ds_read_b128 v[72:75], v184 offset:24576
    v_mfma_f32_16x16x32_bf16 v[144:147], v[152:155], v[20:23], v[144:147]
    ds_read_b64_tr_b16 v[76:77], v188 offset:0
    v_mfma_f32_16x16x32_bf16 v[140:143], v[16:19], v[24:27], v[140:143]
    ds_read_b64_tr_b16 v[78:79], v188 offset:160
    ds_read_b64_tr_b16 v[80:81], v188 offset:32
    v_mfma_f32_16x16x32_bf16 v[148:151], v[152:155], v[24:27], v[148:151]
    ds_read_b64_tr_b16 v[82:83], v188 offset:192
    v_mfma_f32_16x16x32_bf16 v[132:135], v[44:47], v[44:47], v[132:135]
    ds_read_b128 v[100:103], v185 offset:24576
    ds_read_b64_tr_b16 v[104:105], v188 offset:1280
    v_mfma_f32_16x16x32_bf16 v[128:131], v[152:155], v[44:47], v[128:131]
    ds_read_b64_tr_b16 v[106:107], v188 offset:1440
    v_mfma_f32_16x16x32_bf16 v[136:139], v[44:47], v[48:51], v[136:139]
    ds_read_b64_tr_b16 v[108:109], v188 offset:1312
    ds_read_b64_tr_b16 v[110:111], v188 offset:1472
    v_mfma_f32_16x16x32_bf16 v[144:147], v[152:155], v[48:51], v[144:147]
    v_mfma_f32_16x16x32_bf16 v[140:143], v[44:47], v[52:55], v[140:143]
    v_mfma_f32_16x16x32_bf16 v[148:151], v[152:155], v[52:55], v[148:151]
    s_waitcnt lgkmcnt(0)
    s_barrier
    s_mul_i32 s42, s60, 2560
    v_mfma_f32_16x16x32_bf16 v[132:135], v[72:75], v[72:75], v[132:135]
    v_add_u32 v188, s42, v204
    s_add_u32 s60, s60, 1
    v_mfma_f32_16x16x32_bf16 v[128:131], v[152:155], v[72:75], v[128:131]
    s_cmp_eq_u32 s60, 10
    v_mfma_f32_16x16x32_bf16 v[136:139], v[72:75], v[76:79], v[136:139]
    s_cselect_b32 s60, 0, s60
    ds_read_b128 v[16:19], v184 offset:32768
    v_mfma_f32_16x16x32_bf16 v[144:147], v[152:155], v[76:79], v[144:147]
    ds_read_b64_tr_b16 v[20:21], v188 offset:0
    v_mfma_f32_16x16x32_bf16 v[140:143], v[72:75], v[80:83], v[140:143]
    ds_read_b64_tr_b16 v[22:23], v188 offset:160
    ds_read_b64_tr_b16 v[24:25], v188 offset:32
    v_mfma_f32_16x16x32_bf16 v[148:151], v[152:155], v[80:83], v[148:151]
    ds_read_b64_tr_b16 v[26:27], v188 offset:192
    v_mfma_f32_16x16x32_bf16 v[132:135], v[100:103], v[100:103], v[132:135]
    ds_read_b128 v[44:47], v185 offset:32768
    ds_read_b64_tr_b16 v[48:49], v188 offset:1280
    v_mfma_f32_16x16x32_bf16 v[128:131], v[152:155], v[100:103], v[128:131]
    ds_read_b64_tr_b16 v[50:51], v188 offset:1440
    v_mfma_f32_16x16x32_bf16 v[136:139], v[100:103], v[104:107], v[136:139]
    ds_read_b64_tr_b16 v[52:53], v188 offset:1312
    ds_read_b64_tr_b16 v[54:55], v188 offset:1472
    v_mfma_f32_16x16x32_bf16 v[144:147], v[152:155], v[104:107], v[144:147]
    v_mfma_f32_16x16x32_bf16 v[140:143], v[100:103], v[108:111], v[140:143]
    v_mfma_f32_16x16x32_bf16 v[148:151], v[152:155], v[108:111], v[148:151]
    s_waitcnt lgkmcnt(0)
    s_barrier
    s_mul_i32 s42, s60, 2560
    v_mfma_f32_16x16x32_bf16 v[132:135], v[16:19], v[16:19], v[132:135]
    v_add_u32 v188, s42, v204
    s_add_u32 s60, s60, 1
    v_mfma_f32_16x16x32_bf16 v[128:131], v[152:155], v[16:19], v[128:131]
    s_cmp_eq_u32 s60, 10
    v_mfma_f32_16x16x32_bf16 v[136:139], v[16:19], v[20:23], v[136:139]
    s_cselect_b32 s60, 0, s60
    ds_read_b128 v[72:75], v202 offset:0
    v_mfma_f32_16x16x32_bf16 v[144:147], v[152:155], v[20:23], v[144:147]
    ds_read_b64_tr_b16 v[76:77], v188 offset:0
    v_mfma_f32_16x16x32_bf16 v[140:143], v[16:19], v[24:27], v[140:143]
    ds_read_b64_tr_b16 v[78:79], v188 offset:160
    ds_read_b64_tr_b16 v[80:81], v188 offset:32
    v_mfma_f32_16x16x32_bf16 v[148:151], v[152:155], v[24:27], v[148:151]
    ds_read_b64_tr_b16 v[82:83], v188 offset:192
    v_mfma_f32_16x16x32_bf16 v[132:135], v[44:47], v[44:47], v[132:135]
    ds_read_b128 v[100:103], v203 offset:0
    ds_read_b64_tr_b16 v[104:105], v188 offset:1280
    v_mfma_f32_16x16x32_bf16 v[128:131], v[152:155], v[44:47], v[128:131]
    ds_read_b64_tr_b16 v[106:107], v188 offset:1440
    v_mfma_f32_16x16x32_bf16 v[136:139], v[44:47], v[48:51], v[136:139]
    ds_read_b64_tr_b16 v[108:109], v188 offset:1312
    ds_read_b64_tr_b16 v[110:111], v188 offset:1472
    v_mfma_f32_16x16x32_bf16 v[144:147], v[152:155], v[48:51], v[144:147]
    v_mfma_f32_16x16x32_bf16 v[140:143], v[44:47], v[52:55], v[140:143]
    v_mfma_f32_16x16x32_bf16 v[148:151], v[152:155], v[52:55], v[148:151]
    s_waitcnt lgkmcnt(0)
    s_barrier
    s_mul_i32 s42, s60, 2560
    v_mfma_f32_16x16x32_bf16 v[132:135], v[72:75], v[72:75], v[132:135]
    v_add_u32 v188, s42, v204
    s_add_u32 s60, s60, 1
    v_mfma_f32_16x16x32_bf16 v[128:131], v[152:155], v[72:75], v[128:131]
    s_cmp_eq_u32 s60, 10
    v_mfma_f32_16x16x32_bf16 v[136:139], v[72:75], v[76:79], v[136:139]
    s_cselect_b32 s60, 0, s60
    ds_read_b128 v[16:19], v202 offset:8192
    v_mfma_f32_16x16x32_bf16 v[144:147], v[152:155], v[76:79], v[144:147]
    ds_read_b64_tr_b16 v[20:21], v188 offset:0
    v_mfma_f32_16x16x32_bf16 v[140:143], v[72:75], v[80:83], v[140:143]
    ds_read_b64_tr_b16 v[22:23], v188 offset:160
    ds_read_b64_tr_b16 v[24:25], v188 offset:32
    v_mfma_f32_16x16x32_bf16 v[148:151], v[152:155], v[80:83], v[148:151]
    ds_read_b64_tr_b16 v[26:27], v188 offset:192
    v_mfma_f32_16x16x32_bf16 v[132:135], v[100:103], v[100:103], v[132:135]
    ds_read_b128 v[44:47], v203 offset:8192
    ds_read_b64_tr_b16 v[48:49], v188 offset:1280
    v_mfma_f32_16x16x32_bf16 v[128:131], v[152:155], v[100:103], v[128:131]
    ds_read_b64_tr_b16 v[50:51], v188 offset:1440
    v_mfma_f32_16x16x32_bf16 v[136:139], v[100:103], v[104:107], v[136:139]
    ds_read_b64_tr_b16 v[52:53], v188 offset:1312
    ds_read_b64_tr_b16 v[54:55], v188 offset:1472
    v_mfma_f32_16x16x32_bf16 v[144:147], v[152:155], v[104:107], v[144:147]
    v_mfma_f32_16x16x32_bf16 v[140:143], v[100:103], v[108:111], v[140:143]
    v_mfma_f32_16x16x32_bf16 v[148:151], v[152:155], v[108:111], v[148:151]
    s_waitcnt lgkmcnt(0)
    s_barrier
    s_mul_i32 s42, s60, 2560
    v_mfma_f32_16x16x32_bf16 v[132:135], v[16:19], v[16:19], v[132:135]
    v_add_u32 v188, s42, v204
    s_add_u32 s60, s60, 1
    v_mfma_f32_16x16x32_bf16 v[128:131], v[152:155], v[16:19], v[128:131]
    s_cmp_eq_u32 s60, 10
    v_mfma_f32_16x16x32_bf16 v[136:139], v[16:19], v[20:23], v[136:139]
    s_cselect_b32 s60, 0, s60
    ds_read_b128 v[72:75], v202 offset:16384
    v_mfma_f32_16x16x32_bf16 v[144:147], v[152:155], v[20:23], v[144:147]
    ds_read_b64_tr_b16 v[76:77], v188 offset:0
    v_mfma_f32_16x16x32_bf16 v[140:143], v[16:19], v[24:27], v[140:143]
    ds_read_b64_tr_b16 v[78:79], v188 offset:160
    ds_read_b64_tr_b16 v[80:81], v188 offset:32
    v_mfma_f32_16x16x32_bf16 v[148:151], v[152:155], v[24:27], v[148:151]
    ds_read_b64_tr_b16 v[82:83], v188 offset:192
    v_mfma_f32_16x16x32_bf16 v[132:135], v[44:47], v[44:47], v[132:135]
    ds_read_b128 v[100:103], v203 offset:16384
    ds_read_b64_tr_b16 v[104:105], v188 offset:1280
    v_mfma_f32_16x16x32_bf16 v[128:131], v[152:155], v[44:47], v[128:131]
    ds_read_b64_tr_b16 v[106:107], v188 offset:1440
    v_mfma_f32_16x16x32_bf16 v[136:139], v[44:47], v[48:51], v[136:139]
    ds_read_b64_tr_b16 v[108:109], v188 offset:1312
    ds_read_b64_tr_b16 v[110:111], v188 offset:1472
    v_mfma_f32_16x16x32_bf16 v[144:147], v[152:155], v[48:51], v[144:147]
    v_mfma_f32_16x16x32_bf16 v[140:143], v[44:47], v[52:55], v[140:143]
    v_mfma_f32_16x16x32_bf16 v[148:151], v[152:155], v[52:55], v[148:151]
    s_waitcnt lgkmcnt(0)
    s_barrier
    s_mul_i32 s42, s60, 2560
    v_mfma_f32_16x16x32_bf16 v[132:135], v[72:75], v[72:75], v[132:135]
    v_add_u32 v188, s42, v204
    s_add_u32 s60, s60, 1
    v_mfma_f32_16x16x32_bf16 v[128:131], v[152:155], v[72:75], v[128:131]
    s_cmp_eq_u32 s60, 10
    v_mfma_f32_16x16x32_bf16 v[136:139], v[72:75], v[76:79], v[136:139]
    s_cselect_b32 s60, 0, s60
    ds_read_b128 v[16:19], v202 offset:24576
    v_mfma_f32_16x16x32_bf16 v[144:147], v[152:155], v[76:79], v[144:147]
    ds_read_b64_tr_b16 v[20:21], v188 offset:0
    v_mfma_f32_16x16x32_bf16 v[140:143], v[72:75], v[80:83], v[140:143]
    ds_read_b64_tr_b16 v[22:23], v188 offset:160
    ds_read_b64_tr_b16 v[24:25], v188 offset:32
    v_mfma_f32_16x16x32_bf16 v[148:151], v[152:155], v[80:83], v[148:151]
    ds_read_b64_tr_b16 v[26:27], v188 offset:192
    v_mfma_f32_16x16x32_bf16 v[132:135], v[100:103], v[100:103], v[132:135]
    ds_read_b128 v[44:47], v203 offset:24576
    ds_read_b64_tr_b16 v[48:49], v188 offset:1280
    v_mfma_f32_16x16x32_bf16 v[128:131], v[152:155], v[100:103], v[128:131]
    ds_read_b64_tr_b16 v[50:51], v188 offset:1440
    v_mfma_f32_16x16x32_bf16 v[136:139], v[100:103], v[104:107], v[136:139]
    ds_read_b64_tr_b16 v[52:53], v188 offset:1312
    ds_read_b64_tr_b16 v[54:55], v188 offset:1472
    v_mfma_f32_16x16x32_bf16 v[144:147], v[152:155], v[104:107], v[144:147]
    v_mfma_f32_16x16x32_bf16 v[140:143], v[100:103], v[108:111], v[140:143]
    v_mfma_f32_16x16x32_bf16 v[148:151], v[152:155], v[108:111], v[148:151]
    s_waitcnt lgkmcnt(0)
    s_barrier
    s_mul_i32 s42, s60, 2560
    v_mfma_f32_16x16x32_bf16 v[132:135], v[16:19], v[16:19], v[132:135]
    v_add_u32 v188, s42, v204
    s_add_u32 s60, s60, 1
    v_mfma_f32_16x16x32_bf16 v[128:131], v[152:155], v[16:19], v[128:131]
    s_cmp_eq_u32 s60, 10
    v_mfma_f32_16x16x32_bf16 v[136:139], v[16:19], v[20:23], v[136:139]
    s_cselect_b32 s60, 0, s60
    ds_read_b128 v[72:75], v202 offset:32768
    v_mfma_f32_16x16x32_bf16 v[144:147], v[152:155], v[20:23], v[144:147]
    ds_read_b64_tr_b16 v[76:77], v188 offset:0
    v_mfma_f32_16x16x32_bf16 v[140:143], v[16:19], v[24:27], v[140:143]
    ds_read_b64_tr_b16 v[78:79], v188 offset:160
    ds_read_b64_tr_b16 v[80:81], v188 offset:32
    v_mfma_f32_16x16x32_bf16 v[148:151], v[152:155], v[24:27], v[148:151]
    ds_read_b64_tr_b16 v[82:83], v188 offset:192
    v_mfma_f32_16x16x32_bf16 v[132:135], v[44:47], v[44:47], v[132:135]
    ds_read_b128 v[100:103], v203 offset:32768
    ds_read_b64_tr_b16 v[104:105], v188 offset:1280
    v_mfma_f32_16x16x32_bf16 v[128:131], v[152:155], v[44:47], v[128:131]
    ds_read_b64_tr_b16 v[106:107], v188 offset:1440
    v_mfma_f32_16x16x32_bf16 v[136:139], v[44:47], v[48:51], v[136:139]
    ds_read_b64_tr_b16 v[108:109], v188 offset:1312
    ds_read_b64_tr_b16 v[110:111], v188 offset:1472
    v_mfma_f32_16x16x32_bf16 v[144:147], v[152:155], v[48:51], v[144:147]
    v_mfma_f32_16x16x32_bf16 v[140:143], v[44:47], v[52:55], v[140:143]
    v_mfma_f32_16x16x32_bf16 v[148:151], v[152:155], v[52:55], v[148:151]
    s_waitcnt lgkmcnt(0)
    s_barrier
    ds_read_b128 v[16:19], v184 offset:0
    ds_read_b64_tr_b16 v[20:21], v186 offset:0
    v_mfma_f32_16x16x32_bf16 v[132:135], v[72:75], v[72:75], v[132:135]
    ds_read_b64_tr_b16 v[22:23], v186 offset:2560
    ds_read_b64_tr_b16 v[24:25], v186 offset:32
    ds_read_b64_tr_b16 v[26:27], v186 offset:2592
    v_mfma_f32_16x16x32_bf16 v[128:131], v[152:155], v[72:75], v[128:131]
    ds_read_b64_tr_b16 v[28:29], v186 offset:64
    ds_read_b64_tr_b16 v[30:31], v186 offset:2624
    v_mfma_f32_16x16x32_bf16 v[136:139], v[72:75], v[76:79], v[136:139]
    ds_read_b64_tr_b16 v[32:33], v186 offset:96
    ds_read_b64_tr_b16 v[34:35], v186 offset:2656
    ds_read_b64_tr_b16 v[36:37], v186 offset:128
    v_mfma_f32_16x16x32_bf16 v[144:147], v[152:155], v[76:79], v[144:147]
    ds_read_b64_tr_b16 v[38:39], v186 offset:2688
    ds_read_b64_tr_b16 v[40:41], v187 offset:0
    ds_read_b64_tr_b16 v[42:43], v187 offset:2560
    v_mfma_f32_16x16x32_bf16 v[140:143], v[72:75], v[80:83], v[140:143]
    ds_read_b128 v[44:47], v185 offset:0
    ds_read_b64_tr_b16 v[48:49], v186 offset:5120
    v_mfma_f32_16x16x32_bf16 v[148:151], v[152:155], v[80:83], v[148:151]
    ds_read_b64_tr_b16 v[50:51], v186 offset:7680
    ds_read_b64_tr_b16 v[52:53], v186 offset:5152
    ds_read_b64_tr_b16 v[54:55], v186 offset:7712
    v_mfma_f32_16x16x32_bf16 v[132:135], v[100:103], v[100:103], v[132:135]
    ds_read_b64_tr_b16 v[56:57], v186 offset:5184
    ds_read_b64_tr_b16 v[58:59], v186 offset:7744
    v_mfma_f32_16x16x32_bf16 v[128:131], v[152:155], v[100:103], v[128:131]
    ds_read_b64_tr_b16 v[60:61], v186 offset:5216
    ds_read_b64_tr_b16 v[62:63], v186 offset:7776
    ds_read_b64_tr_b16 v[64:65], v186 offset:5248
    v_mfma_f32_16x16x32_bf16 v[136:139], v[100:103], v[104:107], v[136:139]
    ds_read_b64_tr_b16 v[66:67], v186 offset:7808
    ds_read_b64_tr_b16 v[68:69], v187 offset:5120
    ds_read_b64_tr_b16 v[70:71], v187 offset:7680
    v_mfma_f32_16x16x32_bf16 v[144:147], v[152:155], v[104:107], v[144:147]
    v_mfma_f32_16x16x32_bf16 v[140:143], v[100:103], v[108:111], v[140:143]
    v_mfma_f32_16x16x32_bf16 v[148:151], v[152:155], v[108:111], v[148:151]
    s_nop 7
    v_cndmask_b32 v5, v132, v133, s[52:53]
    v_cndmask_b32 v5, v5, v134, s[54:55]
    v_cndmask_b32 v5, v5, v135, s[56:57]
    ds_bpermute_b32 v7, v12, v5
    v_mul_f32 v200, 0x3acccccd, v128
    s_waitcnt lgkmcnt(0)
    s_barrier
    v_mul_f32 v7, 0x3acccccd, v7
    v_fma_f32 v7, -v200, v200, v7
    v_max_f32 v7, 0, v7
    v_add_f32 v7, 0x3727c5ac, v7
    v_rsq_f32 v201, v7
    s_nop 0
    ds_write_b64 v199, v[200:201]
    s_waitcnt lgkmcnt(0)
    ds_read_b128 v[206:209], v198
    ds_read_b128 v[210:213], v198 offset:16
    s_waitcnt lgkmcnt(0)
    v_fma_f32 v136, -v206, v144, v136
    v_fma_f32 v137, -v208, v145, v137
    v_fma_f32 v138, -v210, v146, v138
    v_fma_f32 v139, -v212, v147, v139
    v_mul_f32 v136, v207, v136
    v_mul_f32 v137, v209, v137
    v_mul_f32 v138, v211, v138
    v_mul_f32 v139, v213, v139
    v_cvt_pk_bf16_f32 v144, v136, v137
    v_cvt_pk_bf16_f32 v145, v138, v139
    buffer_store_dwordx2 v[144:145], v196, s[16:19], s46 offen sc1
    v_fma_f32 v140, -v206, v148, v140
    v_fma_f32 v141, -v208, v149, v141
    v_fma_f32 v142, -v210, v150, v142
    v_fma_f32 v143, -v212, v151, v143
    v_mul_f32 v140, v207, v140
    v_mul_f32 v141, v209, v141
    v_mul_f32 v142, v211, v142
    v_mul_f32 v143, v213, v143
    v_cvt_pk_bf16_f32 v148, v140, v141
    v_cvt_pk_bf16_f32 v149, v142, v143
    buffer_store_dwordx2 v[148:149], v197, s[16:19], s46 offen sc1
    ds_read_b128 v[72:75], v184 offset:8192
    ds_read_b64_tr_b16 v[76:77], v186 offset:10240
    v_mfma_f32_16x16x32_bf16 v[156:159], v[20:23], v[16:19], 0
    ds_read_b64_tr_b16 v[78:79], v186 offset:12800
    ds_read_b64_tr_b16 v[80:81], v186 offset:10272
    v_mfma_f32_16x16x32_bf16 v[160:163], v[24:27], v[16:19], 0
    ds_read_b64_tr_b16 v[82:83], v186 offset:12832
    ds_read_b64_tr_b16 v[84:85], v186 offset:10304
    v_mfma_f32_16x16x32_bf16 v[164:167], v[28:31], v[16:19], 0
    ds_read_b64_tr_b16 v[86:87], v186 offset:12864
    ds_read_b64_tr_b16 v[88:89], v186 offset:10336
    v_mfma_f32_16x16x32_bf16 v[168:171], v[32:35], v[16:19], 0
    ds_read_b64_tr_b16 v[90:91], v186 offset:12896
    ds_read_b64_tr_b16 v[92:93], v186 offset:10368
    v_mfma_f32_16x16x32_bf16 v[172:175], v[36:39], v[16:19], 0
    ds_read_b64_tr_b16 v[94:95], v186 offset:12928
    ds_read_b64_tr_b16 v[96:97], v187 offset:10240
    ds_read_b64_tr_b16 v[98:99], v187 offset:12800
    v_mfma_f32_16x16x32_bf16 v[180:183], v[36:39], v[152:155], 0
    ds_read_b128 v[100:103], v185 offset:8192
    ds_read_b64_tr_b16 v[104:105], v186 offset:15360
    v_mfma_f32_16x16x32_bf16 v[176:179], v[40:43], v[152:155], 0
    ds_read_b64_tr_b16 v[106:107], v186 offset:17920
    ds_read_b64_tr_b16 v[108:109], v186 offset:15392
    v_mfma_f32_16x16x32_bf16 v[156:159], v[48:51], v[44:47], v[156:159]
    ds_read_b64_tr_b16 v[110:111], v186 offset:17952
    ds_read_b64_tr_b16 v[112:113], v186 offset:15424
    v_mfma_f32_16x16x32_bf16 v[160:163], v[52:55], v[44:47], v[160:163]
    ds_read_b64_tr_b16 v[114:115], v186 offset:17984
    ds_read_b64_tr_b16 v[116:117], v186 offset:15456
    v_mfma_f32_16x16x32_bf16 v[164:167], v[56:59], v[44:47], v[164:167]
    ds_read_b64_tr_b16 v[118:119], v186 offset:18016
    ds_read_b64_tr_b16 v[120:121], v186 offset:15488
    v_mfma_f32_16x16x32_bf16 v[168:171], v[60:63], v[44:47], v[168:171]
    ds_read_b64_tr_b16 v[122:123], v186 offset:18048
    ds_read_b64_tr_b16 v[124:125], v187 offset:15360
    ds_read_b64_tr_b16 v[126:127], v187 offset:17920
    v_mfma_f32_16x16x32_bf16 v[172:175], v[64:67], v[44:47], v[172:175]
    v_mfma_f32_16x16x32_bf16 v[180:183], v[64:67], v[152:155], v[180:183]
    v_mfma_f32_16x16x32_bf16 v[176:179], v[68:71], v[152:155], v[176:179]
    s_waitcnt lgkmcnt(0)
    s_barrier
    ds_read_b128 v[16:19], v184 offset:16384
    ds_read_b64_tr_b16 v[20:21], v186 offset:20480
    v_mfma_f32_16x16x32_bf16 v[156:159], v[76:79], v[72:75], v[156:159]
    ds_read_b64_tr_b16 v[22:23], v186 offset:23040
    ds_read_b64_tr_b16 v[24:25], v186 offset:20512
    v_mfma_f32_16x16x32_bf16 v[160:163], v[80:83], v[72:75], v[160:163]
    ds_read_b64_tr_b16 v[26:27], v186 offset:23072
    ds_read_b64_tr_b16 v[28:29], v186 offset:20544
    v_mfma_f32_16x16x32_bf16 v[164:167], v[84:87], v[72:75], v[164:167]
    ds_read_b64_tr_b16 v[30:31], v186 offset:23104
    ds_read_b64_tr_b16 v[32:33], v186 offset:20576
    v_mfma_f32_16x16x32_bf16 v[168:171], v[88:91], v[72:75], v[168:171]
    ds_read_b64_tr_b16 v[34:35], v186 offset:23136
    ds_read_b64_tr_b16 v[36:37], v186 offset:20608
    v_mfma_f32_16x16x32_bf16 v[172:175], v[92:95], v[72:75], v[172:175]
    ds_read_b64_tr_b16 v[38:39], v186 offset:23168
    ds_read_b64_tr_b16 v[40:41], v187 offset:20480
    ds_read_b64_tr_b16 v[42:43], v187 offset:23040
    v_mfma_f32_16x16x32_bf16 v[180:183], v[92:95], v[152:155], v[180:183]
    ds_read_b128 v[44:47], v185 offset:16384
    ds_read_b64_tr_b16 v[48:49], v186 offset:25600
    v_mfma_f32_16x16x32_bf16 v[176:179], v[96:99], v[152:155], v[176:179]
    ds_read_b64_tr_b16 v[50:51], v186 offset:28160
    ds_read_b64_tr_b16 v[52:53], v186 offset:25632
    v_mfma_f32_16x16x32_bf16 v[156:159], v[104:107], v[100:103], v[156:159]
    ds_read_b64_tr_b16 v[54:55], v186 offset:28192
    ds_read_b64_tr_b16 v[56:57], v186 offset:25664
    v_mfma_f32_16x16x32_bf16 v[160:163], v[108:111], v[100:103], v[160:163]
    ds_read_b64_tr_b16 v[58:59], v186 offset:28224
    ds_read_b64_tr_b16 v[60:61], v186 offset:25696
    v_mfma_f32_16x16x32_bf16 v[164:167], v[112:115], v[100:103], v[164:167]
    ds_read_b64_tr_b16 v[62:63], v186 offset:28256
    ds_read_b64_tr_b16 v[64:65], v186 offset:25728
    v_mfma_f32_16x16x32_bf16 v[168:171], v[116:119], v[100:103], v[168:171]
    ds_read_b64_tr_b16 v[66:67], v186 offset:28288
    ds_read_b64_tr_b16 v[68:69], v187 offset:25600
    ds_read_b64_tr_b16 v[70:71], v187 offset:28160
    v_mfma_f32_16x16x32_bf16 v[172:175], v[120:123], v[100:103], v[172:175]
    v_mfma_f32_16x16x32_bf16 v[180:183], v[120:123], v[152:155], v[180:183]
    v_mfma_f32_16x16x32_bf16 v[176:179], v[124:127], v[152:155], v[176:179]
    s_waitcnt lgkmcnt(0)
    s_branch sequential_preLN__grouped_kv_mqa__dense_activation_silu__prompt_kernel_pB
sequential_preLN__grouped_kv_mqa__dense_activation_silu__prompt_kernel_pB:
    s_barrier
    ds_read_b128 v[72:75], v184 offset:24576
    ds_read_b64_tr_b16 v[76:77], v186 offset:30720
    v_mfma_f32_16x16x32_bf16 v[156:159], v[20:23], v[16:19], v[156:159]
    ds_read_b64_tr_b16 v[78:79], v186 offset:33280
    ds_read_b64_tr_b16 v[80:81], v186 offset:30752
    v_mfma_f32_16x16x32_bf16 v[160:163], v[24:27], v[16:19], v[160:163]
    ds_read_b64_tr_b16 v[82:83], v186 offset:33312
    ds_read_b64_tr_b16 v[84:85], v186 offset:30784
    v_mfma_f32_16x16x32_bf16 v[164:167], v[28:31], v[16:19], v[164:167]
    ds_read_b64_tr_b16 v[86:87], v186 offset:33344
    ds_read_b64_tr_b16 v[88:89], v186 offset:30816
    v_mfma_f32_16x16x32_bf16 v[168:171], v[32:35], v[16:19], v[168:171]
    ds_read_b64_tr_b16 v[90:91], v186 offset:33376
    ds_read_b64_tr_b16 v[92:93], v186 offset:30848
    v_mfma_f32_16x16x32_bf16 v[172:175], v[36:39], v[16:19], v[172:175]
    ds_read_b64_tr_b16 v[94:95], v186 offset:33408
    ds_read_b64_tr_b16 v[96:97], v187 offset:30720
    ds_read_b64_tr_b16 v[98:99], v187 offset:33280
    v_mfma_f32_16x16x32_bf16 v[180:183], v[36:39], v[152:155], v[180:183]
    ds_read_b128 v[100:103], v185 offset:24576
    ds_read_b64_tr_b16 v[104:105], v186 offset:35840
    v_mfma_f32_16x16x32_bf16 v[176:179], v[40:43], v[152:155], v[176:179]
    ds_read_b64_tr_b16 v[106:107], v186 offset:38400
    ds_read_b64_tr_b16 v[108:109], v186 offset:35872
    v_mfma_f32_16x16x32_bf16 v[156:159], v[48:51], v[44:47], v[156:159]
    ds_read_b64_tr_b16 v[110:111], v186 offset:38432
    ds_read_b64_tr_b16 v[112:113], v186 offset:35904
    v_mfma_f32_16x16x32_bf16 v[160:163], v[52:55], v[44:47], v[160:163]
    ds_read_b64_tr_b16 v[114:115], v186 offset:38464
    ds_read_b64_tr_b16 v[116:117], v186 offset:35936
    v_mfma_f32_16x16x32_bf16 v[164:167], v[56:59], v[44:47], v[164:167]
    ds_read_b64_tr_b16 v[118:119], v186 offset:38496
    ds_read_b64_tr_b16 v[120:121], v186 offset:35968
    v_mfma_f32_16x16x32_bf16 v[168:171], v[60:63], v[44:47], v[168:171]
    ds_read_b64_tr_b16 v[122:123], v186 offset:38528
    ds_read_b64_tr_b16 v[124:125], v187 offset:35840
    ds_read_b64_tr_b16 v[126:127], v187 offset:38400
    v_mfma_f32_16x16x32_bf16 v[172:175], v[64:67], v[44:47], v[172:175]
    v_mfma_f32_16x16x32_bf16 v[180:183], v[64:67], v[152:155], v[180:183]
    v_mfma_f32_16x16x32_bf16 v[176:179], v[68:71], v[152:155], v[176:179]
    s_waitcnt vmcnt(0)
    s_waitcnt lgkmcnt(0)
    s_barrier
    ds_read_b128 v[16:19], v184 offset:32768
    ds_read_b64_tr_b16 v[20:21], v186 offset:0
    v_mfma_f32_16x16x32_bf16 v[156:159], v[76:79], v[72:75], v[156:159]
    ds_read_b64_tr_b16 v[22:23], v186 offset:2560
    ds_read_b64_tr_b16 v[24:25], v186 offset:32
    v_mfma_f32_16x16x32_bf16 v[160:163], v[80:83], v[72:75], v[160:163]
    ds_read_b64_tr_b16 v[26:27], v186 offset:2592
    ds_read_b64_tr_b16 v[28:29], v186 offset:64
    v_mfma_f32_16x16x32_bf16 v[164:167], v[84:87], v[72:75], v[164:167]
    ds_read_b64_tr_b16 v[30:31], v186 offset:2624
    ds_read_b64_tr_b16 v[32:33], v186 offset:96
    v_mfma_f32_16x16x32_bf16 v[168:171], v[88:91], v[72:75], v[168:171]
    ds_read_b64_tr_b16 v[34:35], v186 offset:2656
    ds_read_b64_tr_b16 v[36:37], v186 offset:128
    v_mfma_f32_16x16x32_bf16 v[172:175], v[92:95], v[72:75], v[172:175]
    ds_read_b64_tr_b16 v[38:39], v186 offset:2688
    ds_read_b64_tr_b16 v[40:41], v187 offset:0
    ds_read_b64_tr_b16 v[42:43], v187 offset:2560
    v_mfma_f32_16x16x32_bf16 v[180:183], v[92:95], v[152:155], v[180:183]
    ds_read_b128 v[44:47], v185 offset:32768
    ds_read_b64_tr_b16 v[48:49], v186 offset:5120
    v_mfma_f32_16x16x32_bf16 v[176:179], v[96:99], v[152:155], v[176:179]
    ds_read_b64_tr_b16 v[50:51], v186 offset:7680
    ds_read_b64_tr_b16 v[52:53], v186 offset:5152
    v_mfma_f32_16x16x32_bf16 v[156:159], v[104:107], v[100:103], v[156:159]
    ds_read_b64_tr_b16 v[54:55], v186 offset:7712
    ds_read_b64_tr_b16 v[56:57], v186 offset:5184
    v_mfma_f32_16x16x32_bf16 v[160:163], v[108:111], v[100:103], v[160:163]
    ds_read_b64_tr_b16 v[58:59], v186 offset:7744
    ds_read_b64_tr_b16 v[60:61], v186 offset:5216
    v_mfma_f32_16x16x32_bf16 v[164:167], v[112:115], v[100:103], v[164:167]
    ds_read_b64_tr_b16 v[62:63], v186 offset:7776
    ds_read_b64_tr_b16 v[64:65], v186 offset:5248
    v_mfma_f32_16x16x32_bf16 v[168:171], v[116:119], v[100:103], v[168:171]
    ds_read_b64_tr_b16 v[66:67], v186 offset:7808
    ds_read_b64_tr_b16 v[68:69], v187 offset:5120
    ds_read_b64_tr_b16 v[70:71], v187 offset:7680
    v_mfma_f32_16x16x32_bf16 v[172:175], v[120:123], v[100:103], v[172:175]
    v_mfma_f32_16x16x32_bf16 v[180:183], v[120:123], v[152:155], v[180:183]
    v_mfma_f32_16x16x32_bf16 v[176:179], v[124:127], v[152:155], v[176:179]
    s_waitcnt lgkmcnt(0)
    s_barrier
    ds_read_b128 v[72:75], v202 offset:0
    ds_read_b64_tr_b16 v[76:77], v186 offset:10240
    v_mfma_f32_16x16x32_bf16 v[156:159], v[20:23], v[16:19], v[156:159]
    ds_read_b64_tr_b16 v[78:79], v186 offset:12800
    ds_read_b64_tr_b16 v[80:81], v186 offset:10272
    v_mfma_f32_16x16x32_bf16 v[160:163], v[24:27], v[16:19], v[160:163]
    ds_read_b64_tr_b16 v[82:83], v186 offset:12832
    ds_read_b64_tr_b16 v[84:85], v186 offset:10304
    v_mfma_f32_16x16x32_bf16 v[164:167], v[28:31], v[16:19], v[164:167]
    ds_read_b64_tr_b16 v[86:87], v186 offset:12864
    ds_read_b64_tr_b16 v[88:89], v186 offset:10336
    v_mfma_f32_16x16x32_bf16 v[168:171], v[32:35], v[16:19], v[168:171]
    ds_read_b64_tr_b16 v[90:91], v186 offset:12896
    ds_read_b64_tr_b16 v[92:93], v186 offset:10368
    v_mfma_f32_16x16x32_bf16 v[172:175], v[36:39], v[16:19], v[172:175]
    ds_read_b64_tr_b16 v[94:95], v186 offset:12928
    ds_read_b64_tr_b16 v[96:97], v187 offset:10240
    ds_read_b64_tr_b16 v[98:99], v187 offset:12800
    v_mfma_f32_16x16x32_bf16 v[180:183], v[36:39], v[152:155], v[180:183]
    ds_read_b128 v[100:103], v203 offset:0
    ds_read_b64_tr_b16 v[104:105], v186 offset:15360
    v_mfma_f32_16x16x32_bf16 v[176:179], v[40:43], v[152:155], v[176:179]
    ds_read_b64_tr_b16 v[106:107], v186 offset:17920
    ds_read_b64_tr_b16 v[108:109], v186 offset:15392
    v_mfma_f32_16x16x32_bf16 v[156:159], v[48:51], v[44:47], v[156:159]
    ds_read_b64_tr_b16 v[110:111], v186 offset:17952
    ds_read_b64_tr_b16 v[112:113], v186 offset:15424
    v_mfma_f32_16x16x32_bf16 v[160:163], v[52:55], v[44:47], v[160:163]
    ds_read_b64_tr_b16 v[114:115], v186 offset:17984
    ds_read_b64_tr_b16 v[116:117], v186 offset:15456
    v_mfma_f32_16x16x32_bf16 v[164:167], v[56:59], v[44:47], v[164:167]
    ds_read_b64_tr_b16 v[118:119], v186 offset:18016
    ds_read_b64_tr_b16 v[120:121], v186 offset:15488
    v_mfma_f32_16x16x32_bf16 v[168:171], v[60:63], v[44:47], v[168:171]
    ds_read_b64_tr_b16 v[122:123], v186 offset:18048
    ds_read_b64_tr_b16 v[124:125], v187 offset:15360
    ds_read_b64_tr_b16 v[126:127], v187 offset:17920
    v_mfma_f32_16x16x32_bf16 v[172:175], v[64:67], v[44:47], v[172:175]
    v_mfma_f32_16x16x32_bf16 v[180:183], v[64:67], v[152:155], v[180:183]
    v_mfma_f32_16x16x32_bf16 v[176:179], v[68:71], v[152:155], v[176:179]
    s_waitcnt lgkmcnt(0)
    s_barrier
    ds_read_b128 v[16:19], v202 offset:8192
    ds_read_b64_tr_b16 v[20:21], v186 offset:20480
    v_mfma_f32_16x16x32_bf16 v[156:159], v[76:79], v[72:75], v[156:159]
    ds_read_b64_tr_b16 v[22:23], v186 offset:23040
    ds_read_b64_tr_b16 v[24:25], v186 offset:20512
    v_mfma_f32_16x16x32_bf16 v[160:163], v[80:83], v[72:75], v[160:163]
    ds_read_b64_tr_b16 v[26:27], v186 offset:23072
    ds_read_b64_tr_b16 v[28:29], v186 offset:20544
    v_mfma_f32_16x16x32_bf16 v[164:167], v[84:87], v[72:75], v[164:167]
    ds_read_b64_tr_b16 v[30:31], v186 offset:23104
    ds_read_b64_tr_b16 v[32:33], v186 offset:20576
    v_mfma_f32_16x16x32_bf16 v[168:171], v[88:91], v[72:75], v[168:171]
    ds_read_b64_tr_b16 v[34:35], v186 offset:23136
    ds_read_b64_tr_b16 v[36:37], v186 offset:20608
    v_mfma_f32_16x16x32_bf16 v[172:175], v[92:95], v[72:75], v[172:175]
    ds_read_b64_tr_b16 v[38:39], v186 offset:23168
    ds_read_b64_tr_b16 v[40:41], v187 offset:20480
    ds_read_b64_tr_b16 v[42:43], v187 offset:23040
    v_mfma_f32_16x16x32_bf16 v[180:183], v[92:95], v[152:155], v[180:183]
    ds_read_b128 v[44:47], v203 offset:8192
    ds_read_b64_tr_b16 v[48:49], v186 offset:25600
    v_mfma_f32_16x16x32_bf16 v[176:179], v[96:99], v[152:155], v[176:179]
    ds_read_b64_tr_b16 v[50:51], v186 offset:28160
    ds_read_b64_tr_b16 v[52:53], v186 offset:25632
    v_mfma_f32_16x16x32_bf16 v[156:159], v[104:107], v[100:103], v[156:159]
    ds_read_b64_tr_b16 v[54:55], v186 offset:28192
    ds_read_b64_tr_b16 v[56:57], v186 offset:25664
    v_mfma_f32_16x16x32_bf16 v[160:163], v[108:111], v[100:103], v[160:163]
    ds_read_b64_tr_b16 v[58:59], v186 offset:28224
    ds_read_b64_tr_b16 v[60:61], v186 offset:25696
    v_mfma_f32_16x16x32_bf16 v[164:167], v[112:115], v[100:103], v[164:167]
    ds_read_b64_tr_b16 v[62:63], v186 offset:28256
    ds_read_b64_tr_b16 v[64:65], v186 offset:25728
    v_mfma_f32_16x16x32_bf16 v[168:171], v[116:119], v[100:103], v[168:171]
    ds_read_b64_tr_b16 v[66:67], v186 offset:28288
    ds_read_b64_tr_b16 v[68:69], v187 offset:25600
    ds_read_b64_tr_b16 v[70:71], v187 offset:28160
    v_mfma_f32_16x16x32_bf16 v[172:175], v[120:123], v[100:103], v[172:175]
    v_mfma_f32_16x16x32_bf16 v[180:183], v[120:123], v[152:155], v[180:183]
    v_mfma_f32_16x16x32_bf16 v[176:179], v[124:127], v[152:155], v[176:179]
    s_waitcnt lgkmcnt(0)
    s_barrier
    ds_read_b128 v[72:75], v202 offset:16384
    ds_read_b64_tr_b16 v[76:77], v186 offset:30720
    v_mfma_f32_16x16x32_bf16 v[156:159], v[20:23], v[16:19], v[156:159]
    ds_read_b64_tr_b16 v[78:79], v186 offset:33280
    ds_read_b64_tr_b16 v[80:81], v186 offset:30752
    v_mfma_f32_16x16x32_bf16 v[160:163], v[24:27], v[16:19], v[160:163]
    ds_read_b64_tr_b16 v[82:83], v186 offset:33312
    ds_read_b64_tr_b16 v[84:85], v186 offset:30784
    v_mfma_f32_16x16x32_bf16 v[164:167], v[28:31], v[16:19], v[164:167]
    ds_read_b64_tr_b16 v[86:87], v186 offset:33344
    ds_read_b64_tr_b16 v[88:89], v186 offset:30816
    v_mfma_f32_16x16x32_bf16 v[168:171], v[32:35], v[16:19], v[168:171]
    ds_read_b64_tr_b16 v[90:91], v186 offset:33376
    ds_read_b64_tr_b16 v[92:93], v186 offset:30848
    v_mfma_f32_16x16x32_bf16 v[172:175], v[36:39], v[16:19], v[172:175]
    ds_read_b64_tr_b16 v[94:95], v186 offset:33408
    ds_read_b64_tr_b16 v[96:97], v187 offset:30720
    ds_read_b64_tr_b16 v[98:99], v187 offset:33280
    v_mfma_f32_16x16x32_bf16 v[180:183], v[36:39], v[152:155], v[180:183]
    ds_read_b128 v[100:103], v203 offset:16384
    ds_read_b64_tr_b16 v[104:105], v186 offset:35840
    v_mfma_f32_16x16x32_bf16 v[176:179], v[40:43], v[152:155], v[176:179]
    ds_read_b64_tr_b16 v[106:107], v186 offset:38400
    ds_read_b64_tr_b16 v[108:109], v186 offset:35872
    v_mfma_f32_16x16x32_bf16 v[156:159], v[48:51], v[44:47], v[156:159]
    ds_read_b64_tr_b16 v[110:111], v186 offset:38432
    ds_read_b64_tr_b16 v[112:113], v186 offset:35904
    v_mfma_f32_16x16x32_bf16 v[160:163], v[52:55], v[44:47], v[160:163]
    ds_read_b64_tr_b16 v[114:115], v186 offset:38464
    ds_read_b64_tr_b16 v[116:117], v186 offset:35936
    v_mfma_f32_16x16x32_bf16 v[164:167], v[56:59], v[44:47], v[164:167]
    ds_read_b64_tr_b16 v[118:119], v186 offset:38496
    ds_read_b64_tr_b16 v[120:121], v186 offset:35968
    v_mfma_f32_16x16x32_bf16 v[168:171], v[60:63], v[44:47], v[168:171]
    ds_read_b64_tr_b16 v[122:123], v186 offset:38528
    ds_read_b64_tr_b16 v[124:125], v187 offset:35840
    ds_read_b64_tr_b16 v[126:127], v187 offset:38400
    v_mfma_f32_16x16x32_bf16 v[172:175], v[64:67], v[44:47], v[172:175]
    v_mfma_f32_16x16x32_bf16 v[180:183], v[64:67], v[152:155], v[180:183]
    v_mfma_f32_16x16x32_bf16 v[176:179], v[68:71], v[152:155], v[176:179]
    s_waitcnt lgkmcnt(0)
    s_barrier
    ds_read_b128 v[16:19], v202 offset:24576
    ds_read_b64_tr_b16 v[20:21], v186 offset:0
    v_mfma_f32_16x16x32_bf16 v[156:159], v[76:79], v[72:75], v[156:159]
    ds_read_b64_tr_b16 v[22:23], v186 offset:2560
    ds_read_b64_tr_b16 v[24:25], v186 offset:32
    v_mfma_f32_16x16x32_bf16 v[160:163], v[80:83], v[72:75], v[160:163]
    ds_read_b64_tr_b16 v[26:27], v186 offset:2592
    ds_read_b64_tr_b16 v[28:29], v186 offset:64
    v_mfma_f32_16x16x32_bf16 v[164:167], v[84:87], v[72:75], v[164:167]
    ds_read_b64_tr_b16 v[30:31], v186 offset:2624
    ds_read_b64_tr_b16 v[32:33], v186 offset:96
    v_mfma_f32_16x16x32_bf16 v[168:171], v[88:91], v[72:75], v[168:171]
    ds_read_b64_tr_b16 v[34:35], v186 offset:2656
    ds_read_b64_tr_b16 v[36:37], v186 offset:128
    v_mfma_f32_16x16x32_bf16 v[172:175], v[92:95], v[72:75], v[172:175]
    ds_read_b64_tr_b16 v[38:39], v186 offset:2688
    ds_read_b64_tr_b16 v[40:41], v187 offset:0
    ds_read_b64_tr_b16 v[42:43], v187 offset:2560
    v_mfma_f32_16x16x32_bf16 v[180:183], v[92:95], v[152:155], v[180:183]
    ds_read_b128 v[44:47], v203 offset:24576
    ds_read_b64_tr_b16 v[48:49], v186 offset:5120
    v_mfma_f32_16x16x32_bf16 v[176:179], v[96:99], v[152:155], v[176:179]
    ds_read_b64_tr_b16 v[50:51], v186 offset:7680
    ds_read_b64_tr_b16 v[52:53], v186 offset:5152
    v_mfma_f32_16x16x32_bf16 v[156:159], v[104:107], v[100:103], v[156:159]
    ds_read_b64_tr_b16 v[54:55], v186 offset:7712
    ds_read_b64_tr_b16 v[56:57], v186 offset:5184
    v_mfma_f32_16x16x32_bf16 v[160:163], v[108:111], v[100:103], v[160:163]
    ds_read_b64_tr_b16 v[58:59], v186 offset:7744
    ds_read_b64_tr_b16 v[60:61], v186 offset:5216
    v_mfma_f32_16x16x32_bf16 v[164:167], v[112:115], v[100:103], v[164:167]
    ds_read_b64_tr_b16 v[62:63], v186 offset:7776
    ds_read_b64_tr_b16 v[64:65], v186 offset:5248
    v_mfma_f32_16x16x32_bf16 v[168:171], v[116:119], v[100:103], v[168:171]
    ds_read_b64_tr_b16 v[66:67], v186 offset:7808
    ds_read_b64_tr_b16 v[68:69], v187 offset:5120
    ds_read_b64_tr_b16 v[70:71], v187 offset:7680
    v_mfma_f32_16x16x32_bf16 v[172:175], v[120:123], v[100:103], v[172:175]
    v_mfma_f32_16x16x32_bf16 v[180:183], v[120:123], v[152:155], v[180:183]
    v_mfma_f32_16x16x32_bf16 v[176:179], v[124:127], v[152:155], v[176:179]
    s_waitcnt lgkmcnt(0)
    s_barrier
    ds_read_b128 v[72:75], v202 offset:32768
    ds_read_b64_tr_b16 v[76:77], v186 offset:10240
    v_mfma_f32_16x16x32_bf16 v[156:159], v[20:23], v[16:19], v[156:159]
    ds_read_b64_tr_b16 v[78:79], v186 offset:12800
    ds_read_b64_tr_b16 v[80:81], v186 offset:10272
    v_mfma_f32_16x16x32_bf16 v[160:163], v[24:27], v[16:19], v[160:163]
    ds_read_b64_tr_b16 v[82:83], v186 offset:12832
    ds_read_b64_tr_b16 v[84:85], v186 offset:10304
    v_mfma_f32_16x16x32_bf16 v[164:167], v[28:31], v[16:19], v[164:167]
    ds_read_b64_tr_b16 v[86:87], v186 offset:12864
    ds_read_b64_tr_b16 v[88:89], v186 offset:10336
    v_mfma_f32_16x16x32_bf16 v[168:171], v[32:35], v[16:19], v[168:171]
    ds_read_b64_tr_b16 v[90:91], v186 offset:12896
    ds_read_b64_tr_b16 v[92:93], v186 offset:10368
    v_mfma_f32_16x16x32_bf16 v[172:175], v[36:39], v[16:19], v[172:175]
    ds_read_b64_tr_b16 v[94:95], v186 offset:12928
    ds_read_b64_tr_b16 v[96:97], v187 offset:10240
    ds_read_b64_tr_b16 v[98:99], v187 offset:12800
    v_mfma_f32_16x16x32_bf16 v[180:183], v[36:39], v[152:155], v[180:183]
    ds_read_b128 v[100:103], v203 offset:32768
    ds_read_b64_tr_b16 v[104:105], v186 offset:15360
    v_mfma_f32_16x16x32_bf16 v[176:179], v[40:43], v[152:155], v[176:179]
    ds_read_b64_tr_b16 v[106:107], v186 offset:17920
    ds_read_b64_tr_b16 v[108:109], v186 offset:15392
    v_mfma_f32_16x16x32_bf16 v[156:159], v[48:51], v[44:47], v[156:159]
    ds_read_b64_tr_b16 v[110:111], v186 offset:17952
    ds_read_b64_tr_b16 v[112:113], v186 offset:15424
    v_mfma_f32_16x16x32_bf16 v[160:163], v[52:55], v[44:47], v[160:163]
    ds_read_b64_tr_b16 v[114:115], v186 offset:17984
    ds_read_b64_tr_b16 v[116:117], v186 offset:15456
    v_mfma_f32_16x16x32_bf16 v[164:167], v[56:59], v[44:47], v[164:167]
    ds_read_b64_tr_b16 v[118:119], v186 offset:18016
    ds_read_b64_tr_b16 v[120:121], v186 offset:15488
    v_mfma_f32_16x16x32_bf16 v[168:171], v[60:63], v[44:47], v[168:171]
    ds_read_b64_tr_b16 v[122:123], v186 offset:18048
    ds_read_b64_tr_b16 v[124:125], v187 offset:15360
    ds_read_b64_tr_b16 v[126:127], v187 offset:17920
    v_mfma_f32_16x16x32_bf16 v[172:175], v[64:67], v[44:47], v[172:175]
    v_mfma_f32_16x16x32_bf16 v[180:183], v[64:67], v[152:155], v[180:183]
    v_mfma_f32_16x16x32_bf16 v[176:179], v[68:71], v[152:155], v[176:179]
    s_waitcnt lgkmcnt(0)
    v_mfma_f32_16x16x32_bf16 v[156:159], v[76:79], v[72:75], v[156:159]
    v_mfma_f32_16x16x32_bf16 v[160:163], v[80:83], v[72:75], v[160:163]
    v_mfma_f32_16x16x32_bf16 v[164:167], v[84:87], v[72:75], v[164:167]
    v_mfma_f32_16x16x32_bf16 v[168:171], v[88:91], v[72:75], v[168:171]
    v_mfma_f32_16x16x32_bf16 v[172:175], v[92:95], v[72:75], v[172:175]
    v_mfma_f32_16x16x32_bf16 v[180:183], v[92:95], v[152:155], v[180:183]
    v_mfma_f32_16x16x32_bf16 v[176:179], v[96:99], v[152:155], v[176:179]
    v_mfma_f32_16x16x32_bf16 v[156:159], v[104:107], v[100:103], v[156:159]
    v_mfma_f32_16x16x32_bf16 v[160:163], v[108:111], v[100:103], v[160:163]
    v_mfma_f32_16x16x32_bf16 v[164:167], v[112:115], v[100:103], v[164:167]
    v_mfma_f32_16x16x32_bf16 v[168:171], v[116:119], v[100:103], v[168:171]
    v_mfma_f32_16x16x32_bf16 v[172:175], v[120:123], v[100:103], v[172:175]
    v_mfma_f32_16x16x32_bf16 v[180:183], v[120:123], v[152:155], v[180:183]
    v_mfma_f32_16x16x32_bf16 v[176:179], v[124:127], v[152:155], v[176:179]
    s_waitcnt lgkmcnt(0)
    s_nop 7
    s_lshl_b32 s42, s36, 6
    v_add_u32 v4, s42, v189
    s_mov_b32 exec_lo, 0x00010001
    s_mov_b32 exec_hi, 0x00010001
    ds_write_b128 v4, v[176:179]
    s_mov_b64 exec, -1
    v_mul_f32 v9, 0x3ea52b5c, v201
    s_waitcnt lgkmcnt(0)

    s_barrier
    ds_read_b128 v[16:19], v189 offset:0
    ds_read_b128 v[20:23], v189 offset:64
    ds_read_b128 v[24:27], v189 offset:128
    ds_read_b128 v[28:31], v189 offset:192
    v_fma_f32 v172, -v200, v180, v172
    v_fma_f32 v173, -v200, v181, v173
    v_fma_f32 v174, -v200, v182, v174
    v_fma_f32 v175, -v200, v183, v175
    v_mul_f32 v172, v9, v172
    v_mul_f32 v173, v9, v173
    v_mul_f32 v174, v9, v174
    v_mul_f32 v175, v9, v175
    v_cvt_pk_bf16_f32 v172, v172, v173
    v_cvt_pk_bf16_f32 v173, v174, v175
    ds_write_b64 v194, v[172:173]
    s_waitcnt lgkmcnt(0)
    v_fma_f32 v156, -v200, v16, v156
    v_fma_f32 v157, -v200, v17, v157
    v_fma_f32 v158, -v200, v18, v158
    v_fma_f32 v159, -v200, v19, v159
    v_mul_f32 v156, v9, v156
    v_mul_f32 v157, v9, v157
    v_mul_f32 v158, v9, v158
    v_mul_f32 v159, v9, v159
    v_cvt_pk_bf16_f32 v156, v156, v157
    v_cvt_pk_bf16_f32 v157, v158, v159
    ds_write_b64 v190, v[156:157]
    v_fma_f32 v160, -v200, v20, v160
    v_fma_f32 v161, -v200, v21, v161
    v_fma_f32 v162, -v200, v22, v162
    v_fma_f32 v163, -v200, v23, v163
    v_mul_f32 v160, v9, v160
    v_mul_f32 v161, v9, v161
    v_mul_f32 v162, v9, v162
    v_mul_f32 v163, v9, v163
    v_cvt_pk_bf16_f32 v160, v160, v161
    v_cvt_pk_bf16_f32 v161, v162, v163
    ds_write_b64 v191, v[160:161]
    v_fma_f32 v164, -v200, v24, v164
    v_fma_f32 v165, -v200, v25, v165
    v_fma_f32 v166, -v200, v26, v166
    v_fma_f32 v167, -v200, v27, v167
    v_mul_f32 v164, v9, v164
    v_mul_f32 v165, v9, v165
    v_mul_f32 v166, v9, v166
    v_mul_f32 v167, v9, v167
    v_cvt_pk_bf16_f32 v164, v164, v165
    v_cvt_pk_bf16_f32 v165, v166, v167
    ds_write_b64 v192, v[164:165]
    v_fma_f32 v168, -v200, v28, v168
    v_fma_f32 v169, -v200, v29, v169
    v_fma_f32 v170, -v200, v30, v170
    v_fma_f32 v171, -v200, v31, v171
    v_mul_f32 v168, v9, v168
    v_mul_f32 v169, v9, v169
    v_mul_f32 v170, v9, v170
    v_mul_f32 v171, v9, v171
    v_cvt_pk_bf16_f32 v168, v168, v169
    v_cvt_pk_bf16_f32 v169, v170, v171
    ds_write_b64 v193, v[168:169]
    s_waitcnt lgkmcnt(0)
sequential_preLN__grouped_kv_mqa__dense_activation_silu__prompt_kernel_qrd:
    s_barrier
    s_mov_b32 s16, s12
    s_and_b32 s17, s13, 0xffff
    s_mov_b32 s18, 0x1900000
    s_mov_b32 s19, 0x00020000
    s_add_u32 s20, s12, 0x280000
    s_addc_u32 s21, s13, 0
    s_and_b32 s21, s21, 0xffff
    s_mov_b32 s22, 0x28000
    s_mov_b32 s23, 0x00020000
    v_and_b32 v2, 31, v1
    v_lshrrev_b32 v3, 5, v1
    v_lshlrev_b32 v112, 4, v1
    s_lshl_b32 s41, s36, 10
    s_mul_i32 s40, s36, 1280
    s_add_u32 s40, s40, 153600
    v_add_u32 v4, s40, v112
    v_lshl_add_u32 v5, v2, 3, s40
    v_mov_b32 v12, 0
    v_mov_b32 v13, 0
    v_mov_b32 v14, 0
    v_mov_b32 v15, 0
    ds_read_b128 v[8:11], v4
    s_mov_b32 exec_hi, 0
    ds_read_b64 v[12:13], v5 offset:1024
    s_mov_b32 exec_hi, -1
    s_mov_b32 exec_lo, 0
    ds_read_b64 v[14:15], v5 offset:1024
    s_mov_b32 exec_lo, -1

    s_add_u32 s42, s41, 0
    s_mov_b32 m0, s42
    s_nop 0
    buffer_load_dwordx4 v112, s[20:23], s42 offen sc1 lds
    s_add_u32 s42, s41, 8192
    s_mov_b32 m0, s42
    s_nop 0
    buffer_load_dwordx4 v112, s[20:23], s42 offen sc1 lds
    s_add_u32 s42, s41, 16384
    s_mov_b32 m0, s42
    s_nop 0
    buffer_load_dwordx4 v112, s[20:23], s42 offen sc1 lds
    s_add_u32 s42, s41, 24576
    s_mov_b32 m0, s42
    s_nop 0
    buffer_load_dwordx4 v112, s[20:23], s42 offen sc1 lds
    v_cmp_eq_u32 vcc, 24, v2
    s_mov_b64 s[56:57], vcc
    v_cmp_eq_u32 vcc, 28, v2
    s_or_b64 vcc, vcc, s[56:57]
    v_mov_b32 v5, 0x3f803f80
    s_mov_b32 s60, 0x000fffff
    s_mov_b32 s61, 0x000fffff
    s_nop 0
    v_cndmask_b32 v4, 0, v5, vcc

    v_mov_b32 v38, v4
    v_mov_b32 v39, v4
    v_mov_b32 v40, v4
    v_mov_b32 v41, v4
    v_mov_b32 v42, v4
    v_mov_b32 v43, v4
    v_mov_b32 v44, v4
    v_mov_b32 v45, v4
    v_mov_b32 v46, v4
    v_mov_b32 v47, v4
    v_mov_b32 v48, v4
    v_mov_b32 v49, v4
    v_mov_b32 v50, v4
    v_mov_b32 v51, v4
    v_mov_b32 v52, v4
    v_mov_b32 v53, v4
    s_mul_i32 s47, s36, 5120
    s_add_u32 s47, s47, 122880
    s_lshl_b32 s52, s36, 8
    s_add_u32 s52, s52, s2
    s_cmp_lt_u32 s52, 432
    s_cbranch_scc0 sequential_preLN__grouped_kv_mqa__dense_activation_silu__prompt_kernel_sl1
    s_mov_b32 s28, s10
    s_and_b32 s29, s11, 0xffff
    s_lshr_b32 s53, s52, 3
    s_and_b32 s54, s52, 7
    s_mul_i32 s55, s53, 40960
    s_mul_i32 s42, s54, 160
    s_add_u32 s55, s55, s42
    s_mul_i32 s56, s54, 276480
    s_lshl_b32 s42, s53, 10
    s_add_u32 s56, s56, s42
    s_add_u32 s56, s56, 23068672
    s_mov_b32 s57, 55296
    s_mov_b32 s58, 5
    s_mov_b32 s59, 160
    s_mov_b32 s66, 6554
    s_mov_b32 s67, 10
    s_mov_b32 s68, 1280
    s_mov_b32 s69, 0x7fff0000
    s_mov_b64 s[62:63], 0
    s_branch sequential_preLN__grouped_kv_mqa__dense_activation_silu__prompt_kernel_sl2

sequential_preLN__grouped_kv_mqa__dense_activation_silu__prompt_kernel_sl1:
    s_mov_b32 s28, s8
    s_and_b32 s29, s9, 0xffff
    s_sub_u32 s52, s52, 432
    s_mul_hi_u32 s53, s52, 119304648
    s_mul_i32 s54, s53, 36
    s_sub_u32 s54, s52, s54
    s_mul_i32 s55, s53, 110592
    s_mul_i32 s42, s54, 96
    s_add_u32 s55, s55, s42
    s_mul_i32 s56, s54, 61440
    s_lshl_b32 s42, s53, 10
    s_add_u32 s56, s56, s42
    s_add_u32 s56, s56, 19922944
    s_mov_b32 s57, 20480
    s_mul_i32 s69, s53, 6912
    s_mul_i32 s42, s54, 192
    s_add_u32 s69, s69, s42
    s_add_u32 s69, s69, 9961472
    s_cmp_lt_u32 s52, 720
    s_cbranch_scc0 sequential_preLN__grouped_kv_mqa__dense_activation_silu__prompt_kernel_sl3
    s_cselect_b32 s58, 3, 0
    s_cselect_b32 s69, s69, 0x7fff0000
    s_mov_b32 s59, 96
    s_mov_b32 s66, 10923
    s_mov_b32 s67, 6
    s_mov_b32 s68, 3456
    s_mov_b64 s[62:63], -1
    s_branch sequential_preLN__grouped_kv_mqa__dense_activation_silu__prompt_kernel_sl2

sequential_preLN__grouped_kv_mqa__dense_activation_silu__prompt_kernel_sl3:
    s_mov_b32 s28, s74
    s_and_b32 s29, s75, 0xffff
    s_sub_u32 s52, s52, 720
    s_lshr_b32 s53, s52, 3
    s_and_b32 s54, s52, 7
    s_mul_i32 s55, s54, 160
    s_mul_i32 s56, s54, 20
    s_add_u32 s56, s56, s53
    s_mul_i32 s56, s56, 5120
    s_add_u32 s56, s56, 18874368
    s_movk_i32 s57, 1024
    s_cmp_lt_u32 s52, 160
    s_cselect_b32 s58, 5, 0
    s_mov_b32 s59, 160
    s_mov_b32 s69, 0x7fff0000
    s_mov_b32 s30, 819200
    s_mov_b32 s31, 0x00020000
    s_cmp_ge_u32 s53, 10
    s_cselect_b32 s42, 40, 0
    s_cselect_b32 s43, 10, 0
    s_sub_u32 s53, s53, s43
    s_lshl_b32 s53, s53, 5

    v_add_u32 v4, 0, v1
    v_mul_u32_u24 v5, 6554, v4
    v_lshrrev_b32 v5, 16, v5
    v_mul_u32_u24 v7, 10, v5
    v_sub_u32 v6, v4, v7

    v_add_u32 v5, s53, v5
    v_mul_u32_u24 v7, 1639, v5
    v_lshrrev_b32 v7, 16, v7
    v_mul_u32_u24 v115, 40, v7
    v_sub_u32 v114, v5, v115

    v_mul_u32_u24 v7, 80, v7
    v_add3_u32 v7, v7, v114, s42
    v_mul_u32_u24 v7, 1280, v7
    v_lshl_add_u32 v142, v6, 4, v7

    v_add_u32 v4, 64, v1
    v_mul_u32_u24 v5, 6554, v4
    v_lshrrev_b32 v5, 16, v5
    v_mul_u32_u24 v7, 10, v5
    v_sub_u32 v6, v4, v7

    v_add_u32 v5, s53, v5
    v_mul_u32_u24 v7, 1639, v5
    v_lshrrev_b32 v7, 16, v7
    v_mul_u32_u24 v115, 40, v7
    v_sub_u32 v114, v5, v115

    v_mul_u32_u24 v7, 80, v7
    v_add3_u32 v7, v7, v114, s42
    v_mul_u32_u24 v7, 1280, v7
    v_lshl_add_u32 v143, v6, 4, v7

    v_add_u32 v4, 128, v1
    v_mul_u32_u24 v5, 6554, v4
    v_lshrrev_b32 v5, 16, v5
    v_mul_u32_u24 v7, 10, v5
    v_sub_u32 v6, v4, v7

    v_add_u32 v5, s53, v5
    v_mul_u32_u24 v7, 1639, v5
    v_lshrrev_b32 v7, 16, v7
    v_mul_u32_u24 v115, 40, v7
    v_sub_u32 v114, v5, v115

    v_mul_u32_u24 v7, 80, v7
    v_add3_u32 v7, v7, v114, s42
    v_mul_u32_u24 v7, 1280, v7
    v_lshl_add_u32 v144, v6, 4, v7

    v_add_u32 v4, 192, v1
    v_mul_u32_u24 v5, 6554, v4
    v_lshrrev_b32 v5, 16, v5
    v_mul_u32_u24 v7, 10, v5
    v_sub_u32 v6, v4, v7

    v_add_u32 v5, s53, v5
    v_mul_u32_u24 v7, 1639, v5
    v_lshrrev_b32 v7, 16, v7
    v_mul_u32_u24 v115, 40, v7
    v_sub_u32 v114, v5, v115

    v_mul_u32_u24 v7, 80, v7
    v_add3_u32 v7, v7, v114, s42
    v_mul_u32_u24 v7, 1280, v7
    v_lshl_add_u32 v145, v6, 4, v7

    v_add_u32 v4, 256, v1
    v_mul_u32_u24 v5, 6554, v4
    v_lshrrev_b32 v5, 16, v5
    v_mul_u32_u24 v7, 10, v5
    v_sub_u32 v6, v4, v7

    v_add_u32 v5, s53, v5
    v_mul_u32_u24 v7, 1639, v5
    v_lshrrev_b32 v7, 16, v7
    v_mul_u32_u24 v115, 40, v7
    v_sub_u32 v114, v5, v115

    v_mul_u32_u24 v7, 80, v7
    v_add3_u32 v7, v7, v114, s42
    v_mul_u32_u24 v7, 1280, v7
    v_lshl_add_u32 v146, v6, 4, v7

    s_branch sequential_preLN__grouped_kv_mqa__dense_activation_silu__prompt_kernel_sl4
sequential_preLN__grouped_kv_mqa__dense_activation_silu__prompt_kernel_sl2:
    s_mov_b32 s30, 2211840
    s_mov_b32 s31, 0x00020000

    v_add_u32 v4, 0, v1
    v_mul_lo_u32 v5, v4, s66
    v_lshrrev_b32 v5, 16, v5
    v_mul_lo_u32 v6, v5, s67
    v_sub_u32 v6, v4, v6
    v_bfe_u32 v7, v5, 2, 2
    v_lshlrev_b32 v7, 3, v7
    v_bfe_u32 v4, v5, 4, 1
    v_lshl_add_u32 v7, v4, 2, v7
    v_and_b32 v4, 3, v5
    v_add_u32 v7, v7, v4
    v_cndmask_b32 v5, v5, v7, s[62:63]
    v_mul_lo_u32 v5, v5, s68
    v_lshl_add_u32 v142, v6, 4, v5

    v_add_u32 v4, 64, v1
    v_mul_lo_u32 v5, v4, s66
    v_lshrrev_b32 v5, 16, v5
    v_mul_lo_u32 v6, v5, s67
    v_sub_u32 v6, v4, v6
    v_bfe_u32 v7, v5, 2, 2
    v_lshlrev_b32 v7, 3, v7
    v_bfe_u32 v4, v5, 4, 1
    v_lshl_add_u32 v7, v4, 2, v7
    v_and_b32 v4, 3, v5
    v_add_u32 v7, v7, v4
    v_cndmask_b32 v5, v5, v7, s[62:63]
    v_mul_lo_u32 v5, v5, s68
    v_lshl_add_u32 v143, v6, 4, v5

    v_add_u32 v4, 128, v1
    v_mul_lo_u32 v5, v4, s66
    v_lshrrev_b32 v5, 16, v5
    v_mul_lo_u32 v6, v5, s67
    v_sub_u32 v6, v4, v6
    v_bfe_u32 v7, v5, 2, 2
    v_lshlrev_b32 v7, 3, v7
    v_bfe_u32 v4, v5, 4, 1
    v_lshl_add_u32 v7, v4, 2, v7
    v_and_b32 v4, 3, v5
    v_add_u32 v7, v7, v4
    v_cndmask_b32 v5, v5, v7, s[62:63]
    v_mul_lo_u32 v5, v5, s68
    v_lshl_add_u32 v144, v6, 4, v5

    v_add_u32 v4, 192, v1
    v_mul_lo_u32 v5, v4, s66
    v_lshrrev_b32 v5, 16, v5
    v_mul_lo_u32 v6, v5, s67
    v_sub_u32 v6, v4, v6
    v_bfe_u32 v7, v5, 2, 2
    v_lshlrev_b32 v7, 3, v7
    v_bfe_u32 v4, v5, 4, 1
    v_lshl_add_u32 v7, v4, 2, v7
    v_and_b32 v4, 3, v5
    v_add_u32 v7, v7, v4
    v_cndmask_b32 v5, v5, v7, s[62:63]
    v_mul_lo_u32 v5, v5, s68
    v_lshl_add_u32 v145, v6, 4, v5

    v_add_u32 v4, 256, v1
    v_mul_lo_u32 v5, v4, s66
    v_lshrrev_b32 v5, 16, v5
    v_mul_lo_u32 v6, v5, s67
    v_sub_u32 v6, v4, v6
    v_bfe_u32 v7, v5, 2, 2
    v_lshlrev_b32 v7, 3, v7
    v_bfe_u32 v4, v5, 4, 1
    v_lshl_add_u32 v7, v4, 2, v7
    v_and_b32 v4, 3, v5
    v_add_u32 v7, v7, v4
    v_cndmask_b32 v5, v5, v7, s[62:63]
    v_mul_lo_u32 v5, v5, s68
    v_lshl_add_u32 v146, v6, 4, v5

sequential_preLN__grouped_kv_mqa__dense_activation_silu__prompt_kernel_sl4:
    v_mov_b32 v110, v112
    v_mul_u32_u24 v111, 20, v3
    v_add_u32 v111, v111, v2
    v_lshlrev_b32 v111, 4, v111
    v_add_u32 v111, 10240, v111

    v_mov_b32 v94, 0
    v_mov_b32 v95, 0
    v_mov_b32 v96, 0
    v_mov_b32 v97, 0
    v_mov_b32 v98, 0
    v_mov_b32 v99, 0
    v_mov_b32 v100, 0
    v_mov_b32 v101, 0
    v_mov_b32 v102, 0
    v_mov_b32 v103, 0
    v_mov_b32 v104, 0
    v_mov_b32 v105, 0
    v_mov_b32 v106, 0
    v_mov_b32 v107, 0
    v_mov_b32 v108, 0
    v_mov_b32 v109, 0
    v_mov_b32 v90, 0
    v_mov_b32 v91, 0
    v_mov_b32 v92, 0
    v_mov_b32 v93, 0
    s_cmp_lt_u32 s36, 4
    s_cbranch_scc1 sequential_preLN__grouped_kv_mqa__dense_activation_silu__prompt_kernel_p0
    s_setprio 1

sequential_preLN__grouped_kv_mqa__dense_activation_silu__prompt_kernel_p0:
    s_waitcnt vmcnt(0) lgkmcnt(0)
    s_barrier
    ds_read_b128 v[22:25], v110 offset:0
    ds_read_b128 v[30:33], v110 offset:8192
    ds_read_b128 v[26:29], v110 offset:1024
    s_mov_b64 exec, s[60:61]
    ds_read_b128 v[38:41], v111 offset:0
    ds_read_b128 v[46:49], v111 offset:640
    s_mov_b64 exec, -1
    s_waitcnt lgkmcnt(0)
    v_mfma_f32_32x32x16_bf16 v[54:69], v[22:25], v[8:11], 0
    s_nop 7
    s_nop 3
    v_mfma_f32_32x32x8_bf16 v[54:69], v[30:31], v[12:13], v[54:69]
    s_nop 7
    s_nop 3
    s_waitcnt lgkmcnt(0)
    v_mfma_f32_32x32x16_bf16 v[70:85], v[26:29], v[8:11], 0
    s_add_u32 s42, s41, 32768
    s_mov_b32 m0, s42
    s_nop 0
    buffer_load_dwordx4 v112, s[20:23], s42 offen sc1 lds
    v_exp_f32 v54, v54
    v_exp_f32 v55, v55
    v_exp_f32 v56, v56
    v_exp_f32 v57, v57
    v_exp_f32 v58, v58
    v_exp_f32 v59, v59
    v_mfma_f32_32x32x16_bf16 v[94:109], v[50:53], v[90:93], v[94:109]
    ds_read_b128 v[22:25], v110 offset:2048
    s_mov_b64 exec, s[60:61]
    ds_read_b128 v[42:45], v111 offset:1280
    ds_read_b128 v[50:53], v111 offset:1920
    s_mov_b64 exec, -1
    v_exp_f32 v60, v60
    v_exp_f32 v61, v61
    v_cvt_pk_bf16_f32 v86, v54, v55
    v_cvt_pk_bf16_f32 v87, v56, v57
    v_cvt_pk_bf16_f32 v88, v58, v59
    v_cvt_pk_bf16_f32 v89, v60, v61
    v_mfma_f32_32x32x8_bf16 v[70:85], v[32:33], v[12:13], v[70:85]
    s_add_u32 s42, s41, 40960
    s_mov_b32 m0, s42
    s_nop 0
    buffer_load_dwordx4 v112, s[20:23], s42 offen sc1 lds
    v_exp_f32 v62, v62
    v_exp_f32 v63, v63
    v_exp_f32 v64, v64
    v_exp_f32 v65, v65
    v_exp_f32 v66, v66
    v_exp_f32 v67, v67
    v_mfma_f32_32x32x16_bf16 v[94:109], v[38:41], v[86:89], v[94:109]
    v_exp_f32 v68, v68
    v_exp_f32 v69, v69
    v_cvt_pk_bf16_f32 v90, v62, v63
    v_cvt_pk_bf16_f32 v91, v64, v65
    v_cvt_pk_bf16_f32 v92, v66, v67
    v_cvt_pk_bf16_f32 v93, v68, v69
    s_waitcnt lgkmcnt(0)
    v_mfma_f32_32x32x16_bf16 v[54:69], v[22:25], v[8:11], 0
    s_add_u32 s42, s41, 49152
    s_mov_b32 m0, s42
    s_nop 0
    buffer_load_dwordx4 v112, s[20:23], s42 offen sc1 lds
    v_exp_f32 v70, v70
    v_exp_f32 v71, v71
    v_exp_f32 v72, v72
    v_exp_f32 v73, v73
    v_exp_f32 v74, v74
    v_exp_f32 v75, v75
    v_mfma_f32_32x32x16_bf16 v[94:109], v[46:49], v[90:93], v[94:109]
    ds_read_b128 v[26:29], v110 offset:3072
    s_mov_b64 exec, s[60:61]
    ds_read_b128 v[38:41], v111 offset:2560
    ds_read_b128 v[46:49], v111 offset:3200
    s_mov_b64 exec, -1
    v_exp_f32 v76, v76
    v_exp_f32 v77, v77
    v_cvt_pk_bf16_f32 v86, v70, v71
    v_cvt_pk_bf16_f32 v87, v72, v73
    v_cvt_pk_bf16_f32 v88, v74, v75
    v_cvt_pk_bf16_f32 v89, v76, v77
    v_mfma_f32_32x32x8_bf16 v[54:69], v[30:31], v[14:15], v[54:69]
    s_add_u32 s42, s41, 57344
    s_mov_b32 m0, s42
    s_nop 0
    buffer_load_dwordx4 v112, s[20:23], s42 offen sc1 lds
    v_exp_f32 v78, v78
    v_exp_f32 v79, v79
    v_exp_f32 v80, v80
    v_exp_f32 v81, v81
    v_exp_f32 v82, v82
    v_exp_f32 v83, v83
    v_mfma_f32_32x32x16_bf16 v[94:109], v[42:45], v[86:89], v[94:109]
    v_exp_f32 v84, v84
    v_exp_f32 v85, v85
    v_cvt_pk_bf16_f32 v90, v78, v79
    v_cvt_pk_bf16_f32 v91, v80, v81
    v_cvt_pk_bf16_f32 v92, v82, v83
    v_cvt_pk_bf16_f32 v93, v84, v85
    s_waitcnt lgkmcnt(0)
    v_mfma_f32_32x32x16_bf16 v[70:85], v[26:29], v[8:11], 0
    s_add_u32 s42, s41, 65536
    s_mov_b32 m0, s42
    s_nop 0
    buffer_load_dwordx4 v112, s[20:23], s42 offen sc1 lds
    v_exp_f32 v54, v54
    v_exp_f32 v55, v55
    v_exp_f32 v56, v56
    v_exp_f32 v57, v57
    v_exp_f32 v58, v58
    v_exp_f32 v59, v59
    v_mfma_f32_32x32x16_bf16 v[94:109], v[50:53], v[90:93], v[94:109]
    ds_read_b128 v[22:25], v110 offset:4096
    ds_read_b128 v[34:37], v110 offset:9216
    s_mov_b64 exec, s[60:61]
    ds_read_b128 v[42:45], v111 offset:3840
    ds_read_b128 v[50:53], v111 offset:4480
    s_mov_b64 exec, -1
    v_exp_f32 v60, v60
    v_exp_f32 v61, v61
    v_cvt_pk_bf16_f32 v86, v54, v55
    v_cvt_pk_bf16_f32 v87, v56, v57
    v_cvt_pk_bf16_f32 v88, v58, v59
    v_cvt_pk_bf16_f32 v89, v60, v61
    v_mfma_f32_32x32x8_bf16 v[70:85], v[32:33], v[14:15], v[70:85]
    s_add_u32 s42, s41, 73728
    s_mov_b32 m0, s42
    s_nop 0
    buffer_load_dwordx4 v112, s[20:23], s42 offen sc1 lds
    v_exp_f32 v62, v62
    v_exp_f32 v63, v63
    v_exp_f32 v64, v64
    v_exp_f32 v65, v65
    v_exp_f32 v66, v66
    v_exp_f32 v67, v67
    v_mfma_f32_32x32x16_bf16 v[94:109], v[38:41], v[86:89], v[94:109]
    v_exp_f32 v68, v68
    v_exp_f32 v69, v69
    v_cvt_pk_bf16_f32 v90, v62, v63
    v_cvt_pk_bf16_f32 v91, v64, v65
    v_cvt_pk_bf16_f32 v92, v66, v67
    v_cvt_pk_bf16_f32 v93, v68, v69
    s_waitcnt lgkmcnt(0)
    v_mfma_f32_32x32x16_bf16 v[54:69], v[22:25], v[8:11], 0
    s_add_u32 s42, s41, 81920
    s_mov_b32 m0, s42
    s_nop 0
    buffer_load_dwordx4 v112, s[20:23], s42 offen sc1 lds
    v_exp_f32 v70, v70
    v_exp_f32 v71, v71
    v_exp_f32 v72, v72
    v_exp_f32 v73, v73
    v_exp_f32 v74, v74
    v_exp_f32 v75, v75
    v_mfma_f32_32x32x16_bf16 v[94:109], v[46:49], v[90:93], v[94:109]
    ds_read_b128 v[26:29], v110 offset:5120
    s_mov_b64 exec, s[60:61]
    ds_read_b128 v[38:41], v111 offset:5120
    ds_read_b128 v[46:49], v111 offset:5760
    s_mov_b64 exec, -1
    v_exp_f32 v76, v76
    v_exp_f32 v77, v77
    v_cvt_pk_bf16_f32 v86, v70, v71
    v_cvt_pk_bf16_f32 v87, v72, v73
    v_cvt_pk_bf16_f32 v88, v74, v75
    v_cvt_pk_bf16_f32 v89, v76, v77
    v_mfma_f32_32x32x8_bf16 v[54:69], v[34:35], v[12:13], v[54:69]
    s_add_u32 s42, s41, 90112
    s_mov_b32 m0, s42
    s_nop 0
    buffer_load_dwordx4 v112, s[20:23], s42 offen sc1 lds
    v_exp_f32 v78, v78
    v_exp_f32 v79, v79
    v_exp_f32 v80, v80
    v_exp_f32 v81, v81
    v_exp_f32 v82, v82
    v_exp_f32 v83, v83
    v_mfma_f32_32x32x16_bf16 v[94:109], v[42:45], v[86:89], v[94:109]
    v_exp_f32 v84, v84
    v_exp_f32 v85, v85
    v_cvt_pk_bf16_f32 v90, v78, v79
    v_cvt_pk_bf16_f32 v91, v80, v81
    v_cvt_pk_bf16_f32 v92, v82, v83
    v_cvt_pk_bf16_f32 v93, v84, v85
    s_waitcnt lgkmcnt(0)
    v_mfma_f32_32x32x16_bf16 v[70:85], v[26:29], v[8:11], 0
    s_add_u32 s42, s41, 98304
    s_mov_b32 m0, s42
    s_nop 0
    buffer_load_dwordx4 v112, s[20:23], s42 offen sc1 lds
    v_exp_f32 v54, v54
    v_exp_f32 v55, v55
    v_exp_f32 v56, v56
    v_exp_f32 v57, v57
    v_exp_f32 v58, v58
    v_exp_f32 v59, v59
    v_mfma_f32_32x32x16_bf16 v[94:109], v[50:53], v[90:93], v[94:109]
    ds_read_b128 v[22:25], v110 offset:6144
    s_mov_b64 exec, s[60:61]
    ds_read_b128 v[42:45], v111 offset:6400
    ds_read_b128 v[50:53], v111 offset:7040
    s_mov_b64 exec, -1
    v_exp_f32 v60, v60
    v_exp_f32 v61, v61
    v_cvt_pk_bf16_f32 v86, v54, v55
    v_cvt_pk_bf16_f32 v87, v56, v57
    v_cvt_pk_bf16_f32 v88, v58, v59
    v_cvt_pk_bf16_f32 v89, v60, v61
    v_mfma_f32_32x32x8_bf16 v[70:85], v[36:37], v[12:13], v[70:85]
    s_add_u32 s42, s41, 106496
    s_mov_b32 m0, s42
    s_nop 0
    buffer_load_dwordx4 v112, s[20:23], s42 offen sc1 lds
    v_exp_f32 v62, v62
    v_exp_f32 v63, v63
    v_exp_f32 v64, v64
    v_exp_f32 v65, v65
    v_exp_f32 v66, v66
    v_exp_f32 v67, v67
    v_mfma_f32_32x32x16_bf16 v[94:109], v[38:41], v[86:89], v[94:109]
    v_exp_f32 v68, v68
    v_exp_f32 v69, v69
    v_cvt_pk_bf16_f32 v90, v62, v63
    v_cvt_pk_bf16_f32 v91, v64, v65
    v_cvt_pk_bf16_f32 v92, v66, v67
    v_cvt_pk_bf16_f32 v93, v68, v69
    s_waitcnt lgkmcnt(0)
    v_mfma_f32_32x32x16_bf16 v[54:69], v[22:25], v[8:11], 0
    s_add_u32 s42, s41, 114688
    s_mov_b32 m0, s42
    s_nop 0
    buffer_load_dwordx4 v112, s[20:23], s42 offen sc1 lds
    v_exp_f32 v70, v70
    v_exp_f32 v71, v71
    v_exp_f32 v72, v72
    v_exp_f32 v73, v73
    v_exp_f32 v74, v74
    v_exp_f32 v75, v75
    v_mfma_f32_32x32x16_bf16 v[94:109], v[46:49], v[90:93], v[94:109]
    ds_read_b128 v[26:29], v110 offset:7168
    s_mov_b64 exec, s[60:61]
    ds_read_b128 v[38:41], v111 offset:7680
    ds_read_b128 v[46:49], v111 offset:8320
    s_mov_b64 exec, -1
    v_exp_f32 v76, v76
    v_exp_f32 v77, v77
    v_cvt_pk_bf16_f32 v86, v70, v71
    v_cvt_pk_bf16_f32 v87, v72, v73
    v_cvt_pk_bf16_f32 v88, v74, v75
    v_cvt_pk_bf16_f32 v89, v76, v77
    v_mfma_f32_32x32x8_bf16 v[54:69], v[34:35], v[14:15], v[54:69]
    s_cmp_gt_u32 s58, 0
    s_cselect_b32 s43, s55, 0x7fff0000
    s_add_u32 s42, s47, 0
    s_mov_b32 m0, s42
    s_nop 0
    buffer_load_dwordx4 v142, s[28:31], s43 offen lds
    v_exp_f32 v78, v78
    v_exp_f32 v79, v79
    v_exp_f32 v80, v80
    v_exp_f32 v81, v81
    v_exp_f32 v82, v82
    v_exp_f32 v83, v83
    v_mfma_f32_32x32x16_bf16 v[94:109], v[42:45], v[86:89], v[94:109]
    v_exp_f32 v84, v84
    v_exp_f32 v85, v85
    v_cvt_pk_bf16_f32 v90, v78, v79
    v_cvt_pk_bf16_f32 v91, v80, v81
    v_cvt_pk_bf16_f32 v92, v82, v83
    v_cvt_pk_bf16_f32 v93, v84, v85
    s_waitcnt lgkmcnt(0)
    v_mfma_f32_32x32x16_bf16 v[70:85], v[26:29], v[8:11], 0
    s_cmp_gt_u32 s58, 1
    s_cselect_b32 s43, s55, 0x7fff0000
    s_add_u32 s42, s47, 1024
    s_mov_b32 m0, s42
    s_nop 0
    buffer_load_dwordx4 v143, s[28:31], s43 offen lds
    v_exp_f32 v54, v54
    v_exp_f32 v55, v55
    v_exp_f32 v56, v56
    v_exp_f32 v57, v57
    v_exp_f32 v58, v58
    v_exp_f32 v59, v59
    v_mfma_f32_32x32x16_bf16 v[94:109], v[50:53], v[90:93], v[94:109]
    ds_read_b128 v[22:25], v110 offset:20480
    ds_read_b128 v[30:33], v110 offset:28672
    s_mov_b64 exec, s[60:61]
    ds_read_b128 v[42:45], v111 offset:8960
    ds_read_b128 v[50:53], v111 offset:9600
    s_mov_b64 exec, -1
    v_exp_f32 v60, v60
    v_exp_f32 v61, v61
    v_cvt_pk_bf16_f32 v86, v54, v55
    v_cvt_pk_bf16_f32 v87, v56, v57
    v_cvt_pk_bf16_f32 v88, v58, v59
    v_cvt_pk_bf16_f32 v89, v60, v61
    v_mfma_f32_32x32x8_bf16 v[70:85], v[36:37], v[14:15], v[70:85]
    s_cmp_gt_u32 s58, 2
    s_cselect_b32 s43, s55, 0x7fff0000
    s_add_u32 s42, s47, 2048
    s_mov_b32 m0, s42
    s_nop 0
    buffer_load_dwordx4 v144, s[28:31], s43 offen lds
    v_exp_f32 v62, v62
    v_exp_f32 v63, v63
    v_exp_f32 v64, v64
    v_exp_f32 v65, v65
    v_exp_f32 v66, v66
    v_exp_f32 v67, v67
    v_mfma_f32_32x32x16_bf16 v[94:109], v[38:41], v[86:89], v[94:109]
    v_exp_f32 v68, v68
    v_exp_f32 v69, v69
    v_cvt_pk_bf16_f32 v90, v62, v63
    v_cvt_pk_bf16_f32 v91, v64, v65
    v_cvt_pk_bf16_f32 v92, v66, v67
    v_cvt_pk_bf16_f32 v93, v68, v69
    s_waitcnt lgkmcnt(0)
    v_mfma_f32_32x32x16_bf16 v[54:69], v[22:25], v[8:11], 0
    s_cmp_gt_u32 s58, 3
    s_cselect_b32 s43, s55, 0x7fff0000
    s_add_u32 s42, s47, 3072
    s_mov_b32 m0, s42
    s_nop 0
    buffer_load_dwordx4 v145, s[28:31], s43 offen lds
    v_exp_f32 v70, v70
    v_exp_f32 v71, v71
    v_exp_f32 v72, v72
    v_exp_f32 v73, v73
    v_exp_f32 v74, v74
    v_exp_f32 v75, v75
    v_mfma_f32_32x32x16_bf16 v[94:109], v[46:49], v[90:93], v[94:109]
    ds_read_b128 v[26:29], v110 offset:21504
    s_mov_b64 exec, s[60:61]
    ds_read_b128 v[38:41], v111 offset:20480
    ds_read_b128 v[46:49], v111 offset:21120
    s_mov_b64 exec, -1
    v_exp_f32 v76, v76
    v_exp_f32 v77, v77
    v_cvt_pk_bf16_f32 v86, v70, v71
    v_cvt_pk_bf16_f32 v87, v72, v73
    v_cvt_pk_bf16_f32 v88, v74, v75
    v_cvt_pk_bf16_f32 v89, v76, v77
    v_mfma_f32_32x32x8_bf16 v[54:69], v[30:31], v[12:13], v[54:69]
    s_cmp_gt_u32 s58, 4
    s_cselect_b32 s43, s55, 0x7fff0000
    s_add_u32 s42, s47, 4096
    s_mov_b32 m0, s42
    s_nop 0
    buffer_load_dwordx4 v146, s[28:31], s43 offen lds
    v_exp_f32 v78, v78
    v_exp_f32 v79, v79
    v_exp_f32 v80, v80
    v_exp_f32 v81, v81
    v_exp_f32 v82, v82
    v_exp_f32 v83, v83
    v_mfma_f32_32x32x16_bf16 v[94:109], v[42:45], v[86:89], v[94:109]
    v_exp_f32 v84, v84
    v_exp_f32 v85, v85
    v_cvt_pk_bf16_f32 v90, v78, v79
    v_cvt_pk_bf16_f32 v91, v80, v81
    v_cvt_pk_bf16_f32 v92, v82, v83
    v_cvt_pk_bf16_f32 v93, v84, v85
    v_add_u32 v110, 20480, v110
    v_add_u32 v111, 20480, v111
    s_waitcnt vmcnt(5)
    s_barrier
    s_waitcnt lgkmcnt(0)
    v_mfma_f32_32x32x16_bf16 v[70:85], v[26:29], v[8:11], 0
    v_exp_f32 v54, v54
    v_exp_f32 v55, v55
    v_exp_f32 v56, v56
    v_exp_f32 v57, v57
    v_exp_f32 v58, v58
    v_exp_f32 v59, v59
    v_mfma_f32_32x32x16_bf16 v[94:109], v[50:53], v[90:93], v[94:109]
    ds_read_b128 v[22:25], v110 offset:2048
    s_mov_b64 exec, s[60:61]
    ds_read_b128 v[42:45], v111 offset:1280
    ds_read_b128 v[50:53], v111 offset:1920
    s_mov_b64 exec, -1
    v_exp_f32 v60, v60
    v_exp_f32 v61, v61
    v_cvt_pk_bf16_f32 v86, v54, v55
    v_cvt_pk_bf16_f32 v87, v56, v57
    v_cvt_pk_bf16_f32 v88, v58, v59
    v_cvt_pk_bf16_f32 v89, v60, v61
    v_mfma_f32_32x32x8_bf16 v[70:85], v[32:33], v[12:13], v[70:85]
    v_exp_f32 v62, v62
    v_exp_f32 v63, v63
    v_exp_f32 v64, v64
    v_exp_f32 v65, v65
    v_exp_f32 v66, v66
    v_exp_f32 v67, v67
    v_mfma_f32_32x32x16_bf16 v[94:109], v[38:41], v[86:89], v[94:109]
    v_exp_f32 v68, v68
    v_exp_f32 v69, v69
    v_cvt_pk_bf16_f32 v90, v62, v63
    v_cvt_pk_bf16_f32 v91, v64, v65
    v_cvt_pk_bf16_f32 v92, v66, v67
    v_cvt_pk_bf16_f32 v93, v68, v69
    s_waitcnt lgkmcnt(0)
    v_mfma_f32_32x32x16_bf16 v[54:69], v[22:25], v[8:11], 0
    v_exp_f32 v70, v70
    v_exp_f32 v71, v71
    v_exp_f32 v72, v72
    v_exp_f32 v73, v73
    v_exp_f32 v74, v74
    v_exp_f32 v75, v75
    v_mfma_f32_32x32x16_bf16 v[94:109], v[46:49], v[90:93], v[94:109]
    ds_read_b128 v[26:29], v110 offset:3072
    s_mov_b64 exec, s[60:61]
    ds_read_b128 v[38:41], v111 offset:2560
    ds_read_b128 v[46:49], v111 offset:3200
    s_mov_b64 exec, -1
    v_exp_f32 v76, v76
    v_exp_f32 v77, v77
    v_cvt_pk_bf16_f32 v86, v70, v71
    v_cvt_pk_bf16_f32 v87, v72, v73
    v_cvt_pk_bf16_f32 v88, v74, v75
    v_cvt_pk_bf16_f32 v89, v76, v77
    v_mfma_f32_32x32x8_bf16 v[54:69], v[30:31], v[14:15], v[54:69]
    v_exp_f32 v78, v78
    v_exp_f32 v79, v79
    v_exp_f32 v80, v80
    v_exp_f32 v81, v81
    v_exp_f32 v82, v82
    v_exp_f32 v83, v83
    v_mfma_f32_32x32x16_bf16 v[94:109], v[42:45], v[86:89], v[94:109]
    v_exp_f32 v84, v84
    v_exp_f32 v85, v85
    v_cvt_pk_bf16_f32 v90, v78, v79
    v_cvt_pk_bf16_f32 v91, v80, v81
    v_cvt_pk_bf16_f32 v92, v82, v83
    v_cvt_pk_bf16_f32 v93, v84, v85
    s_waitcnt lgkmcnt(0)
    v_mfma_f32_32x32x16_bf16 v[70:85], v[26:29], v[8:11], 0
    v_exp_f32 v54, v54
    v_exp_f32 v55, v55
    v_exp_f32 v56, v56
    v_exp_f32 v57, v57
    v_exp_f32 v58, v58
    v_exp_f32 v59, v59
    v_mfma_f32_32x32x16_bf16 v[94:109], v[50:53], v[90:93], v[94:109]
    ds_read_b128 v[22:25], v110 offset:4096
    ds_read_b128 v[34:37], v110 offset:9216
    s_mov_b64 exec, s[60:61]
    ds_read_b128 v[42:45], v111 offset:3840
    ds_read_b128 v[50:53], v111 offset:4480
    s_mov_b64 exec, -1
    v_exp_f32 v60, v60
    v_exp_f32 v61, v61
    v_cvt_pk_bf16_f32 v86, v54, v55
    v_cvt_pk_bf16_f32 v87, v56, v57
    v_cvt_pk_bf16_f32 v88, v58, v59
    v_cvt_pk_bf16_f32 v89, v60, v61
    v_mfma_f32_32x32x8_bf16 v[70:85], v[32:33], v[14:15], v[70:85]
    v_exp_f32 v62, v62
    v_exp_f32 v63, v63
    v_exp_f32 v64, v64
    v_exp_f32 v65, v65
    v_exp_f32 v66, v66
    v_exp_f32 v67, v67
    v_mfma_f32_32x32x16_bf16 v[94:109], v[38:41], v[86:89], v[94:109]
    v_exp_f32 v68, v68
    v_exp_f32 v69, v69
    v_cvt_pk_bf16_f32 v90, v62, v63
    v_cvt_pk_bf16_f32 v91, v64, v65
    v_cvt_pk_bf16_f32 v92, v66, v67
    v_cvt_pk_bf16_f32 v93, v68, v69
    s_waitcnt lgkmcnt(0)
    v_mfma_f32_32x32x16_bf16 v[54:69], v[22:25], v[8:11], 0
    v_exp_f32 v70, v70
    v_exp_f32 v71, v71
    v_exp_f32 v72, v72
    v_exp_f32 v73, v73
    v_exp_f32 v74, v74
    v_exp_f32 v75, v75
    v_mfma_f32_32x32x16_bf16 v[94:109], v[46:49], v[90:93], v[94:109]
    ds_read_b128 v[26:29], v110 offset:5120
    s_mov_b64 exec, s[60:61]
    ds_read_b128 v[38:41], v111 offset:5120
    ds_read_b128 v[46:49], v111 offset:5760
    s_mov_b64 exec, -1
    v_exp_f32 v76, v76
    v_exp_f32 v77, v77
    v_cvt_pk_bf16_f32 v86, v70, v71
    v_cvt_pk_bf16_f32 v87, v72, v73
    v_cvt_pk_bf16_f32 v88, v74, v75
    v_cvt_pk_bf16_f32 v89, v76, v77
    v_mfma_f32_32x32x8_bf16 v[54:69], v[34:35], v[12:13], v[54:69]
    v_exp_f32 v78, v78
    v_exp_f32 v79, v79
    v_exp_f32 v80, v80
    v_exp_f32 v81, v81
    v_exp_f32 v82, v82
    v_exp_f32 v83, v83
    v_mfma_f32_32x32x16_bf16 v[94:109], v[42:45], v[86:89], v[94:109]
    v_exp_f32 v84, v84
    v_exp_f32 v85, v85
    v_cvt_pk_bf16_f32 v90, v78, v79
    v_cvt_pk_bf16_f32 v91, v80, v81
    v_cvt_pk_bf16_f32 v92, v82, v83
    v_cvt_pk_bf16_f32 v93, v84, v85
    s_waitcnt lgkmcnt(0)
    v_mfma_f32_32x32x16_bf16 v[70:85], v[26:29], v[8:11], 0
    v_exp_f32 v54, v54
    v_exp_f32 v55, v55
    v_exp_f32 v56, v56
    v_exp_f32 v57, v57
    v_exp_f32 v58, v58
    v_exp_f32 v59, v59
    v_mfma_f32_32x32x16_bf16 v[94:109], v[50:53], v[90:93], v[94:109]
    ds_read_b128 v[22:25], v110 offset:6144
    s_mov_b64 exec, s[60:61]
    ds_read_b128 v[42:45], v111 offset:6400
    ds_read_b128 v[50:53], v111 offset:7040
    s_mov_b64 exec, -1
    v_exp_f32 v60, v60
    v_exp_f32 v61, v61
    v_cvt_pk_bf16_f32 v86, v54, v55
    v_cvt_pk_bf16_f32 v87, v56, v57
    v_cvt_pk_bf16_f32 v88, v58, v59
    v_cvt_pk_bf16_f32 v89, v60, v61
    v_mfma_f32_32x32x8_bf16 v[70:85], v[36:37], v[12:13], v[70:85]
    v_exp_f32 v62, v62
    v_exp_f32 v63, v63
    v_exp_f32 v64, v64
    v_exp_f32 v65, v65
    v_exp_f32 v66, v66
    v_exp_f32 v67, v67
    v_mfma_f32_32x32x16_bf16 v[94:109], v[38:41], v[86:89], v[94:109]
    v_exp_f32 v68, v68
    v_exp_f32 v69, v69
    v_cvt_pk_bf16_f32 v90, v62, v63
    v_cvt_pk_bf16_f32 v91, v64, v65
    v_cvt_pk_bf16_f32 v92, v66, v67
    v_cvt_pk_bf16_f32 v93, v68, v69
    s_waitcnt lgkmcnt(0)
    v_mfma_f32_32x32x16_bf16 v[54:69], v[22:25], v[8:11], 0
    v_exp_f32 v70, v70
    v_exp_f32 v71, v71
    v_exp_f32 v72, v72
    v_exp_f32 v73, v73
    v_exp_f32 v74, v74
    v_exp_f32 v75, v75
    v_mfma_f32_32x32x16_bf16 v[94:109], v[46:49], v[90:93], v[94:109]
    ds_read_b128 v[26:29], v110 offset:7168
    s_mov_b64 exec, s[60:61]
    ds_read_b128 v[38:41], v111 offset:7680
    ds_read_b128 v[46:49], v111 offset:8320
    s_mov_b64 exec, -1
    v_exp_f32 v76, v76
    v_exp_f32 v77, v77
    v_cvt_pk_bf16_f32 v86, v70, v71
    v_cvt_pk_bf16_f32 v87, v72, v73
    v_cvt_pk_bf16_f32 v88, v74, v75
    v_cvt_pk_bf16_f32 v89, v76, v77
    v_mfma_f32_32x32x8_bf16 v[54:69], v[34:35], v[14:15], v[54:69]
    v_exp_f32 v78, v78
    v_exp_f32 v79, v79
    v_exp_f32 v80, v80
    v_exp_f32 v81, v81
    v_exp_f32 v82, v82
    v_exp_f32 v83, v83
    v_mfma_f32_32x32x16_bf16 v[94:109], v[42:45], v[86:89], v[94:109]
    v_exp_f32 v84, v84
    v_exp_f32 v85, v85
    v_cvt_pk_bf16_f32 v90, v78, v79
    v_cvt_pk_bf16_f32 v91, v80, v81
    v_cvt_pk_bf16_f32 v92, v82, v83
    v_cvt_pk_bf16_f32 v93, v84, v85
    s_waitcnt lgkmcnt(0)
    v_mfma_f32_32x32x16_bf16 v[70:85], v[26:29], v[8:11], 0
    v_exp_f32 v54, v54
    v_exp_f32 v55, v55
    v_exp_f32 v56, v56
    v_exp_f32 v57, v57
    v_exp_f32 v58, v58
    v_exp_f32 v59, v59
    v_mfma_f32_32x32x16_bf16 v[94:109], v[50:53], v[90:93], v[94:109]
    ds_read_b128 v[22:25], v110 offset:20480
    ds_read_b128 v[30:33], v110 offset:28672
    s_mov_b64 exec, s[60:61]
    ds_read_b128 v[42:45], v111 offset:8960
    ds_read_b128 v[50:53], v111 offset:9600
    s_mov_b64 exec, -1
    v_exp_f32 v60, v60
    v_exp_f32 v61, v61
    v_cvt_pk_bf16_f32 v86, v54, v55
    v_cvt_pk_bf16_f32 v87, v56, v57
    v_cvt_pk_bf16_f32 v88, v58, v59
    v_cvt_pk_bf16_f32 v89, v60, v61
    v_mfma_f32_32x32x8_bf16 v[70:85], v[36:37], v[14:15], v[70:85]
    v_exp_f32 v62, v62
    v_exp_f32 v63, v63
    v_exp_f32 v64, v64
    v_exp_f32 v65, v65
    v_exp_f32 v66, v66
    v_exp_f32 v67, v67
    v_mfma_f32_32x32x16_bf16 v[94:109], v[38:41], v[86:89], v[94:109]
    v_exp_f32 v68, v68
    v_exp_f32 v69, v69
    v_cvt_pk_bf16_f32 v90, v62, v63
    v_cvt_pk_bf16_f32 v91, v64, v65
    v_cvt_pk_bf16_f32 v92, v66, v67
    v_cvt_pk_bf16_f32 v93, v68, v69
    s_waitcnt lgkmcnt(0)
    v_mfma_f32_32x32x16_bf16 v[54:69], v[22:25], v[8:11], 0
    v_exp_f32 v70, v70
    v_exp_f32 v71, v71
    v_exp_f32 v72, v72
    v_exp_f32 v73, v73
    v_exp_f32 v74, v74
    v_exp_f32 v75, v75
    v_mfma_f32_32x32x16_bf16 v[94:109], v[46:49], v[90:93], v[94:109]
    ds_read_b128 v[26:29], v110 offset:21504
    s_mov_b64 exec, s[60:61]
    ds_read_b128 v[38:41], v111 offset:20480
    ds_read_b128 v[46:49], v111 offset:21120
    s_mov_b64 exec, -1
    v_exp_f32 v76, v76
    v_exp_f32 v77, v77
    v_cvt_pk_bf16_f32 v86, v70, v71
    v_cvt_pk_bf16_f32 v87, v72, v73
    v_cvt_pk_bf16_f32 v88, v74, v75
    v_cvt_pk_bf16_f32 v89, v76, v77
    v_mfma_f32_32x32x8_bf16 v[54:69], v[30:31], v[12:13], v[54:69]
    v_exp_f32 v78, v78
    v_exp_f32 v79, v79
    v_exp_f32 v80, v80
    v_exp_f32 v81, v81
    v_exp_f32 v82, v82
    v_exp_f32 v83, v83
    v_mfma_f32_32x32x16_bf16 v[94:109], v[42:45], v[86:89], v[94:109]
    v_exp_f32 v84, v84
    v_exp_f32 v85, v85
    v_cvt_pk_bf16_f32 v90, v78, v79
    v_cvt_pk_bf16_f32 v91, v80, v81
    v_cvt_pk_bf16_f32 v92, v82, v83
    v_cvt_pk_bf16_f32 v93, v84, v85
    v_add_u32 v110, 20480, v110
    v_add_u32 v111, 20480, v111
    v_lshrrev_b32 v4, 2, v1
    v_mul_lo_u32 v4, v4, s59
    v_and_b32 v5, 3, v1
    v_lshl_add_u32 v4, v5, 3, v4
    v_add_u32 v4, s47, v4
    s_lshl_b32 s42, s59, 4
    v_add_u32 v5, s42, v4
    v_mov_b32 v134, 0x3f803f80
    v_mov_b32 v135, 0x3f803f80
    v_mov_b32 v136, 0x3f803f80
    v_mov_b32 v137, 0x3f803f80
    s_waitcnt vmcnt(0)

    ds_read_b64_tr_b16 v[114:115], v4 offset:0
    ds_read_b64_tr_b16 v[116:117], v5 offset:0
    ds_read_b64_tr_b16 v[118:119], v4 offset:32
    ds_read_b64_tr_b16 v[120:121], v5 offset:32
    ds_read_b64_tr_b16 v[122:123], v4 offset:64
    ds_read_b64_tr_b16 v[124:125], v5 offset:64
    ds_read_b64_tr_b16 v[126:127], v4 offset:96
    ds_read_b64_tr_b16 v[128:129], v5 offset:96
    ds_read_b64_tr_b16 v[130:131], v4 offset:128
    ds_read_b64_tr_b16 v[132:133], v5 offset:128
    v_and_b32 v4, 15, v1
    v_cmp_eq_u32 vcc, 0, v4
    v_mov_b32 v5, 0x7fffff00
    v_and_b32 v6, 48, v1
    s_waitcnt lgkmcnt(0)
    v_cndmask_b32 v6, v5, v6, vcc

    v_mfma_f32_16x16x32_bf16 v[138:141], v[114:117], v[134:137], 0
    v_mfma_f32_16x16x32_bf16 v[142:145], v[118:121], v[134:137], 0
    v_mfma_f32_16x16x32_bf16 v[146:149], v[122:125], v[134:137], 0
    s_cmp_gt_u32 s58, 0
    s_cselect_b32 s43, s56, 0x7fff0000
    buffer_store_dwordx4 v[114:117], v112, s[16:19], s43 offen sc1
    s_add_u32 s56, s56, s57
    s_cmp_gt_u32 s58, 1
    s_cselect_b32 s43, s56, 0x7fff0000
    buffer_store_dwordx4 v[118:121], v112, s[16:19], s43 offen sc1
    s_add_u32 s56, s56, s57
    s_cmp_gt_u32 s58, 2
    s_cselect_b32 s43, s56, 0x7fff0000
    buffer_store_dwordx4 v[122:125], v112, s[16:19], s43 offen sc1
    s_add_u32 s56, s56, s57
    s_cmp_gt_u32 s58, 3
    s_cselect_b32 s43, s56, 0x7fff0000
    buffer_store_dwordx4 v[126:129], v112, s[16:19], s43 offen sc1
    s_add_u32 s56, s56, s57
    s_cmp_gt_u32 s58, 4
    s_cselect_b32 s43, s56, 0x7fff0000
    buffer_store_dwordx4 v[130:133], v112, s[16:19], s43 offen sc1
    s_add_u32 s56, s56, s57
    s_add_u32 s42, s47, 0
    s_mov_b32 m0, s42
    s_nop 0
    buffer_load_dwordx4 v112, s[20:23], s42 offen sc1 lds
    s_add_u32 s42, s47, 1024
    s_mov_b32 m0, s42
    s_nop 0
    buffer_load_dwordx4 v112, s[20:23], s42 offen sc1 lds
    s_add_u32 s42, s47, 2048
    s_mov_b32 m0, s42
    s_nop 0
    buffer_load_dwordx4 v112, s[20:23], s42 offen sc1 lds
    s_add_u32 s42, s47, 3072
    s_mov_b32 m0, s42
    s_nop 0
    buffer_load_dwordx4 v112, s[20:23], s42 offen sc1 lds
    s_add_u32 s42, s47, 4096
    s_mov_b32 m0, s42
    s_nop 0
    buffer_load_dwordx4 v112, s[20:23], s42 offen sc1 lds
    buffer_store_dwordx4 v[138:141], v6, s[16:19], s69 offen offset:0 sc1
    buffer_store_dwordx4 v[142:145], v6, s[16:19], s69 offen offset:64 sc1
    buffer_store_dwordx4 v[146:149], v6, s[16:19], s69 offen offset:128 sc1
    s_mov_b32 s64, 2
.p2align 6
sequential_preLN__grouped_kv_mqa__dense_activation_silu__prompt_kernel_l1:
    s_waitcnt lgkmcnt(0)
    v_mfma_f32_32x32x16_bf16 v[70:85], v[26:29], v[8:11], 0
    v_exp_f32 v54, v54
    v_exp_f32 v55, v55
    v_exp_f32 v56, v56
    v_exp_f32 v57, v57
    v_exp_f32 v58, v58
    v_exp_f32 v59, v59
    v_mfma_f32_32x32x16_bf16 v[94:109], v[50:53], v[90:93], v[94:109]
    ds_read_b128 v[22:25], v110 offset:2048
    s_mov_b64 exec, s[60:61]
    ds_read_b128 v[42:45], v111 offset:1280
    ds_read_b128 v[50:53], v111 offset:1920
    s_mov_b64 exec, -1
    v_exp_f32 v60, v60
    v_exp_f32 v61, v61
    v_cvt_pk_bf16_f32 v86, v54, v55
    v_cvt_pk_bf16_f32 v87, v56, v57
    v_cvt_pk_bf16_f32 v88, v58, v59
    v_cvt_pk_bf16_f32 v89, v60, v61
    v_mfma_f32_32x32x8_bf16 v[70:85], v[32:33], v[12:13], v[70:85]
    v_exp_f32 v62, v62
    v_exp_f32 v63, v63
    v_exp_f32 v64, v64
    v_exp_f32 v65, v65
    v_exp_f32 v66, v66
    v_exp_f32 v67, v67
    v_mfma_f32_32x32x16_bf16 v[94:109], v[38:41], v[86:89], v[94:109]
    v_exp_f32 v68, v68
    v_exp_f32 v69, v69
    v_cvt_pk_bf16_f32 v90, v62, v63
    v_cvt_pk_bf16_f32 v91, v64, v65
    v_cvt_pk_bf16_f32 v92, v66, v67
    v_cvt_pk_bf16_f32 v93, v68, v69
    s_waitcnt lgkmcnt(0)
    v_mfma_f32_32x32x16_bf16 v[54:69], v[22:25], v[8:11], 0
    v_exp_f32 v70, v70
    v_exp_f32 v71, v71
    v_exp_f32 v72, v72
    v_exp_f32 v73, v73
    v_exp_f32 v74, v74
    v_exp_f32 v75, v75
    v_mfma_f32_32x32x16_bf16 v[94:109], v[46:49], v[90:93], v[94:109]
    ds_read_b128 v[26:29], v110 offset:3072
    s_mov_b64 exec, s[60:61]
    ds_read_b128 v[38:41], v111 offset:2560
    ds_read_b128 v[46:49], v111 offset:3200
    s_mov_b64 exec, -1
    v_exp_f32 v76, v76
    v_exp_f32 v77, v77
    v_cvt_pk_bf16_f32 v86, v70, v71
    v_cvt_pk_bf16_f32 v87, v72, v73
    v_cvt_pk_bf16_f32 v88, v74, v75
    v_cvt_pk_bf16_f32 v89, v76, v77
    v_mfma_f32_32x32x8_bf16 v[54:69], v[30:31], v[14:15], v[54:69]
    v_exp_f32 v78, v78
    v_exp_f32 v79, v79
    v_exp_f32 v80, v80
    v_exp_f32 v81, v81
    v_exp_f32 v82, v82
    v_exp_f32 v83, v83
    v_mfma_f32_32x32x16_bf16 v[94:109], v[42:45], v[86:89], v[94:109]
    v_exp_f32 v84, v84
    v_exp_f32 v85, v85
    v_cvt_pk_bf16_f32 v90, v78, v79
    v_cvt_pk_bf16_f32 v91, v80, v81
    v_cvt_pk_bf16_f32 v92, v82, v83
    v_cvt_pk_bf16_f32 v93, v84, v85
    s_waitcnt lgkmcnt(0)
    v_mfma_f32_32x32x16_bf16 v[70:85], v[26:29], v[8:11], 0
    v_exp_f32 v54, v54
    v_exp_f32 v55, v55
    v_exp_f32 v56, v56
    v_exp_f32 v57, v57
    v_exp_f32 v58, v58
    v_exp_f32 v59, v59
    v_mfma_f32_32x32x16_bf16 v[94:109], v[50:53], v[90:93], v[94:109]
    ds_read_b128 v[22:25], v110 offset:4096
    ds_read_b128 v[34:37], v110 offset:9216
    s_mov_b64 exec, s[60:61]
    ds_read_b128 v[42:45], v111 offset:3840
    ds_read_b128 v[50:53], v111 offset:4480
    s_mov_b64 exec, -1
    v_exp_f32 v60, v60
    v_exp_f32 v61, v61
    v_cvt_pk_bf16_f32 v86, v54, v55
    v_cvt_pk_bf16_f32 v87, v56, v57
    v_cvt_pk_bf16_f32 v88, v58, v59
    v_cvt_pk_bf16_f32 v89, v60, v61
    v_mfma_f32_32x32x8_bf16 v[70:85], v[32:33], v[14:15], v[70:85]
    v_exp_f32 v62, v62
    v_exp_f32 v63, v63
    v_exp_f32 v64, v64
    v_exp_f32 v65, v65
    v_exp_f32 v66, v66
    v_exp_f32 v67, v67
    v_mfma_f32_32x32x16_bf16 v[94:109], v[38:41], v[86:89], v[94:109]
    v_exp_f32 v68, v68
    v_exp_f32 v69, v69
    v_cvt_pk_bf16_f32 v90, v62, v63
    v_cvt_pk_bf16_f32 v91, v64, v65
    v_cvt_pk_bf16_f32 v92, v66, v67
    v_cvt_pk_bf16_f32 v93, v68, v69
    s_waitcnt lgkmcnt(0)
    v_mfma_f32_32x32x16_bf16 v[54:69], v[22:25], v[8:11], 0
    v_exp_f32 v70, v70
    v_exp_f32 v71, v71
    v_exp_f32 v72, v72
    v_exp_f32 v73, v73
    v_exp_f32 v74, v74
    v_exp_f32 v75, v75
    v_mfma_f32_32x32x16_bf16 v[94:109], v[46:49], v[90:93], v[94:109]
    ds_read_b128 v[26:29], v110 offset:5120
    s_mov_b64 exec, s[60:61]
    ds_read_b128 v[38:41], v111 offset:5120
    ds_read_b128 v[46:49], v111 offset:5760
    s_mov_b64 exec, -1
    v_exp_f32 v76, v76
    v_exp_f32 v77, v77
    v_cvt_pk_bf16_f32 v86, v70, v71
    v_cvt_pk_bf16_f32 v87, v72, v73
    v_cvt_pk_bf16_f32 v88, v74, v75
    v_cvt_pk_bf16_f32 v89, v76, v77
    v_mfma_f32_32x32x8_bf16 v[54:69], v[34:35], v[12:13], v[54:69]
    v_exp_f32 v78, v78
    v_exp_f32 v79, v79
    v_exp_f32 v80, v80
    v_exp_f32 v81, v81
    v_exp_f32 v82, v82
    v_exp_f32 v83, v83
    v_mfma_f32_32x32x16_bf16 v[94:109], v[42:45], v[86:89], v[94:109]
    v_exp_f32 v84, v84
    v_exp_f32 v85, v85
    v_cvt_pk_bf16_f32 v90, v78, v79
    v_cvt_pk_bf16_f32 v91, v80, v81
    v_cvt_pk_bf16_f32 v92, v82, v83
    v_cvt_pk_bf16_f32 v93, v84, v85
    s_waitcnt lgkmcnt(0)
    v_mfma_f32_32x32x16_bf16 v[70:85], v[26:29], v[8:11], 0
    v_exp_f32 v54, v54
    v_exp_f32 v55, v55
    v_exp_f32 v56, v56
    v_exp_f32 v57, v57
    v_exp_f32 v58, v58
    v_exp_f32 v59, v59
    v_mfma_f32_32x32x16_bf16 v[94:109], v[50:53], v[90:93], v[94:109]
    ds_read_b128 v[22:25], v110 offset:6144
    s_mov_b64 exec, s[60:61]
    ds_read_b128 v[42:45], v111 offset:6400
    ds_read_b128 v[50:53], v111 offset:7040
    s_mov_b64 exec, -1
    v_exp_f32 v60, v60
    v_exp_f32 v61, v61
    v_cvt_pk_bf16_f32 v86, v54, v55
    v_cvt_pk_bf16_f32 v87, v56, v57
    v_cvt_pk_bf16_f32 v88, v58, v59
    v_cvt_pk_bf16_f32 v89, v60, v61
    v_mfma_f32_32x32x8_bf16 v[70:85], v[36:37], v[12:13], v[70:85]
    v_exp_f32 v62, v62
    v_exp_f32 v63, v63
    v_exp_f32 v64, v64
    v_exp_f32 v65, v65
    v_exp_f32 v66, v66
    v_exp_f32 v67, v67
    v_mfma_f32_32x32x16_bf16 v[94:109], v[38:41], v[86:89], v[94:109]
    v_exp_f32 v68, v68
    v_exp_f32 v69, v69
    v_cvt_pk_bf16_f32 v90, v62, v63
    v_cvt_pk_bf16_f32 v91, v64, v65
    v_cvt_pk_bf16_f32 v92, v66, v67
    v_cvt_pk_bf16_f32 v93, v68, v69
    s_waitcnt lgkmcnt(0)
    v_mfma_f32_32x32x16_bf16 v[54:69], v[22:25], v[8:11], 0
    v_exp_f32 v70, v70
    v_exp_f32 v71, v71
    v_exp_f32 v72, v72
    v_exp_f32 v73, v73
    v_exp_f32 v74, v74
    v_exp_f32 v75, v75
    v_mfma_f32_32x32x16_bf16 v[94:109], v[46:49], v[90:93], v[94:109]
    ds_read_b128 v[26:29], v110 offset:7168
    s_mov_b64 exec, s[60:61]
    ds_read_b128 v[38:41], v111 offset:7680
    ds_read_b128 v[46:49], v111 offset:8320
    s_mov_b64 exec, -1
    v_exp_f32 v76, v76
    v_exp_f32 v77, v77
    v_cvt_pk_bf16_f32 v86, v70, v71
    v_cvt_pk_bf16_f32 v87, v72, v73
    v_cvt_pk_bf16_f32 v88, v74, v75
    v_cvt_pk_bf16_f32 v89, v76, v77
    v_mfma_f32_32x32x8_bf16 v[54:69], v[34:35], v[14:15], v[54:69]
    v_exp_f32 v78, v78
    v_exp_f32 v79, v79
    v_exp_f32 v80, v80
    v_exp_f32 v81, v81
    v_exp_f32 v82, v82
    v_exp_f32 v83, v83
    v_mfma_f32_32x32x16_bf16 v[94:109], v[42:45], v[86:89], v[94:109]
    v_exp_f32 v84, v84
    v_exp_f32 v85, v85
    v_cvt_pk_bf16_f32 v90, v78, v79
    v_cvt_pk_bf16_f32 v91, v80, v81
    v_cvt_pk_bf16_f32 v92, v82, v83
    v_cvt_pk_bf16_f32 v93, v84, v85
    s_waitcnt lgkmcnt(0)
    v_mfma_f32_32x32x16_bf16 v[70:85], v[26:29], v[8:11], 0
    v_exp_f32 v54, v54
    v_exp_f32 v55, v55
    v_exp_f32 v56, v56
    v_exp_f32 v57, v57
    v_exp_f32 v58, v58
    v_exp_f32 v59, v59
    v_mfma_f32_32x32x16_bf16 v[94:109], v[50:53], v[90:93], v[94:109]
    ds_read_b128 v[22:25], v110 offset:20480
    ds_read_b128 v[30:33], v110 offset:28672
    s_mov_b64 exec, s[60:61]
    ds_read_b128 v[42:45], v111 offset:8960
    ds_read_b128 v[50:53], v111 offset:9600
    s_mov_b64 exec, -1
    v_exp_f32 v60, v60
    v_exp_f32 v61, v61
    v_cvt_pk_bf16_f32 v86, v54, v55
    v_cvt_pk_bf16_f32 v87, v56, v57
    v_cvt_pk_bf16_f32 v88, v58, v59
    v_cvt_pk_bf16_f32 v89, v60, v61
    v_mfma_f32_32x32x8_bf16 v[70:85], v[36:37], v[14:15], v[70:85]
    v_exp_f32 v62, v62
    v_exp_f32 v63, v63
    v_exp_f32 v64, v64
    v_exp_f32 v65, v65
    v_exp_f32 v66, v66
    v_exp_f32 v67, v67
    v_mfma_f32_32x32x16_bf16 v[94:109], v[38:41], v[86:89], v[94:109]
    v_exp_f32 v68, v68
    v_exp_f32 v69, v69
    v_cvt_pk_bf16_f32 v90, v62, v63
    v_cvt_pk_bf16_f32 v91, v64, v65
    v_cvt_pk_bf16_f32 v92, v66, v67
    v_cvt_pk_bf16_f32 v93, v68, v69
    s_waitcnt lgkmcnt(0)
    v_mfma_f32_32x32x16_bf16 v[54:69], v[22:25], v[8:11], 0
    v_exp_f32 v70, v70
    v_exp_f32 v71, v71
    v_exp_f32 v72, v72
    v_exp_f32 v73, v73
    v_exp_f32 v74, v74
    v_exp_f32 v75, v75
    v_mfma_f32_32x32x16_bf16 v[94:109], v[46:49], v[90:93], v[94:109]
    ds_read_b128 v[26:29], v110 offset:21504
    s_mov_b64 exec, s[60:61]
    ds_read_b128 v[38:41], v111 offset:20480
    ds_read_b128 v[46:49], v111 offset:21120
    s_mov_b64 exec, -1
    v_exp_f32 v76, v76
    v_exp_f32 v77, v77
    v_cvt_pk_bf16_f32 v86, v70, v71
    v_cvt_pk_bf16_f32 v87, v72, v73
    v_cvt_pk_bf16_f32 v88, v74, v75
    v_cvt_pk_bf16_f32 v89, v76, v77
    v_mfma_f32_32x32x8_bf16 v[54:69], v[30:31], v[12:13], v[54:69]
    v_exp_f32 v78, v78
    v_exp_f32 v79, v79
    v_exp_f32 v80, v80
    v_exp_f32 v81, v81
    v_exp_f32 v82, v82
    v_exp_f32 v83, v83
    v_mfma_f32_32x32x16_bf16 v[94:109], v[42:45], v[86:89], v[94:109]
    v_exp_f32 v84, v84
    v_exp_f32 v85, v85
    v_cvt_pk_bf16_f32 v90, v78, v79
    v_cvt_pk_bf16_f32 v91, v80, v81
    v_cvt_pk_bf16_f32 v92, v82, v83
    v_cvt_pk_bf16_f32 v93, v84, v85
    v_add_u32 v110, 20480, v110
    v_add_u32 v111, 20480, v111
    s_sub_u32 s64, s64, 1
    s_cmp_lg_u32 s64, 0
    s_cbranch_scc1 sequential_preLN__grouped_kv_mqa__dense_activation_silu__prompt_kernel_l1
    s_waitcnt vmcnt(0)
    s_barrier
    s_cmp_eq_u32 s36, 0
    s_cbranch_scc0 sequential_preLN__grouped_kv_mqa__dense_activation_silu__prompt_kernel_nog
    v_mov_b32 v250, 0
    v_mov_b32 v251, 1
    s_mov_b64 exec, 1
    buffer_atomic_add v251, v250, s[16:19], s15 offen sc1
    s_mov_b64 exec, -1

sequential_preLN__grouped_kv_mqa__dense_activation_silu__prompt_kernel_nog:
    s_mov_b32 s64, 1
.p2align 6
sequential_preLN__grouped_kv_mqa__dense_activation_silu__prompt_kernel_l2:
    s_waitcnt lgkmcnt(0)
    v_mfma_f32_32x32x16_bf16 v[70:85], v[26:29], v[8:11], 0
    v_exp_f32 v54, v54
    v_exp_f32 v55, v55
    v_exp_f32 v56, v56
    v_exp_f32 v57, v57
    v_exp_f32 v58, v58
    v_exp_f32 v59, v59
    v_mfma_f32_32x32x16_bf16 v[94:109], v[50:53], v[90:93], v[94:109]
    ds_read_b128 v[22:25], v110 offset:2048
    s_mov_b64 exec, s[60:61]
    ds_read_b128 v[42:45], v111 offset:1280
    ds_read_b128 v[50:53], v111 offset:1920
    s_mov_b64 exec, -1
    v_exp_f32 v60, v60
    v_exp_f32 v61, v61
    v_cvt_pk_bf16_f32 v86, v54, v55
    v_cvt_pk_bf16_f32 v87, v56, v57
    v_cvt_pk_bf16_f32 v88, v58, v59
    v_cvt_pk_bf16_f32 v89, v60, v61
    v_mfma_f32_32x32x8_bf16 v[70:85], v[32:33], v[12:13], v[70:85]
    v_exp_f32 v62, v62
    v_exp_f32 v63, v63
    v_exp_f32 v64, v64
    v_exp_f32 v65, v65
    v_exp_f32 v66, v66
    v_exp_f32 v67, v67
    v_mfma_f32_32x32x16_bf16 v[94:109], v[38:41], v[86:89], v[94:109]
    v_exp_f32 v68, v68
    v_exp_f32 v69, v69
    v_cvt_pk_bf16_f32 v90, v62, v63
    v_cvt_pk_bf16_f32 v91, v64, v65
    v_cvt_pk_bf16_f32 v92, v66, v67
    v_cvt_pk_bf16_f32 v93, v68, v69
    s_waitcnt lgkmcnt(0)
    v_mfma_f32_32x32x16_bf16 v[54:69], v[22:25], v[8:11], 0
    v_exp_f32 v70, v70
    v_exp_f32 v71, v71
    v_exp_f32 v72, v72
    v_exp_f32 v73, v73
    v_exp_f32 v74, v74
    v_exp_f32 v75, v75
    v_mfma_f32_32x32x16_bf16 v[94:109], v[46:49], v[90:93], v[94:109]
    ds_read_b128 v[26:29], v110 offset:3072
    s_mov_b64 exec, s[60:61]
    ds_read_b128 v[38:41], v111 offset:2560
    ds_read_b128 v[46:49], v111 offset:3200
    s_mov_b64 exec, -1
    v_exp_f32 v76, v76
    v_exp_f32 v77, v77
    v_cvt_pk_bf16_f32 v86, v70, v71
    v_cvt_pk_bf16_f32 v87, v72, v73
    v_cvt_pk_bf16_f32 v88, v74, v75
    v_cvt_pk_bf16_f32 v89, v76, v77
    v_mfma_f32_32x32x8_bf16 v[54:69], v[30:31], v[14:15], v[54:69]
    v_exp_f32 v78, v78
    v_exp_f32 v79, v79
    v_exp_f32 v80, v80
    v_exp_f32 v81, v81
    v_exp_f32 v82, v82
    v_exp_f32 v83, v83
    v_mfma_f32_32x32x16_bf16 v[94:109], v[42:45], v[86:89], v[94:109]
    v_exp_f32 v84, v84
    v_exp_f32 v85, v85
    v_cvt_pk_bf16_f32 v90, v78, v79
    v_cvt_pk_bf16_f32 v91, v80, v81
    v_cvt_pk_bf16_f32 v92, v82, v83
    v_cvt_pk_bf16_f32 v93, v84, v85
    s_waitcnt lgkmcnt(0)
    v_mfma_f32_32x32x16_bf16 v[70:85], v[26:29], v[8:11], 0
    v_exp_f32 v54, v54
    v_exp_f32 v55, v55
    v_exp_f32 v56, v56
    v_exp_f32 v57, v57
    v_exp_f32 v58, v58
    v_exp_f32 v59, v59
    v_mfma_f32_32x32x16_bf16 v[94:109], v[50:53], v[90:93], v[94:109]
    ds_read_b128 v[22:25], v110 offset:4096
    ds_read_b128 v[34:37], v110 offset:9216
    s_mov_b64 exec, s[60:61]
    ds_read_b128 v[42:45], v111 offset:3840
    ds_read_b128 v[50:53], v111 offset:4480
    s_mov_b64 exec, -1
    v_exp_f32 v60, v60
    v_exp_f32 v61, v61
    v_cvt_pk_bf16_f32 v86, v54, v55
    v_cvt_pk_bf16_f32 v87, v56, v57
    v_cvt_pk_bf16_f32 v88, v58, v59
    v_cvt_pk_bf16_f32 v89, v60, v61
    v_mfma_f32_32x32x8_bf16 v[70:85], v[32:33], v[14:15], v[70:85]
    v_exp_f32 v62, v62
    v_exp_f32 v63, v63
    v_exp_f32 v64, v64
    v_exp_f32 v65, v65
    v_exp_f32 v66, v66
    v_exp_f32 v67, v67
    v_mfma_f32_32x32x16_bf16 v[94:109], v[38:41], v[86:89], v[94:109]
    v_exp_f32 v68, v68
    v_exp_f32 v69, v69
    v_cvt_pk_bf16_f32 v90, v62, v63
    v_cvt_pk_bf16_f32 v91, v64, v65
    v_cvt_pk_bf16_f32 v92, v66, v67
    v_cvt_pk_bf16_f32 v93, v68, v69
    s_waitcnt lgkmcnt(0)
    v_mfma_f32_32x32x16_bf16 v[54:69], v[22:25], v[8:11], 0
    v_exp_f32 v70, v70
    v_exp_f32 v71, v71
    v_exp_f32 v72, v72
    v_exp_f32 v73, v73
    v_exp_f32 v74, v74
    v_exp_f32 v75, v75
    v_mfma_f32_32x32x16_bf16 v[94:109], v[46:49], v[90:93], v[94:109]
    ds_read_b128 v[26:29], v110 offset:5120
    s_mov_b64 exec, s[60:61]
    ds_read_b128 v[38:41], v111 offset:5120
    ds_read_b128 v[46:49], v111 offset:5760
    s_mov_b64 exec, -1
    v_exp_f32 v76, v76
    v_exp_f32 v77, v77
    v_cvt_pk_bf16_f32 v86, v70, v71
    v_cvt_pk_bf16_f32 v87, v72, v73
    v_cvt_pk_bf16_f32 v88, v74, v75
    v_cvt_pk_bf16_f32 v89, v76, v77
    v_mfma_f32_32x32x8_bf16 v[54:69], v[34:35], v[12:13], v[54:69]
    v_exp_f32 v78, v78
    v_exp_f32 v79, v79
    v_exp_f32 v80, v80
    v_exp_f32 v81, v81
    v_exp_f32 v82, v82
    v_exp_f32 v83, v83
    v_mfma_f32_32x32x16_bf16 v[94:109], v[42:45], v[86:89], v[94:109]
    v_exp_f32 v84, v84
    v_exp_f32 v85, v85
    v_cvt_pk_bf16_f32 v90, v78, v79
    v_cvt_pk_bf16_f32 v91, v80, v81
    v_cvt_pk_bf16_f32 v92, v82, v83
    v_cvt_pk_bf16_f32 v93, v84, v85
    s_waitcnt lgkmcnt(0)
    v_mfma_f32_32x32x16_bf16 v[70:85], v[26:29], v[8:11], 0
    v_exp_f32 v54, v54
    v_exp_f32 v55, v55
    v_exp_f32 v56, v56
    v_exp_f32 v57, v57
    v_exp_f32 v58, v58
    v_exp_f32 v59, v59
    v_mfma_f32_32x32x16_bf16 v[94:109], v[50:53], v[90:93], v[94:109]
    ds_read_b128 v[22:25], v110 offset:6144
    s_mov_b64 exec, s[60:61]
    ds_read_b128 v[42:45], v111 offset:6400
    ds_read_b128 v[50:53], v111 offset:7040
    s_mov_b64 exec, -1
    v_exp_f32 v60, v60
    v_exp_f32 v61, v61
    v_cvt_pk_bf16_f32 v86, v54, v55
    v_cvt_pk_bf16_f32 v87, v56, v57
    v_cvt_pk_bf16_f32 v88, v58, v59
    v_cvt_pk_bf16_f32 v89, v60, v61
    v_mfma_f32_32x32x8_bf16 v[70:85], v[36:37], v[12:13], v[70:85]
    v_exp_f32 v62, v62
    v_exp_f32 v63, v63
    v_exp_f32 v64, v64
    v_exp_f32 v65, v65
    v_exp_f32 v66, v66
    v_exp_f32 v67, v67
    v_mfma_f32_32x32x16_bf16 v[94:109], v[38:41], v[86:89], v[94:109]
    v_exp_f32 v68, v68
    v_exp_f32 v69, v69
    v_cvt_pk_bf16_f32 v90, v62, v63
    v_cvt_pk_bf16_f32 v91, v64, v65
    v_cvt_pk_bf16_f32 v92, v66, v67
    v_cvt_pk_bf16_f32 v93, v68, v69
    s_waitcnt lgkmcnt(0)
    v_mfma_f32_32x32x16_bf16 v[54:69], v[22:25], v[8:11], 0
    v_exp_f32 v70, v70
    v_exp_f32 v71, v71
    v_exp_f32 v72, v72
    v_exp_f32 v73, v73
    v_exp_f32 v74, v74
    v_exp_f32 v75, v75
    v_mfma_f32_32x32x16_bf16 v[94:109], v[46:49], v[90:93], v[94:109]
    ds_read_b128 v[26:29], v110 offset:7168
    s_mov_b64 exec, s[60:61]
    ds_read_b128 v[38:41], v111 offset:7680
    ds_read_b128 v[46:49], v111 offset:8320
    s_mov_b64 exec, -1
    v_exp_f32 v76, v76
    v_exp_f32 v77, v77
    v_cvt_pk_bf16_f32 v86, v70, v71
    v_cvt_pk_bf16_f32 v87, v72, v73
    v_cvt_pk_bf16_f32 v88, v74, v75
    v_cvt_pk_bf16_f32 v89, v76, v77
    v_mfma_f32_32x32x8_bf16 v[54:69], v[34:35], v[14:15], v[54:69]
    v_exp_f32 v78, v78
    v_exp_f32 v79, v79
    v_exp_f32 v80, v80
    v_exp_f32 v81, v81
    v_exp_f32 v82, v82
    v_exp_f32 v83, v83
    v_mfma_f32_32x32x16_bf16 v[94:109], v[42:45], v[86:89], v[94:109]
    v_exp_f32 v84, v84
    v_exp_f32 v85, v85
    v_cvt_pk_bf16_f32 v90, v78, v79
    v_cvt_pk_bf16_f32 v91, v80, v81
    v_cvt_pk_bf16_f32 v92, v82, v83
    v_cvt_pk_bf16_f32 v93, v84, v85
    s_waitcnt lgkmcnt(0)
    v_mfma_f32_32x32x16_bf16 v[70:85], v[26:29], v[8:11], 0
    v_exp_f32 v54, v54
    v_exp_f32 v55, v55
    v_exp_f32 v56, v56
    v_exp_f32 v57, v57
    v_exp_f32 v58, v58
    v_exp_f32 v59, v59
    v_mfma_f32_32x32x16_bf16 v[94:109], v[50:53], v[90:93], v[94:109]
    ds_read_b128 v[22:25], v110 offset:20480
    ds_read_b128 v[30:33], v110 offset:28672
    s_mov_b64 exec, s[60:61]
    ds_read_b128 v[42:45], v111 offset:8960
    ds_read_b128 v[50:53], v111 offset:9600
    s_mov_b64 exec, -1
    v_exp_f32 v60, v60
    v_exp_f32 v61, v61
    v_cvt_pk_bf16_f32 v86, v54, v55
    v_cvt_pk_bf16_f32 v87, v56, v57
    v_cvt_pk_bf16_f32 v88, v58, v59
    v_cvt_pk_bf16_f32 v89, v60, v61
    v_mfma_f32_32x32x8_bf16 v[70:85], v[36:37], v[14:15], v[70:85]
    v_exp_f32 v62, v62
    v_exp_f32 v63, v63
    v_exp_f32 v64, v64
    v_exp_f32 v65, v65
    v_exp_f32 v66, v66
    v_exp_f32 v67, v67
    v_mfma_f32_32x32x16_bf16 v[94:109], v[38:41], v[86:89], v[94:109]
    v_exp_f32 v68, v68
    v_exp_f32 v69, v69
    v_cvt_pk_bf16_f32 v90, v62, v63
    v_cvt_pk_bf16_f32 v91, v64, v65
    v_cvt_pk_bf16_f32 v92, v66, v67
    v_cvt_pk_bf16_f32 v93, v68, v69
    s_waitcnt lgkmcnt(0)
    v_mfma_f32_32x32x16_bf16 v[54:69], v[22:25], v[8:11], 0
    v_exp_f32 v70, v70
    v_exp_f32 v71, v71
    v_exp_f32 v72, v72
    v_exp_f32 v73, v73
    v_exp_f32 v74, v74
    v_exp_f32 v75, v75
    v_mfma_f32_32x32x16_bf16 v[94:109], v[46:49], v[90:93], v[94:109]
    ds_read_b128 v[26:29], v110 offset:21504
    s_mov_b64 exec, s[60:61]
    ds_read_b128 v[38:41], v111 offset:20480
    ds_read_b128 v[46:49], v111 offset:21120
    s_mov_b64 exec, -1
    v_exp_f32 v76, v76
    v_exp_f32 v77, v77
    v_cvt_pk_bf16_f32 v86, v70, v71
    v_cvt_pk_bf16_f32 v87, v72, v73
    v_cvt_pk_bf16_f32 v88, v74, v75
    v_cvt_pk_bf16_f32 v89, v76, v77
    v_mfma_f32_32x32x8_bf16 v[54:69], v[30:31], v[12:13], v[54:69]
    v_exp_f32 v78, v78
    v_exp_f32 v79, v79
    v_exp_f32 v80, v80
    v_exp_f32 v81, v81
    v_exp_f32 v82, v82
    v_exp_f32 v83, v83
    v_mfma_f32_32x32x16_bf16 v[94:109], v[42:45], v[86:89], v[94:109]
    v_exp_f32 v84, v84
    v_exp_f32 v85, v85
    v_cvt_pk_bf16_f32 v90, v78, v79
    v_cvt_pk_bf16_f32 v91, v80, v81
    v_cvt_pk_bf16_f32 v92, v82, v83
    v_cvt_pk_bf16_f32 v93, v84, v85
    v_add_u32 v110, 20480, v110
    v_add_u32 v111, 20480, v111
    s_sub_u32 s64, s64, 1
    s_cmp_lg_u32 s64, 0
    s_cbranch_scc1 sequential_preLN__grouped_kv_mqa__dense_activation_silu__prompt_kernel_l2
    s_setprio 0
    s_mov_b32 s64, 3
.p2align 6
sequential_preLN__grouped_kv_mqa__dense_activation_silu__prompt_kernel_l3:
    s_waitcnt lgkmcnt(0)
    v_mfma_f32_32x32x16_bf16 v[70:85], v[26:29], v[8:11], 0
    v_exp_f32 v54, v54
    v_exp_f32 v55, v55
    v_exp_f32 v56, v56
    v_exp_f32 v57, v57
    v_exp_f32 v58, v58
    v_exp_f32 v59, v59
    v_mfma_f32_32x32x16_bf16 v[94:109], v[50:53], v[90:93], v[94:109]
    ds_read_b128 v[22:25], v110 offset:2048
    s_mov_b64 exec, s[60:61]
    ds_read_b128 v[42:45], v111 offset:1280
    ds_read_b128 v[50:53], v111 offset:1920
    s_mov_b64 exec, -1
    v_exp_f32 v60, v60
    v_exp_f32 v61, v61
    v_cvt_pk_bf16_f32 v86, v54, v55
    v_cvt_pk_bf16_f32 v87, v56, v57
    v_cvt_pk_bf16_f32 v88, v58, v59
    v_cvt_pk_bf16_f32 v89, v60, v61
    v_mfma_f32_32x32x8_bf16 v[70:85], v[32:33], v[12:13], v[70:85]
    v_exp_f32 v62, v62
    v_exp_f32 v63, v63
    v_exp_f32 v64, v64
    v_exp_f32 v65, v65
    v_exp_f32 v66, v66
    v_exp_f32 v67, v67
    v_mfma_f32_32x32x16_bf16 v[94:109], v[38:41], v[86:89], v[94:109]
    v_exp_f32 v68, v68
    v_exp_f32 v69, v69
    v_cvt_pk_bf16_f32 v90, v62, v63
    v_cvt_pk_bf16_f32 v91, v64, v65
    v_cvt_pk_bf16_f32 v92, v66, v67
    v_cvt_pk_bf16_f32 v93, v68, v69
    s_waitcnt lgkmcnt(0)
    v_mfma_f32_32x32x16_bf16 v[54:69], v[22:25], v[8:11], 0
    v_exp_f32 v70, v70
    v_exp_f32 v71, v71
    v_exp_f32 v72, v72
    v_exp_f32 v73, v73
    v_exp_f32 v74, v74
    v_exp_f32 v75, v75
    v_mfma_f32_32x32x16_bf16 v[94:109], v[46:49], v[90:93], v[94:109]
    ds_read_b128 v[26:29], v110 offset:3072
    s_mov_b64 exec, s[60:61]
    ds_read_b128 v[38:41], v111 offset:2560
    ds_read_b128 v[46:49], v111 offset:3200
    s_mov_b64 exec, -1
    v_exp_f32 v76, v76
    v_exp_f32 v77, v77
    v_cvt_pk_bf16_f32 v86, v70, v71
    v_cvt_pk_bf16_f32 v87, v72, v73
    v_cvt_pk_bf16_f32 v88, v74, v75
    v_cvt_pk_bf16_f32 v89, v76, v77
    v_mfma_f32_32x32x8_bf16 v[54:69], v[30:31], v[14:15], v[54:69]
    v_exp_f32 v78, v78
    v_exp_f32 v79, v79
    v_exp_f32 v80, v80
    v_exp_f32 v81, v81
    v_exp_f32 v82, v82
    v_exp_f32 v83, v83
    v_mfma_f32_32x32x16_bf16 v[94:109], v[42:45], v[86:89], v[94:109]
    v_exp_f32 v84, v84
    v_exp_f32 v85, v85
    v_cvt_pk_bf16_f32 v90, v78, v79
    v_cvt_pk_bf16_f32 v91, v80, v81
    v_cvt_pk_bf16_f32 v92, v82, v83
    v_cvt_pk_bf16_f32 v93, v84, v85
    s_waitcnt lgkmcnt(0)
    v_mfma_f32_32x32x16_bf16 v[70:85], v[26:29], v[8:11], 0
    v_exp_f32 v54, v54
    v_exp_f32 v55, v55
    v_exp_f32 v56, v56
    v_exp_f32 v57, v57
    v_exp_f32 v58, v58
    v_exp_f32 v59, v59
    v_mfma_f32_32x32x16_bf16 v[94:109], v[50:53], v[90:93], v[94:109]
    ds_read_b128 v[22:25], v110 offset:4096
    ds_read_b128 v[34:37], v110 offset:9216
    s_mov_b64 exec, s[60:61]
    ds_read_b128 v[42:45], v111 offset:3840
    ds_read_b128 v[50:53], v111 offset:4480
    s_mov_b64 exec, -1
    v_exp_f32 v60, v60
    v_exp_f32 v61, v61
    v_cvt_pk_bf16_f32 v86, v54, v55
    v_cvt_pk_bf16_f32 v87, v56, v57
    v_cvt_pk_bf16_f32 v88, v58, v59
    v_cvt_pk_bf16_f32 v89, v60, v61
    v_mfma_f32_32x32x8_bf16 v[70:85], v[32:33], v[14:15], v[70:85]
    v_exp_f32 v62, v62
    v_exp_f32 v63, v63
    v_exp_f32 v64, v64
    v_exp_f32 v65, v65
    v_exp_f32 v66, v66
    v_exp_f32 v67, v67
    v_mfma_f32_32x32x16_bf16 v[94:109], v[38:41], v[86:89], v[94:109]
    v_exp_f32 v68, v68
    v_exp_f32 v69, v69
    v_cvt_pk_bf16_f32 v90, v62, v63
    v_cvt_pk_bf16_f32 v91, v64, v65
    v_cvt_pk_bf16_f32 v92, v66, v67
    v_cvt_pk_bf16_f32 v93, v68, v69
    s_waitcnt lgkmcnt(0)
    v_mfma_f32_32x32x16_bf16 v[54:69], v[22:25], v[8:11], 0
    v_exp_f32 v70, v70
    v_exp_f32 v71, v71
    v_exp_f32 v72, v72
    v_exp_f32 v73, v73
    v_exp_f32 v74, v74
    v_exp_f32 v75, v75
    v_mfma_f32_32x32x16_bf16 v[94:109], v[46:49], v[90:93], v[94:109]
    ds_read_b128 v[26:29], v110 offset:5120
    s_mov_b64 exec, s[60:61]
    ds_read_b128 v[38:41], v111 offset:5120
    ds_read_b128 v[46:49], v111 offset:5760
    s_mov_b64 exec, -1
    v_exp_f32 v76, v76
    v_exp_f32 v77, v77
    v_cvt_pk_bf16_f32 v86, v70, v71
    v_cvt_pk_bf16_f32 v87, v72, v73
    v_cvt_pk_bf16_f32 v88, v74, v75
    v_cvt_pk_bf16_f32 v89, v76, v77
    v_mfma_f32_32x32x8_bf16 v[54:69], v[34:35], v[12:13], v[54:69]
    v_exp_f32 v78, v78
    v_exp_f32 v79, v79
    v_exp_f32 v80, v80
    v_exp_f32 v81, v81
    v_exp_f32 v82, v82
    v_exp_f32 v83, v83
    v_mfma_f32_32x32x16_bf16 v[94:109], v[42:45], v[86:89], v[94:109]
    v_exp_f32 v84, v84
    v_exp_f32 v85, v85
    v_cvt_pk_bf16_f32 v90, v78, v79
    v_cvt_pk_bf16_f32 v91, v80, v81
    v_cvt_pk_bf16_f32 v92, v82, v83
    v_cvt_pk_bf16_f32 v93, v84, v85
    s_waitcnt lgkmcnt(0)
    v_mfma_f32_32x32x16_bf16 v[70:85], v[26:29], v[8:11], 0
    v_exp_f32 v54, v54
    v_exp_f32 v55, v55
    v_exp_f32 v56, v56
    v_exp_f32 v57, v57
    v_exp_f32 v58, v58
    v_exp_f32 v59, v59
    v_mfma_f32_32x32x16_bf16 v[94:109], v[50:53], v[90:93], v[94:109]
    ds_read_b128 v[22:25], v110 offset:6144
    s_mov_b64 exec, s[60:61]
    ds_read_b128 v[42:45], v111 offset:6400
    ds_read_b128 v[50:53], v111 offset:7040
    s_mov_b64 exec, -1
    v_exp_f32 v60, v60
    v_exp_f32 v61, v61
    v_cvt_pk_bf16_f32 v86, v54, v55
    v_cvt_pk_bf16_f32 v87, v56, v57
    v_cvt_pk_bf16_f32 v88, v58, v59
    v_cvt_pk_bf16_f32 v89, v60, v61
    v_mfma_f32_32x32x8_bf16 v[70:85], v[36:37], v[12:13], v[70:85]
    v_exp_f32 v62, v62
    v_exp_f32 v63, v63
    v_exp_f32 v64, v64
    v_exp_f32 v65, v65
    v_exp_f32 v66, v66
    v_exp_f32 v67, v67
    v_mfma_f32_32x32x16_bf16 v[94:109], v[38:41], v[86:89], v[94:109]
    v_exp_f32 v68, v68
    v_exp_f32 v69, v69
    v_cvt_pk_bf16_f32 v90, v62, v63
    v_cvt_pk_bf16_f32 v91, v64, v65
    v_cvt_pk_bf16_f32 v92, v66, v67
    v_cvt_pk_bf16_f32 v93, v68, v69
    s_waitcnt lgkmcnt(0)
    v_mfma_f32_32x32x16_bf16 v[54:69], v[22:25], v[8:11], 0
    v_exp_f32 v70, v70
    v_exp_f32 v71, v71
    v_exp_f32 v72, v72
    v_exp_f32 v73, v73
    v_exp_f32 v74, v74
    v_exp_f32 v75, v75
    v_mfma_f32_32x32x16_bf16 v[94:109], v[46:49], v[90:93], v[94:109]
    ds_read_b128 v[26:29], v110 offset:7168
    s_mov_b64 exec, s[60:61]
    ds_read_b128 v[38:41], v111 offset:7680
    ds_read_b128 v[46:49], v111 offset:8320
    s_mov_b64 exec, -1
    v_exp_f32 v76, v76
    v_exp_f32 v77, v77
    v_cvt_pk_bf16_f32 v86, v70, v71
    v_cvt_pk_bf16_f32 v87, v72, v73
    v_cvt_pk_bf16_f32 v88, v74, v75
    v_cvt_pk_bf16_f32 v89, v76, v77
    v_mfma_f32_32x32x8_bf16 v[54:69], v[34:35], v[14:15], v[54:69]
    v_exp_f32 v78, v78
    v_exp_f32 v79, v79
    v_exp_f32 v80, v80
    v_exp_f32 v81, v81
    v_exp_f32 v82, v82
    v_exp_f32 v83, v83
    v_mfma_f32_32x32x16_bf16 v[94:109], v[42:45], v[86:89], v[94:109]
    v_exp_f32 v84, v84
    v_exp_f32 v85, v85
    v_cvt_pk_bf16_f32 v90, v78, v79
    v_cvt_pk_bf16_f32 v91, v80, v81
    v_cvt_pk_bf16_f32 v92, v82, v83
    v_cvt_pk_bf16_f32 v93, v84, v85
    s_waitcnt lgkmcnt(0)
    v_mfma_f32_32x32x16_bf16 v[70:85], v[26:29], v[8:11], 0
    v_exp_f32 v54, v54
    v_exp_f32 v55, v55
    v_exp_f32 v56, v56
    v_exp_f32 v57, v57
    v_exp_f32 v58, v58
    v_exp_f32 v59, v59
    v_mfma_f32_32x32x16_bf16 v[94:109], v[50:53], v[90:93], v[94:109]
    ds_read_b128 v[22:25], v110 offset:20480
    ds_read_b128 v[30:33], v110 offset:28672
    s_mov_b64 exec, s[60:61]
    ds_read_b128 v[42:45], v111 offset:8960
    ds_read_b128 v[50:53], v111 offset:9600
    s_mov_b64 exec, -1
    v_exp_f32 v60, v60
    v_exp_f32 v61, v61
    v_cvt_pk_bf16_f32 v86, v54, v55
    v_cvt_pk_bf16_f32 v87, v56, v57
    v_cvt_pk_bf16_f32 v88, v58, v59
    v_cvt_pk_bf16_f32 v89, v60, v61
    v_mfma_f32_32x32x8_bf16 v[70:85], v[36:37], v[14:15], v[70:85]
    v_exp_f32 v62, v62
    v_exp_f32 v63, v63
    v_exp_f32 v64, v64
    v_exp_f32 v65, v65
    v_exp_f32 v66, v66
    v_exp_f32 v67, v67
    v_mfma_f32_32x32x16_bf16 v[94:109], v[38:41], v[86:89], v[94:109]
    v_exp_f32 v68, v68
    v_exp_f32 v69, v69
    v_cvt_pk_bf16_f32 v90, v62, v63
    v_cvt_pk_bf16_f32 v91, v64, v65
    v_cvt_pk_bf16_f32 v92, v66, v67
    v_cvt_pk_bf16_f32 v93, v68, v69
    s_waitcnt lgkmcnt(0)
    v_mfma_f32_32x32x16_bf16 v[54:69], v[22:25], v[8:11], 0
    v_exp_f32 v70, v70
    v_exp_f32 v71, v71
    v_exp_f32 v72, v72
    v_exp_f32 v73, v73
    v_exp_f32 v74, v74
    v_exp_f32 v75, v75
    v_mfma_f32_32x32x16_bf16 v[94:109], v[46:49], v[90:93], v[94:109]
    ds_read_b128 v[26:29], v110 offset:21504
    s_mov_b64 exec, s[60:61]
    ds_read_b128 v[38:41], v111 offset:20480
    ds_read_b128 v[46:49], v111 offset:21120
    s_mov_b64 exec, -1
    v_exp_f32 v76, v76
    v_exp_f32 v77, v77
    v_cvt_pk_bf16_f32 v86, v70, v71
    v_cvt_pk_bf16_f32 v87, v72, v73
    v_cvt_pk_bf16_f32 v88, v74, v75
    v_cvt_pk_bf16_f32 v89, v76, v77
    v_mfma_f32_32x32x8_bf16 v[54:69], v[30:31], v[12:13], v[54:69]
    v_exp_f32 v78, v78
    v_exp_f32 v79, v79
    v_exp_f32 v80, v80
    v_exp_f32 v81, v81
    v_exp_f32 v82, v82
    v_exp_f32 v83, v83
    v_mfma_f32_32x32x16_bf16 v[94:109], v[42:45], v[86:89], v[94:109]
    v_exp_f32 v84, v84
    v_exp_f32 v85, v85
    v_cvt_pk_bf16_f32 v90, v78, v79
    v_cvt_pk_bf16_f32 v91, v80, v81
    v_cvt_pk_bf16_f32 v92, v82, v83
    v_cvt_pk_bf16_f32 v93, v84, v85
    v_add_u32 v110, 20480, v110
    v_add_u32 v111, 20480, v111
    s_sub_u32 s64, s64, 1
    s_cmp_lg_u32 s64, 0
    s_cbranch_scc1 sequential_preLN__grouped_kv_mqa__dense_activation_silu__prompt_kernel_l3
    s_nop 1
    v_mfma_f32_32x32x16_bf16 v[94:109], v[50:53], v[90:93], v[94:109]
    s_nop 7
    s_nop 7
    v_max3_f32 v4, |v94|, |v95|, |v96|
    v_max3_f32 v5, |v97|, |v98|, |v99|
    v_max3_f32 v6, |v100|, |v101|, |v102|
    v_max3_f32 v7, |v103|, |v104|, |v105|
    v_max3_f32 v4, v4, v5, v6
    v_max3_f32 v4, v4, v7, v106
    v_cmp_nle_f32 vcc, 0x12800000, v106
    s_mov_b64 s[56:57], vcc
    v_cmp_nge_f32 vcc, 0x7b800000, v4
    s_or_b64 s[56:57], vcc, s[56:57]
    s_cbranch_scc1 sequential_preLN__grouped_kv_mqa__dense_activation_silu__prompt_kernel_slow

sequential_preLN__grouped_kv_mqa__dense_activation_silu__prompt_kernel_store:
    v_rcp_f32 v4, v106
    s_lshr_b32 s40, s36, 2
    s_mul_i32 s40, s40, 80
    s_mul_i32 s41, s38, 10
    s_add_u32 s40, s40, s41
    s_bfe_u32 s41, s36, 0x10001
    s_mul_i32 s41, s41, 5
    s_add_u32 s40, s40, s41
    v_add_u32 v5, s40, v3
    v_and_b32 v6, 15, v2
    v_lshlrev_b32 v6, 4, v6
    v_lshrrev_b32 v7, 4, v2
    v_mul_u32_u24 v7, 20480, v7
    v_add_u32 v6, v6, v7
    s_lshl_b32 s41, s37, 2
    s_and_b32 s42, s36, 1
    s_lshl_b32 s42, s42, 1
    s_add_u32 s41, s41, s42
    s_mul_i32 s41, s41, 20480
    s_add_u32 s41, s41, 3145728

    v_mul_f32 v94, v4, v94
    v_mul_f32 v95, v4, v95
    v_mul_f32 v96, v4, v96
    v_mul_f32 v97, v4, v97
    v_mul_f32 v98, v4, v98
    v_mul_f32 v99, v4, v99
    v_mul_f32 v100, v4, v100
    v_mul_f32 v101, v4, v101
    v_mul_f32 v102, v4, v102
    v_mul_f32 v103, v4, v103
    v_mul_f32 v104, v4, v104
    v_mul_f32 v105, v4, v105
    v_add_u32 v7, 0, v5
    v_lshrrev_b32 v8, 3, v7
    v_lshl_add_u32 v8, v8, 10, v6
    v_and_b32 v9, 3, v7
    v_lshl_add_u32 v8, v9, 8, v8
    v_bfe_u32 v9, v7, 2, 1
    v_lshl_add_u32 v8, v9, 3, v8
    v_cvt_pk_bf16_f32 v86, v94, v95
    v_cvt_pk_bf16_f32 v87, v96, v97

    buffer_store_dwordx2 v[86:87], v8, s[16:19], s41 offen sc1
    v_add_u32 v7, 2, v5
    v_lshrrev_b32 v8, 3, v7
    v_lshl_add_u32 v8, v8, 10, v6
    v_and_b32 v9, 3, v7
    v_lshl_add_u32 v8, v9, 8, v8
    v_bfe_u32 v9, v7, 2, 1
    v_lshl_add_u32 v8, v9, 3, v8
    v_cvt_pk_bf16_f32 v88, v98, v99
    v_cvt_pk_bf16_f32 v89, v100, v101

    buffer_store_dwordx2 v[88:89], v8, s[16:19], s41 offen sc1
    v_add_u32 v7, 4, v5
    v_lshrrev_b32 v8, 3, v7
    v_lshl_add_u32 v8, v8, 10, v6
    v_and_b32 v9, 3, v7
    v_lshl_add_u32 v8, v9, 8, v8
    v_bfe_u32 v9, v7, 2, 1
    v_lshl_add_u32 v8, v9, 3, v8
    v_cvt_pk_bf16_f32 v90, v102, v103
    v_cvt_pk_bf16_f32 v91, v104, v105

    s_mov_b32 exec_hi, 0
    buffer_store_dwordx2 v[90:91], v8, s[16:19], s41 offen sc1
    s_mov_b32 exec_hi, -1
    v_mov_b32 v4, v112
    s_xor_b32 s36, s36, 4
    s_cmp_ge_u32 s36, 4
    s_cbranch_scc0 sequential_preLN__grouped_kv_mqa__dense_activation_silu__prompt_kernel_cons
    s_waitcnt vmcnt(0)

    v_mov_b32 v250, 0
    v_mov_b32 v251, 1
    s_mov_b64 exec, 1
    buffer_atomic_add v251, v250, s[16:19], s14 offen sc1
    s_mov_b64 exec, -1

    s_mov_b32 s18, 26214400
    s_sub_u32 s50, s36, 4
    s_mov_b32 s60, 0
    s_cmp_lt_u32 s50, 2
    s_cbranch_scc1 sequential_preLN__grouped_kv_mqa__dense_activation_silu__prompt_kernel_wo_x
    s_sub_u32 s50, s50, 2
    s_mul_i32 s50, s50, 5
    s_lshl_b32 s61, s50, 10
    s_add_u32 s61, s61, 57344
    s_mul_i32 s49, s38, 102400
    s_add_u32 s49, s49, 18874368

    s_add_u32 s51, s50, 0
    s_and_b32 s46, s51, 1
    s_lshr_b32 s51, s51, 1

    s_mul_i32 s43, s46, 5
    s_add_u32 s43, s43, s51
    s_lshl_b32 s43, s43, 10
    s_add_u32 s52, s43, s49
    s_mov_b32 s63, s46
    s_add_u32 s51, s50, 1
    s_and_b32 s46, s51, 1
    s_lshr_b32 s51, s51, 1

    s_mul_i32 s43, s46, 5
    s_add_u32 s43, s43, s51
    s_lshl_b32 s43, s43, 10
    s_add_u32 s53, s43, s49
    s_mov_b32 s64, s46
    s_add_u32 s51, s50, 2
    s_and_b32 s46, s51, 1
    s_lshr_b32 s51, s51, 1

    s_mul_i32 s43, s46, 5
    s_add_u32 s43, s43, s51
    s_lshl_b32 s43, s43, 10
    s_add_u32 s54, s43, s49
    s_mov_b32 s65, s46
    s_add_u32 s51, s50, 3
    s_and_b32 s46, s51, 1
    s_lshr_b32 s51, s51, 1

    s_mul_i32 s43, s46, 5
    s_add_u32 s43, s43, s51
    s_lshl_b32 s43, s43, 10
    s_add_u32 s55, s43, s49
    s_mov_b32 s66, s46
    s_add_u32 s51, s50, 4
    s_and_b32 s46, s51, 1
    s_lshr_b32 s51, s51, 1

    s_mul_i32 s43, s46, 5
    s_add_u32 s43, s43, s51
    s_lshl_b32 s43, s43, 10
    s_add_u32 s56, s43, s49
    s_mov_b32 s67, s46
    v_mov_b32 v250, 0
    s_mov_b32 s71, 0

sequential_preLN__grouped_kv_mqa__dense_activation_silu__prompt_kernel_poll2:
    buffer_load_dword v251, v250, s[16:19], s15 offen sc1
    s_add_u32 s71, s71, 1
    s_waitcnt vmcnt(0)
    v_readfirstlane_b32 s72, v251
    s_cmp_ge_u32 s72, 256
    s_cbranch_scc1 sequential_preLN__grouped_kv_mqa__dense_activation_silu__prompt_kernel_poll2_ok
    s_sleep 1
    s_cmp_lt_u32 s71, 200000
    s_cbranch_scc1 sequential_preLN__grouped_kv_mqa__dense_activation_silu__prompt_kernel_poll2

sequential_preLN__grouped_kv_mqa__dense_activation_silu__prompt_kernel_poll2_ok:
    s_barrier
    s_add_u32 m0, s61, 0
    s_add_u32 s42, s52, 0
    buffer_load_dwordx4 v4, s[16:19], s42 offen sc1 lds
    s_add_u32 m0, s61, 1024
    s_add_u32 s42, s53, 0
    buffer_load_dwordx4 v4, s[16:19], s42 offen sc1 lds
    s_add_u32 m0, s61, 2048
    s_add_u32 s42, s54, 0
    buffer_load_dwordx4 v4, s[16:19], s42 offen sc1 lds
    s_add_u32 m0, s61, 3072
    s_add_u32 s42, s55, 0
    buffer_load_dwordx4 v4, s[16:19], s42 offen sc1 lds
    s_add_u32 m0, s61, 4096
    s_add_u32 s42, s56, 0
    buffer_load_dwordx4 v4, s[16:19], s42 offen sc1 lds
    s_add_u32 m0, s61, 10240
    s_add_u32 s42, s52, 10240
    buffer_load_dwordx4 v4, s[16:19], s42 offen sc1 lds
    s_add_u32 m0, s61, 11264
    s_add_u32 s42, s53, 10240
    buffer_load_dwordx4 v4, s[16:19], s42 offen sc1 lds
    s_add_u32 m0, s61, 12288
    s_add_u32 s42, s54, 10240
    buffer_load_dwordx4 v4, s[16:19], s42 offen sc1 lds
    s_add_u32 m0, s61, 13312
    s_add_u32 s42, s55, 10240
    buffer_load_dwordx4 v4, s[16:19], s42 offen sc1 lds
    s_add_u32 m0, s61, 14336
    s_add_u32 s42, s56, 10240
    buffer_load_dwordx4 v4, s[16:19], s42 offen sc1 lds
    s_add_u32 m0, s61, 20480
    s_add_u32 s42, s52, 20480
    buffer_load_dwordx4 v4, s[16:19], s42 offen sc1 lds
    s_add_u32 m0, s61, 21504
    s_add_u32 s42, s53, 20480
    buffer_load_dwordx4 v4, s[16:19], s42 offen sc1 lds
    s_add_u32 m0, s61, 22528
    s_add_u32 s42, s54, 20480
    buffer_load_dwordx4 v4, s[16:19], s42 offen sc1 lds
    s_add_u32 m0, s61, 23552
    s_add_u32 s42, s55, 20480
    buffer_load_dwordx4 v4, s[16:19], s42 offen sc1 lds
    s_add_u32 m0, s61, 24576
    s_add_u32 s42, s56, 20480
    buffer_load_dwordx4 v4, s[16:19], s42 offen sc1 lds
    s_waitcnt vmcnt(10)
    s_barrier
    s_add_u32 m0, s61, 30720
    s_add_u32 s42, s52, 30720
    buffer_load_dwordx4 v4, s[16:19], s42 offen sc1 lds
    s_add_u32 m0, s61, 31744
    s_add_u32 s42, s53, 30720
    buffer_load_dwordx4 v4, s[16:19], s42 offen sc1 lds
    s_add_u32 m0, s61, 32768
    s_add_u32 s42, s54, 30720
    buffer_load_dwordx4 v4, s[16:19], s42 offen sc1 lds
    s_add_u32 m0, s61, 33792
    s_add_u32 s42, s55, 30720
    buffer_load_dwordx4 v4, s[16:19], s42 offen sc1 lds
    s_add_u32 m0, s61, 34816
    s_add_u32 s42, s56, 30720
    buffer_load_dwordx4 v4, s[16:19], s42 offen sc1 lds
    s_add_u32 m0, s61, 40960
    s_add_u32 s42, s52, 40960
    buffer_load_dwordx4 v4, s[16:19], s42 offen sc1 lds
    s_add_u32 m0, s61, 41984
    s_add_u32 s42, s53, 40960
    buffer_load_dwordx4 v4, s[16:19], s42 offen sc1 lds
    s_add_u32 m0, s61, 43008
    s_add_u32 s42, s54, 40960
    buffer_load_dwordx4 v4, s[16:19], s42 offen sc1 lds
    s_add_u32 m0, s61, 44032
    s_add_u32 s42, s55, 40960
    buffer_load_dwordx4 v4, s[16:19], s42 offen sc1 lds
    s_add_u32 m0, s61, 45056
    s_add_u32 s42, s56, 40960
    buffer_load_dwordx4 v4, s[16:19], s42 offen sc1 lds
    s_waitcnt vmcnt(15)
    s_barrier
    s_add_u32 m0, s61, 51200
    s_add_u32 s42, s52, 51200
    buffer_load_dwordx4 v4, s[16:19], s42 offen sc1 lds
    s_add_u32 m0, s61, 52224
    s_add_u32 s42, s53, 51200
    buffer_load_dwordx4 v4, s[16:19], s42 offen sc1 lds
    s_add_u32 m0, s61, 53248
    s_add_u32 s42, s54, 51200
    buffer_load_dwordx4 v4, s[16:19], s42 offen sc1 lds
    s_add_u32 m0, s61, 54272
    s_add_u32 s42, s55, 51200
    buffer_load_dwordx4 v4, s[16:19], s42 offen sc1 lds
    s_add_u32 m0, s61, 55296
    s_add_u32 s42, s56, 51200
    buffer_load_dwordx4 v4, s[16:19], s42 offen sc1 lds
    s_add_u32 m0, s61, 61440
    s_add_u32 s42, s52, 61440
    buffer_load_dwordx4 v4, s[16:19], s42 offen sc1 lds
    s_add_u32 m0, s61, 62464
    s_add_u32 s42, s53, 61440
    buffer_load_dwordx4 v4, s[16:19], s42 offen sc1 lds
    s_add_u32 m0, s61, 63488
    s_add_u32 s42, s54, 61440
    buffer_load_dwordx4 v4, s[16:19], s42 offen sc1 lds
    s_add_u32 m0, s61, 64512
    s_add_u32 s42, s55, 61440
    buffer_load_dwordx4 v4, s[16:19], s42 offen sc1 lds
    s_add_u32 m0, s61, 65536
    s_add_u32 s42, s56, 61440
    buffer_load_dwordx4 v4, s[16:19], s42 offen sc1 lds
    s_waitcnt vmcnt(20)
    s_barrier
    s_add_u32 m0, s61, 0
    s_add_u32 s42, s52, 71680
    buffer_load_dwordx4 v4, s[16:19], s42 offen sc1 lds
    s_add_u32 m0, s61, 1024
    s_add_u32 s42, s53, 71680
    buffer_load_dwordx4 v4, s[16:19], s42 offen sc1 lds
    s_add_u32 m0, s61, 2048
    s_add_u32 s42, s54, 71680
    buffer_load_dwordx4 v4, s[16:19], s42 offen sc1 lds
    s_add_u32 m0, s61, 3072
    s_add_u32 s42, s55, 71680
    buffer_load_dwordx4 v4, s[16:19], s42 offen sc1 lds
    s_add_u32 m0, s61, 4096
    s_add_u32 s42, s56, 71680
    buffer_load_dwordx4 v4, s[16:19], s42 offen sc1 lds
    s_add_u32 m0, s61, 10240
    s_add_u32 s42, s52, 81920
    buffer_load_dwordx4 v4, s[16:19], s42 offen sc1 lds
    s_add_u32 m0, s61, 11264
    s_add_u32 s42, s53, 81920
    buffer_load_dwordx4 v4, s[16:19], s42 offen sc1 lds
    s_add_u32 m0, s61, 12288
    s_add_u32 s42, s54, 81920
    buffer_load_dwordx4 v4, s[16:19], s42 offen sc1 lds
    s_add_u32 m0, s61, 13312
    s_add_u32 s42, s55, 81920
    buffer_load_dwordx4 v4, s[16:19], s42 offen sc1 lds
    s_add_u32 m0, s61, 14336
    s_add_u32 s42, s56, 81920
    buffer_load_dwordx4 v4, s[16:19], s42 offen sc1 lds
    s_waitcnt vmcnt(25)
    s_barrier
    s_add_u32 m0, s61, 20480
    s_add_u32 s42, s52, 92160
    buffer_load_dwordx4 v4, s[16:19], s42 offen sc1 lds
    s_add_u32 m0, s61, 21504
    s_add_u32 s42, s53, 92160
    buffer_load_dwordx4 v4, s[16:19], s42 offen sc1 lds
    s_add_u32 m0, s61, 22528
    s_add_u32 s42, s54, 92160
    buffer_load_dwordx4 v4, s[16:19], s42 offen sc1 lds
    s_add_u32 m0, s61, 23552
    s_add_u32 s42, s55, 92160
    buffer_load_dwordx4 v4, s[16:19], s42 offen sc1 lds
    s_add_u32 m0, s61, 24576
    s_add_u32 s42, s56, 92160
    buffer_load_dwordx4 v4, s[16:19], s42 offen sc1 lds
    s_waitcnt vmcnt(25)
    s_barrier
    s_waitcnt vmcnt(20)
    s_barrier
    s_waitcnt vmcnt(15)
    s_barrier
    s_waitcnt vmcnt(10)
    s_barrier
    s_waitcnt vmcnt(5)
    s_barrier
    s_waitcnt vmcnt(0)
    s_barrier
    s_branch sequential_preLN__grouped_kv_mqa__dense_activation_silu__prompt_kernel_wo_done
sequential_preLN__grouped_kv_mqa__dense_activation_silu__prompt_kernel_wo_x:
    s_lshl_b32 s61, s50, 12
    s_lshl_b32 s42, s37, 2
    s_lshl_b32 s43, s50, 1
    s_add_u32 s42, s42, s43
    s_mul_i32 s52, s42, 20480
    s_add_u32 s52, s52, 3145728
    s_add_u32 s53, s52, 1024
    s_add_u32 s54, s52, 20480
    s_add_u32 s55, s54, 1024
    s_mov_b32 s63, 0
    s_mov_b32 s64, 1
    s_mov_b32 s65, 0
    s_mov_b32 s66, 1

    v_mov_b32 v250, 0
    s_mov_b32 s71, 0

sequential_preLN__grouped_kv_mqa__dense_activation_silu__prompt_kernel_poll3:
    buffer_load_dword v251, v250, s[16:19], s14 offen sc1
    s_add_u32 s71, s71, 1
    s_waitcnt vmcnt(0)
    v_readfirstlane_b32 s72, v251
    s_cmp_ge_u32 s72, 32
    s_cbranch_scc1 sequential_preLN__grouped_kv_mqa__dense_activation_silu__prompt_kernel_poll3_ok
    s_sleep 1
    s_cmp_lt_u32 s71, 200000
    s_cbranch_scc1 sequential_preLN__grouped_kv_mqa__dense_activation_silu__prompt_kernel_poll3

sequential_preLN__grouped_kv_mqa__dense_activation_silu__prompt_kernel_poll3_ok:
    s_barrier
    s_add_u32 m0, s61, 0
    s_add_u32 s42, s52, 0
    buffer_load_dwordx4 v4, s[16:19], s42 offen sc1 lds
    s_add_u32 m0, s61, 1024
    s_add_u32 s42, s53, 0
    buffer_load_dwordx4 v4, s[16:19], s42 offen sc1 lds
    s_add_u32 m0, s61, 2048
    s_add_u32 s42, s54, 0
    buffer_load_dwordx4 v4, s[16:19], s42 offen sc1 lds
    s_add_u32 m0, s61, 3072
    s_add_u32 s42, s55, 0
    buffer_load_dwordx4 v4, s[16:19], s42 offen sc1 lds
    s_add_u32 m0, s61, 8192
    s_add_u32 s42, s52, 2048
    buffer_load_dwordx4 v4, s[16:19], s42 offen sc1 lds
    s_add_u32 m0, s61, 9216
    s_add_u32 s42, s53, 2048
    buffer_load_dwordx4 v4, s[16:19], s42 offen sc1 lds
    s_add_u32 m0, s61, 10240
    s_add_u32 s42, s54, 2048
    buffer_load_dwordx4 v4, s[16:19], s42 offen sc1 lds
    s_add_u32 m0, s61, 11264
    s_add_u32 s42, s55, 2048
    buffer_load_dwordx4 v4, s[16:19], s42 offen sc1 lds
    s_add_u32 m0, s61, 16384
    s_add_u32 s42, s52, 4096
    buffer_load_dwordx4 v4, s[16:19], s42 offen sc1 lds
    s_add_u32 m0, s61, 17408
    s_add_u32 s42, s53, 4096
    buffer_load_dwordx4 v4, s[16:19], s42 offen sc1 lds
    s_add_u32 m0, s61, 18432
    s_add_u32 s42, s54, 4096
    buffer_load_dwordx4 v4, s[16:19], s42 offen sc1 lds
    s_add_u32 m0, s61, 19456
    s_add_u32 s42, s55, 4096
    buffer_load_dwordx4 v4, s[16:19], s42 offen sc1 lds
    s_waitcnt vmcnt(8)
    s_barrier
    s_add_u32 m0, s61, 24576
    s_add_u32 s42, s52, 6144
    buffer_load_dwordx4 v4, s[16:19], s42 offen sc1 lds
    s_add_u32 m0, s61, 25600
    s_add_u32 s42, s53, 6144
    buffer_load_dwordx4 v4, s[16:19], s42 offen sc1 lds
    s_add_u32 m0, s61, 26624
    s_add_u32 s42, s54, 6144
    buffer_load_dwordx4 v4, s[16:19], s42 offen sc1 lds
    s_add_u32 m0, s61, 27648
    s_add_u32 s42, s55, 6144
    buffer_load_dwordx4 v4, s[16:19], s42 offen sc1 lds
    s_add_u32 m0, s61, 32768
    s_add_u32 s42, s52, 8192
    buffer_load_dwordx4 v4, s[16:19], s42 offen sc1 lds
    s_add_u32 m0, s61, 33792
    s_add_u32 s42, s53, 8192
    buffer_load_dwordx4 v4, s[16:19], s42 offen sc1 lds
    s_add_u32 m0, s61, 34816
    s_add_u32 s42, s54, 8192
    buffer_load_dwordx4 v4, s[16:19], s42 offen sc1 lds
    s_add_u32 m0, s61, 35840
    s_add_u32 s42, s55, 8192
    buffer_load_dwordx4 v4, s[16:19], s42 offen sc1 lds
    s_waitcnt vmcnt(12)
    s_barrier
    s_add_u32 s42, s14, 20480
    v_mov_b32 v250, 0
    s_mov_b32 s71, 0

sequential_preLN__grouped_kv_mqa__dense_activation_silu__prompt_kernel_poll4:
    buffer_load_dword v251, v250, s[16:19], s42 offen sc1
    s_add_u32 s71, s71, 1
    s_waitcnt vmcnt(0)
    v_readfirstlane_b32 s72, v251
    s_cmp_ge_u32 s72, 8
    s_cbranch_scc1 sequential_preLN__grouped_kv_mqa__dense_activation_silu__prompt_kernel_poll4_ok
    s_sleep 1
    s_cmp_lt_u32 s71, 200000
    s_cbranch_scc1 sequential_preLN__grouped_kv_mqa__dense_activation_silu__prompt_kernel_poll4

sequential_preLN__grouped_kv_mqa__dense_activation_silu__prompt_kernel_poll4_ok:
    s_add_u32 m0, s61, 40960
    s_add_u32 s42, s52, 10240
    buffer_load_dwordx4 v4, s[16:19], s42 offen sc1 lds
    s_add_u32 m0, s61, 41984
    s_add_u32 s42, s53, 10240
    buffer_load_dwordx4 v4, s[16:19], s42 offen sc1 lds
    s_add_u32 m0, s61, 43008
    s_add_u32 s42, s54, 10240
    buffer_load_dwordx4 v4, s[16:19], s42 offen sc1 lds
    s_add_u32 m0, s61, 44032
    s_add_u32 s42, s55, 10240
    buffer_load_dwordx4 v4, s[16:19], s42 offen sc1 lds
    s_add_u32 m0, s61, 49152
    s_add_u32 s42, s52, 12288
    buffer_load_dwordx4 v4, s[16:19], s42 offen sc1 lds
    s_add_u32 m0, s61, 50176
    s_add_u32 s42, s53, 12288
    buffer_load_dwordx4 v4, s[16:19], s42 offen sc1 lds
    s_add_u32 m0, s61, 51200
    s_add_u32 s42, s54, 12288
    buffer_load_dwordx4 v4, s[16:19], s42 offen sc1 lds
    s_add_u32 m0, s61, 52224
    s_add_u32 s42, s55, 12288
    buffer_load_dwordx4 v4, s[16:19], s42 offen sc1 lds
    s_waitcnt vmcnt(16)
    s_barrier
    s_add_u32 m0, s61, 0
    s_add_u32 s42, s52, 14336
    buffer_load_dwordx4 v4, s[16:19], s42 offen sc1 lds
    s_add_u32 m0, s61, 1024
    s_add_u32 s42, s53, 14336
    buffer_load_dwordx4 v4, s[16:19], s42 offen sc1 lds
    s_add_u32 m0, s61, 2048
    s_add_u32 s42, s54, 14336
    buffer_load_dwordx4 v4, s[16:19], s42 offen sc1 lds
    s_add_u32 m0, s61, 3072
    s_add_u32 s42, s55, 14336
    buffer_load_dwordx4 v4, s[16:19], s42 offen sc1 lds
    s_add_u32 m0, s61, 8192
    s_add_u32 s42, s52, 16384
    buffer_load_dwordx4 v4, s[16:19], s42 offen sc1 lds
    s_add_u32 m0, s61, 9216
    s_add_u32 s42, s53, 16384
    buffer_load_dwordx4 v4, s[16:19], s42 offen sc1 lds
    s_add_u32 m0, s61, 10240
    s_add_u32 s42, s54, 16384
    buffer_load_dwordx4 v4, s[16:19], s42 offen sc1 lds
    s_add_u32 m0, s61, 11264
    s_add_u32 s42, s55, 16384
    buffer_load_dwordx4 v4, s[16:19], s42 offen sc1 lds
    s_waitcnt vmcnt(20)
    s_barrier
    s_add_u32 m0, s61, 16384
    s_add_u32 s42, s52, 18432
    buffer_load_dwordx4 v4, s[16:19], s42 offen sc1 lds
    s_add_u32 m0, s61, 17408
    s_add_u32 s42, s53, 18432
    buffer_load_dwordx4 v4, s[16:19], s42 offen sc1 lds
    s_add_u32 m0, s61, 18432
    s_add_u32 s42, s54, 18432
    buffer_load_dwordx4 v4, s[16:19], s42 offen sc1 lds
    s_add_u32 m0, s61, 19456
    s_add_u32 s42, s55, 18432
    buffer_load_dwordx4 v4, s[16:19], s42 offen sc1 lds
    s_waitcnt vmcnt(20)
    s_barrier
    s_waitcnt vmcnt(16)
    s_barrier
    s_waitcnt vmcnt(12)
    s_barrier
    s_waitcnt vmcnt(8)
    s_barrier
    s_waitcnt vmcnt(4)
    s_barrier
    s_waitcnt vmcnt(0)
    s_barrier
sequential_preLN__grouped_kv_mqa__dense_activation_silu__prompt_kernel_wo_done:
    s_barrier
    s_mul_i32 s42, s38, 7
    s_mul_i32 s43, s38, 6
    s_add_u32 s43, s43, 6
    s_cmp_lt_u32 s38, 6
    s_cselect_b32 s44, s42, s43
    s_cselect_b32 s45, 7, 6

    s_mov_b32 s18, 26214400
    s_sub_u32 s50, s36, 4
    s_mul_i32 s48, s44, 40960
    s_add_u32 s48, s48, 19922944
    s_mov_b32 s60, 0

    v_mov_b32 v250, 0
    s_mov_b32 s71, 0

sequential_preLN__grouped_kv_mqa__dense_activation_silu__prompt_kernel_poll5:
    buffer_load_dword v251, v250, s[16:19], s15 offen sc1
    s_add_u32 s71, s71, 1
    s_waitcnt vmcnt(0)
    v_readfirstlane_b32 s72, v251
    s_cmp_ge_u32 s72, 256
    s_cbranch_scc1 sequential_preLN__grouped_kv_mqa__dense_activation_silu__prompt_kernel_poll5_ok
    s_sleep 1
    s_cmp_lt_u32 s71, 200000
    s_cbranch_scc1 sequential_preLN__grouped_kv_mqa__dense_activation_silu__prompt_kernel_poll5

sequential_preLN__grouped_kv_mqa__dense_activation_silu__prompt_kernel_poll5_ok:
    s_cmp_lt_u32 s50, 2
    s_cbranch_scc1 sequential_preLN__grouped_kv_mqa__dense_activation_silu__prompt_kernel_f1x
    s_sub_u32 s51, s50, 2
    s_mul_i32 s51, s51, 3
    s_add_u32 s51, s51, 2
    s_mul_i32 s52, s51, 20480
    s_add_u32 s52, s52, s48
    s_add_u32 s53, s52, 20480
    s_add_u32 s54, s53, 20480
    s_lshl_b32 s55, s51, 11
    s_add_u32 s55, s55, 81920
    s_add_u32 s56, s55, 2048
    s_add_u32 s57, s55, 4096
    s_mov_b32 s58, 0
    s_mov_b32 s62, -1
    s_branch sequential_preLN__grouped_kv_mqa__dense_activation_silu__prompt_kernel_f1go

sequential_preLN__grouped_kv_mqa__dense_activation_silu__prompt_kernel_f1x:
    s_lshl_b32 s42, s37, 2
    s_lshl_b32 s43, s50, 1
    s_add_u32 s42, s42, s43
    s_mul_i32 s52, s42, 20480
    s_add_u32 s52, s52, 6291456
    s_add_u32 s53, s52, 20480
    s_mul_i32 s54, s50, 20480
    s_add_u32 s54, s54, s48
    s_mul_i32 s55, s50, 40960
    s_add_u32 s56, s55, 20480
    s_lshl_b32 s57, s50, 11
    s_add_u32 s57, s57, 81920
    s_movk_i32 s58, 2048
    s_mov_b32 s62, 0
    s_add_u32 s42, s14, 4096

    v_mov_b32 v250, 0
    s_mov_b32 s71, 0

sequential_preLN__grouped_kv_mqa__dense_activation_silu__prompt_kernel_poll6:
    buffer_load_dword v251, v250, s[16:19], s42 offen sc1
    s_add_u32 s71, s71, 1
    s_waitcnt vmcnt(0)
    v_readfirstlane_b32 s72, v251
    s_cmp_ge_u32 s72, 8
    s_cbranch_scc1 sequential_preLN__grouped_kv_mqa__dense_activation_silu__prompt_kernel_poll6_ok
    s_sleep 1
    s_cmp_lt_u32 s71, 200000
    s_cbranch_scc1 sequential_preLN__grouped_kv_mqa__dense_activation_silu__prompt_kernel_poll6

sequential_preLN__grouped_kv_mqa__dense_activation_silu__prompt_kernel_poll6_ok:
sequential_preLN__grouped_kv_mqa__dense_activation_silu__prompt_kernel_f1go:
    s_mov_b32 s70, 0
sequential_preLN__grouped_kv_mqa__dense_activation_silu__prompt_kernel_f1_l1:
    s_and_b32 s42, s60, s62
    s_add_u32 m0, s55, s42
    s_add_u32 s55, s55, s58
    buffer_load_dwordx4 v4, s[16:19], s52 offen sc1 lds
    buffer_load_dwordx4 v4, s[16:19], s52 offen offset:1024 sc1 lds
    s_add_u32 s52, s52, 2048
    s_add_u32 m0, s56, s42
    s_add_u32 s56, s56, s58
    buffer_load_dwordx4 v4, s[16:19], s53 offen sc1 lds
    buffer_load_dwordx4 v4, s[16:19], s53 offen offset:1024 sc1 lds
    s_add_u32 s53, s53, 2048
    s_add_u32 m0, s57, s60
    s_nop 0
    buffer_load_dwordx4 v4, s[16:19], s54 offen sc1 lds
    buffer_load_dwordx4 v4, s[16:19], s54 offen offset:1024 sc1 lds
    s_add_u32 s54, s54, 2048
    s_add_u32 s60, s60, 16384
    s_cmp_ge_u32 s60, 65536
    s_cselect_b32 s60, 0, s60

    s_add_u32 s70, s70, 1
    s_cmp_lt_u32 s70, 3
    s_cbranch_scc1 sequential_preLN__grouped_kv_mqa__dense_activation_silu__prompt_kernel_f1_l1
    s_waitcnt vmcnt(12)
    s_barrier
    s_cmp_lt_u32 s70, 10
    s_cbranch_scc1 sequential_preLN__grouped_kv_mqa__dense_activation_silu__prompt_kernel_f1_l1
    s_mul_i32 s51, s50, 3
    s_lshl_b32 s62, s51, 10
    s_add_u32 s62, s62, 81920

    s_add_u32 s42, s51, 0
    s_lshr_b32 s43, s42, 1
    s_add_u32 s43, s43, 8
    s_mul_i32 s43, s43, 20
    s_and_b32 s46, s42, 1
    s_add_u32 s43, s43, s46
    s_lshl_b32 s43, s43, 10
    s_add_u32 s52, s43, s48
    s_lshr_b32 s42, s42, 2
    s_add_u32 s42, s42, 4
    s_cmp_lt_u32 s42, s45
    s_cselect_b32 s52, s52, 0x7f000000

    s_add_u32 s42, s51, 1
    s_lshr_b32 s43, s42, 1
    s_add_u32 s43, s43, 8
    s_mul_i32 s43, s43, 20
    s_and_b32 s46, s42, 1
    s_add_u32 s43, s43, s46
    s_lshl_b32 s43, s43, 10
    s_add_u32 s53, s43, s48
    s_lshr_b32 s42, s42, 2
    s_add_u32 s42, s42, 4
    s_cmp_lt_u32 s42, s45
    s_cselect_b32 s53, s53, 0x7f000000

    s_add_u32 s42, s51, 2
    s_lshr_b32 s43, s42, 1
    s_add_u32 s43, s43, 8
    s_mul_i32 s43, s43, 20
    s_and_b32 s46, s42, 1
    s_add_u32 s43, s43, s46
    s_lshl_b32 s43, s43, 10
    s_add_u32 s54, s43, s48
    s_lshr_b32 s42, s42, 2
    s_add_u32 s42, s42, 4
    s_cmp_lt_u32 s42, s45
    s_cselect_b32 s54, s54, 0x7f000000

    s_mov_b32 s70, 0
sequential_preLN__grouped_kv_mqa__dense_activation_silu__prompt_kernel_f1_l2:
    s_cmp_lg_u32 s70, 10
    s_cbranch_scc1 sequential_preLN__grouped_kv_mqa__dense_activation_silu__prompt_kernel_f1_l2_go
    s_mov_b32 s18, 0
sequential_preLN__grouped_kv_mqa__dense_activation_silu__prompt_kernel_f1_l2_go:
    s_add_u32 m0, s62, s60
    s_nop 0
    buffer_load_dwordx4 v4, s[16:19], s52 offen sc1 lds
    s_add_u32 s52, s52, 2048
    s_add_u32 m0, m0, 1024
    s_nop 0
    buffer_load_dwordx4 v4, s[16:19], s53 offen sc1 lds
    s_add_u32 s53, s53, 2048
    s_add_u32 m0, m0, 1024
    s_nop 0
    buffer_load_dwordx4 v4, s[16:19], s54 offen sc1 lds
    s_add_u32 s54, s54, 2048
    s_add_u32 s60, s60, 16384
    s_cmp_ge_u32 s60, 65536
    s_cselect_b32 s60, 0, s60

    s_add_u32 s70, s70, 1
    s_waitcnt vmcnt(6)
    s_barrier
    s_cmp_lt_u32 s70, 12
    s_cbranch_scc1 sequential_preLN__grouped_kv_mqa__dense_activation_silu__prompt_kernel_f1_l2
    s_barrier
    s_mov_b32 s18, 26214400
    s_sub_u32 s50, s36, 4
    s_mov_b32 s60, 0
    s_cmp_lt_u32 s50, 2
    s_cbranch_scc1 sequential_preLN__grouped_kv_mqa__dense_activation_silu__prompt_kernel_w2_x
    s_sub_u32 s50, s50, 2
    s_mul_i32 s50, s50, 5
    s_lshl_b32 s61, s50, 10
    s_add_u32 s61, s61, 57344
    s_mul_i32 s49, s38, 276480
    s_add_u32 s49, s49, 23068672

    s_add_u32 s51, s50, 0
    s_and_b32 s46, s51, 1
    s_lshr_b32 s51, s51, 1

    s_mul_i32 s43, s51, 54
    s_add_u32 s43, s43, s46
    s_lshl_b32 s43, s43, 10
    s_add_u32 s52, s43, s49
    s_mov_b32 s63, s46
    s_add_u32 s51, s50, 1
    s_and_b32 s46, s51, 1
    s_lshr_b32 s51, s51, 1

    s_mul_i32 s43, s51, 54
    s_add_u32 s43, s43, s46
    s_lshl_b32 s43, s43, 10
    s_add_u32 s53, s43, s49
    s_mov_b32 s64, s46
    s_add_u32 s51, s50, 2
    s_and_b32 s46, s51, 1
    s_lshr_b32 s51, s51, 1

    s_mul_i32 s43, s51, 54
    s_add_u32 s43, s43, s46
    s_lshl_b32 s43, s43, 10
    s_add_u32 s54, s43, s49
    s_mov_b32 s65, s46
    s_add_u32 s51, s50, 3
    s_and_b32 s46, s51, 1
    s_lshr_b32 s51, s51, 1

    s_mul_i32 s43, s51, 54
    s_add_u32 s43, s43, s46
    s_lshl_b32 s43, s43, 10
    s_add_u32 s55, s43, s49
    s_mov_b32 s66, s46
    s_add_u32 s51, s50, 4
    s_and_b32 s46, s51, 1
    s_lshr_b32 s51, s51, 1

    s_mul_i32 s43, s51, 54
    s_add_u32 s43, s43, s46
    s_lshl_b32 s43, s43, 10
    s_add_u32 s56, s43, s49
    s_mov_b32 s67, s46
    s_add_u32 m0, s61, 0
    s_add_u32 s42, s52, 0
    buffer_load_dwordx4 v4, s[16:19], s42 offen sc1 lds
    s_add_u32 m0, s61, 1024
    s_add_u32 s42, s53, 0
    buffer_load_dwordx4 v4, s[16:19], s42 offen sc1 lds
    s_add_u32 m0, s61, 2048
    s_add_u32 s42, s54, 0
    buffer_load_dwordx4 v4, s[16:19], s42 offen sc1 lds
    s_add_u32 m0, s61, 3072
    s_add_u32 s42, s55, 0
    buffer_load_dwordx4 v4, s[16:19], s42 offen sc1 lds
    s_add_u32 m0, s61, 4096
    s_add_u32 s42, s56, 0
    buffer_load_dwordx4 v4, s[16:19], s42 offen sc1 lds
    s_add_u32 m0, s61, 10240
    s_add_u32 s42, s52, 2048
    buffer_load_dwordx4 v4, s[16:19], s42 offen sc1 lds
    s_add_u32 m0, s61, 11264
    s_add_u32 s42, s53, 2048
    buffer_load_dwordx4 v4, s[16:19], s42 offen sc1 lds
    s_add_u32 m0, s61, 12288
    s_add_u32 s42, s54, 2048
    buffer_load_dwordx4 v4, s[16:19], s42 offen sc1 lds
    s_add_u32 m0, s61, 13312
    s_add_u32 s42, s55, 2048
    buffer_load_dwordx4 v4, s[16:19], s42 offen sc1 lds
    s_add_u32 m0, s61, 14336
    s_add_u32 s42, s56, 2048
    buffer_load_dwordx4 v4, s[16:19], s42 offen sc1 lds
    s_add_u32 m0, s61, 20480
    s_add_u32 s42, s52, 7168
    buffer_load_dwordx4 v4, s[16:19], s42 offen sc1 lds
    s_add_u32 m0, s61, 21504
    s_add_u32 s42, s53, 7168
    buffer_load_dwordx4 v4, s[16:19], s42 offen sc1 lds
    s_add_u32 m0, s61, 22528
    s_add_u32 s42, s54, 7168
    buffer_load_dwordx4 v4, s[16:19], s42 offen sc1 lds
    s_add_u32 m0, s61, 23552
    s_add_u32 s42, s55, 7168
    buffer_load_dwordx4 v4, s[16:19], s42 offen sc1 lds
    s_add_u32 m0, s61, 24576
    s_add_u32 s42, s56, 7168
    buffer_load_dwordx4 v4, s[16:19], s42 offen sc1 lds
    s_add_u32 m0, s61, 30720
    s_add_u32 s42, s52, 9216
    buffer_load_dwordx4 v4, s[16:19], s42 offen sc1 lds
    s_add_u32 m0, s61, 31744
    s_add_u32 s42, s53, 9216
    buffer_load_dwordx4 v4, s[16:19], s42 offen sc1 lds
    s_add_u32 m0, s61, 32768
    s_add_u32 s42, s54, 9216
    buffer_load_dwordx4 v4, s[16:19], s42 offen sc1 lds
    s_add_u32 m0, s61, 33792
    s_add_u32 s42, s55, 9216
    buffer_load_dwordx4 v4, s[16:19], s42 offen sc1 lds
    s_add_u32 m0, s61, 34816
    s_add_u32 s42, s56, 9216
    buffer_load_dwordx4 v4, s[16:19], s42 offen sc1 lds
    s_waitcnt vmcnt(15)
    s_barrier
    s_add_u32 m0, s61, 40960
    s_add_u32 s42, s52, 14336
    buffer_load_dwordx4 v4, s[16:19], s42 offen sc1 lds
    s_add_u32 m0, s61, 41984
    s_add_u32 s42, s53, 14336
    buffer_load_dwordx4 v4, s[16:19], s42 offen sc1 lds
    s_add_u32 m0, s61, 43008
    s_add_u32 s42, s54, 14336
    buffer_load_dwordx4 v4, s[16:19], s42 offen sc1 lds
    s_add_u32 m0, s61, 44032
    s_add_u32 s42, s55, 14336
    buffer_load_dwordx4 v4, s[16:19], s42 offen sc1 lds
    s_add_u32 m0, s61, 45056
    s_add_u32 s42, s56, 14336
    buffer_load_dwordx4 v4, s[16:19], s42 offen sc1 lds
    s_add_u32 m0, s61, 51200
    s_add_u32 s42, s52, 16384
    buffer_load_dwordx4 v4, s[16:19], s42 offen sc1 lds
    s_add_u32 m0, s61, 52224
    s_add_u32 s42, s53, 16384
    buffer_load_dwordx4 v4, s[16:19], s42 offen sc1 lds
    s_add_u32 m0, s61, 53248
    s_add_u32 s42, s54, 16384
    buffer_load_dwordx4 v4, s[16:19], s42 offen sc1 lds
    s_add_u32 m0, s61, 54272
    s_add_u32 s42, s55, 16384
    buffer_load_dwordx4 v4, s[16:19], s42 offen sc1 lds
    s_add_u32 m0, s61, 55296
    s_add_u32 s42, s56, 16384
    buffer_load_dwordx4 v4, s[16:19], s42 offen sc1 lds
    s_waitcnt vmcnt(20)
    s_barrier
    s_add_u32 m0, s61, 61440
    s_add_u32 s42, s52, 21504
    buffer_load_dwordx4 v4, s[16:19], s42 offen sc1 lds
    s_add_u32 m0, s61, 62464
    s_add_u32 s42, s53, 21504
    buffer_load_dwordx4 v4, s[16:19], s42 offen sc1 lds
    s_add_u32 m0, s61, 63488
    s_add_u32 s42, s54, 21504
    buffer_load_dwordx4 v4, s[16:19], s42 offen sc1 lds
    s_add_u32 m0, s61, 64512
    s_add_u32 s42, s55, 21504
    buffer_load_dwordx4 v4, s[16:19], s42 offen sc1 lds
    s_add_u32 m0, s61, 65536
    s_add_u32 s42, s56, 21504
    buffer_load_dwordx4 v4, s[16:19], s42 offen sc1 lds
    s_add_u32 m0, s61, 0
    s_add_u32 s42, s52, 23552
    buffer_load_dwordx4 v4, s[16:19], s42 offen sc1 lds
    s_add_u32 m0, s61, 1024
    s_add_u32 s42, s53, 23552
    buffer_load_dwordx4 v4, s[16:19], s42 offen sc1 lds
    s_add_u32 m0, s61, 2048
    s_add_u32 s42, s54, 23552
    buffer_load_dwordx4 v4, s[16:19], s42 offen sc1 lds
    s_add_u32 m0, s61, 3072
    s_add_u32 s42, s55, 23552
    buffer_load_dwordx4 v4, s[16:19], s42 offen sc1 lds
    s_add_u32 m0, s61, 4096
    s_add_u32 s42, s56, 23552
    buffer_load_dwordx4 v4, s[16:19], s42 offen sc1 lds
    s_waitcnt vmcnt(25)
    s_barrier
    s_add_u32 m0, s61, 10240
    s_add_u32 s42, s52, 28672
    buffer_load_dwordx4 v4, s[16:19], s42 offen sc1 lds
    s_add_u32 m0, s61, 11264
    s_add_u32 s42, s53, 28672
    buffer_load_dwordx4 v4, s[16:19], s42 offen sc1 lds
    s_add_u32 m0, s61, 12288
    s_add_u32 s42, s54, 28672
    buffer_load_dwordx4 v4, s[16:19], s42 offen sc1 lds
    s_add_u32 m0, s61, 13312
    s_add_u32 s42, s55, 28672
    buffer_load_dwordx4 v4, s[16:19], s42 offen sc1 lds
    s_add_u32 m0, s61, 14336
    s_add_u32 s42, s56, 28672
    buffer_load_dwordx4 v4, s[16:19], s42 offen sc1 lds
    s_waitcnt vmcnt(25)
    s_barrier
    s_add_u32 m0, s61, 20480
    s_add_u32 s42, s52, 30720
    buffer_load_dwordx4 v4, s[16:19], s42 offen sc1 lds
    s_add_u32 m0, s61, 21504
    s_add_u32 s42, s53, 30720
    buffer_load_dwordx4 v4, s[16:19], s42 offen sc1 lds
    s_add_u32 m0, s61, 22528
    s_add_u32 s42, s54, 30720
    buffer_load_dwordx4 v4, s[16:19], s42 offen sc1 lds
    s_add_u32 m0, s61, 23552
    s_add_u32 s42, s55, 30720
    buffer_load_dwordx4 v4, s[16:19], s42 offen sc1 lds
    s_add_u32 m0, s61, 24576
    s_add_u32 s42, s56, 30720
    buffer_load_dwordx4 v4, s[16:19], s42 offen sc1 lds
    s_waitcnt vmcnt(25)
    s_barrier
    s_add_u32 m0, s61, 30720
    s_add_u32 s42, s52, 35840
    buffer_load_dwordx4 v4, s[16:19], s42 offen sc1 lds
    s_add_u32 m0, s61, 31744
    s_add_u32 s42, s53, 35840
    buffer_load_dwordx4 v4, s[16:19], s42 offen sc1 lds
    s_add_u32 m0, s61, 32768
    s_add_u32 s42, s54, 35840
    buffer_load_dwordx4 v4, s[16:19], s42 offen sc1 lds
    s_add_u32 m0, s61, 33792
    s_add_u32 s42, s55, 35840
    buffer_load_dwordx4 v4, s[16:19], s42 offen sc1 lds
    s_add_u32 m0, s61, 34816
    s_add_u32 s42, s56, 35840
    buffer_load_dwordx4 v4, s[16:19], s42 offen sc1 lds
    s_waitcnt vmcnt(25)
    s_barrier
    s_add_u32 m0, s61, 40960
    s_add_u32 s42, s52, 37888
    buffer_load_dwordx4 v4, s[16:19], s42 offen sc1 lds
    s_add_u32 m0, s61, 41984
    s_add_u32 s42, s53, 37888
    buffer_load_dwordx4 v4, s[16:19], s42 offen sc1 lds
    s_add_u32 m0, s61, 43008
    s_add_u32 s42, s54, 37888
    buffer_load_dwordx4 v4, s[16:19], s42 offen sc1 lds
    s_add_u32 m0, s61, 44032
    s_add_u32 s42, s55, 37888
    buffer_load_dwordx4 v4, s[16:19], s42 offen sc1 lds
    s_add_u32 m0, s61, 45056
    s_add_u32 s42, s56, 37888
    buffer_load_dwordx4 v4, s[16:19], s42 offen sc1 lds
    s_waitcnt vmcnt(25)
    s_barrier
    s_add_u32 m0, s61, 51200
    s_add_u32 s42, s52, 43008
    buffer_load_dwordx4 v4, s[16:19], s42 offen sc1 lds
    s_add_u32 m0, s61, 52224
    s_add_u32 s42, s53, 43008
    buffer_load_dwordx4 v4, s[16:19], s42 offen sc1 lds
    s_add_u32 m0, s61, 53248
    s_add_u32 s42, s54, 43008
    buffer_load_dwordx4 v4, s[16:19], s42 offen sc1 lds
    s_add_u32 m0, s61, 54272
    s_add_u32 s42, s55, 43008
    buffer_load_dwordx4 v4, s[16:19], s42 offen sc1 lds
    s_add_u32 m0, s61, 55296
    s_add_u32 s42, s56, 43008
    buffer_load_dwordx4 v4, s[16:19], s42 offen sc1 lds
    s_waitcnt vmcnt(25)
    s_barrier
    s_add_u32 m0, s61, 61440
    s_add_u32 s42, s52, 45056
    buffer_load_dwordx4 v4, s[16:19], s42 offen sc1 lds
    s_add_u32 m0, s61, 62464
    s_add_u32 s42, s53, 45056
    buffer_load_dwordx4 v4, s[16:19], s42 offen sc1 lds
    s_add_u32 m0, s61, 63488
    s_add_u32 s42, s54, 45056
    buffer_load_dwordx4 v4, s[16:19], s42 offen sc1 lds
    s_add_u32 m0, s61, 64512
    s_add_u32 s42, s55, 45056
    buffer_load_dwordx4 v4, s[16:19], s42 offen sc1 lds
    s_add_u32 m0, s61, 65536
    s_add_u32 s42, s56, 45056
    buffer_load_dwordx4 v4, s[16:19], s42 offen sc1 lds
    s_waitcnt vmcnt(25)
    s_barrier
    s_add_u32 m0, s61, 0
    s_add_u32 s42, s52, 49152
    buffer_load_dwordx4 v4, s[16:19], s42 offen sc1 lds
    s_add_u32 m0, s61, 1024
    s_add_u32 s42, s53, 49152
    buffer_load_dwordx4 v4, s[16:19], s42 offen sc1 lds
    s_add_u32 m0, s61, 2048
    s_add_u32 s42, s54, 49152
    buffer_load_dwordx4 v4, s[16:19], s42 offen sc1 lds
    s_add_u32 m0, s61, 3072
    s_add_u32 s42, s55, 49152
    buffer_load_dwordx4 v4, s[16:19], s42 offen sc1 lds
    s_add_u32 m0, s61, 4096
    s_add_u32 s42, s56, 49152
    buffer_load_dwordx4 v4, s[16:19], s42 offen sc1 lds
    s_waitcnt vmcnt(25)
    s_barrier
    s_add_u32 m0, s61, 10240
    s_add_u32 s42, s52, 51200
    buffer_load_dwordx4 v4, s[16:19], s42 offen sc1 lds
    s_add_u32 m0, s61, 11264
    s_add_u32 s42, s53, 51200
    buffer_load_dwordx4 v4, s[16:19], s42 offen sc1 lds
    s_add_u32 m0, s61, 12288
    s_add_u32 s42, s54, 51200
    buffer_load_dwordx4 v4, s[16:19], s42 offen sc1 lds
    s_add_u32 m0, s61, 13312
    s_add_u32 s42, s55, 51200
    buffer_load_dwordx4 v4, s[16:19], s42 offen sc1 lds
    s_add_u32 m0, s61, 14336
    s_add_u32 s42, s56, 51200
    buffer_load_dwordx4 v4, s[16:19], s42 offen sc1 lds
    s_waitcnt vmcnt(25)
    s_barrier
    s_add_u32 m0, s61, 20480
    s_add_u32 s42, s52, 4096
    buffer_load_dwordx4 v4, s[16:19], s42 offen sc1 lds
    s_add_u32 m0, s61, 21504
    s_add_u32 s42, s53, 4096
    buffer_load_dwordx4 v4, s[16:19], s42 offen sc1 lds
    s_add_u32 m0, s61, 22528
    s_add_u32 s42, s54, 4096
    buffer_load_dwordx4 v4, s[16:19], s42 offen sc1 lds
    s_add_u32 m0, s61, 23552
    s_add_u32 s42, s55, 4096
    buffer_load_dwordx4 v4, s[16:19], s42 offen sc1 lds
    s_add_u32 m0, s61, 24576
    s_add_u32 s42, s56, 4096
    buffer_load_dwordx4 v4, s[16:19], s42 offen sc1 lds
    s_waitcnt vmcnt(25)
    s_barrier
    s_add_u32 m0, s61, 30720
    s_add_u32 s42, s52, 6144
    s_mul_i32 s43, s63, 4096
    s_add_u32 s42, s42, s43
    buffer_load_dwordx4 v4, s[16:19], s42 offen sc1 lds
    s_add_u32 m0, s61, 31744
    s_add_u32 s42, s53, 6144
    s_mul_i32 s43, s64, 4096
    s_add_u32 s42, s42, s43
    buffer_load_dwordx4 v4, s[16:19], s42 offen sc1 lds
    s_add_u32 m0, s61, 32768
    s_add_u32 s42, s54, 6144
    s_mul_i32 s43, s65, 4096
    s_add_u32 s42, s42, s43
    buffer_load_dwordx4 v4, s[16:19], s42 offen sc1 lds
    s_add_u32 m0, s61, 33792
    s_add_u32 s42, s55, 6144
    s_mul_i32 s43, s66, 4096
    s_add_u32 s42, s42, s43
    buffer_load_dwordx4 v4, s[16:19], s42 offen sc1 lds
    s_add_u32 m0, s61, 34816
    s_add_u32 s42, s56, 6144
    s_mul_i32 s43, s67, 4096
    s_add_u32 s42, s42, s43
    buffer_load_dwordx4 v4, s[16:19], s42 offen sc1 lds
    s_waitcnt vmcnt(25)
    s_barrier
    s_add_u32 m0, s61, 40960
    s_add_u32 s42, s52, 12288
    buffer_load_dwordx4 v4, s[16:19], s42 offen sc1 lds
    s_add_u32 m0, s61, 41984
    s_add_u32 s42, s53, 12288
    buffer_load_dwordx4 v4, s[16:19], s42 offen sc1 lds
    s_add_u32 m0, s61, 43008
    s_add_u32 s42, s54, 12288
    buffer_load_dwordx4 v4, s[16:19], s42 offen sc1 lds
    s_add_u32 m0, s61, 44032
    s_add_u32 s42, s55, 12288
    buffer_load_dwordx4 v4, s[16:19], s42 offen sc1 lds
    s_add_u32 m0, s61, 45056
    s_add_u32 s42, s56, 12288
    buffer_load_dwordx4 v4, s[16:19], s42 offen sc1 lds
    s_waitcnt vmcnt(25)
    s_barrier
    s_add_u32 m0, s61, 51200
    s_add_u32 s42, s52, 18432
    buffer_load_dwordx4 v4, s[16:19], s42 offen sc1 lds
    s_add_u32 m0, s61, 52224
    s_add_u32 s42, s53, 18432
    buffer_load_dwordx4 v4, s[16:19], s42 offen sc1 lds
    s_add_u32 m0, s61, 53248
    s_add_u32 s42, s54, 18432
    buffer_load_dwordx4 v4, s[16:19], s42 offen sc1 lds
    s_add_u32 m0, s61, 54272
    s_add_u32 s42, s55, 18432
    buffer_load_dwordx4 v4, s[16:19], s42 offen sc1 lds
    s_add_u32 m0, s61, 55296
    s_add_u32 s42, s56, 18432
    buffer_load_dwordx4 v4, s[16:19], s42 offen sc1 lds
    s_waitcnt vmcnt(25)
    s_barrier
    s_add_u32 m0, s61, 61440
    s_add_u32 s42, s52, 20480
    s_mul_i32 s43, s63, 4096
    s_add_u32 s42, s42, s43
    buffer_load_dwordx4 v4, s[16:19], s42 offen sc1 lds
    s_add_u32 m0, s61, 62464
    s_add_u32 s42, s53, 20480
    s_mul_i32 s43, s64, 4096
    s_add_u32 s42, s42, s43
    buffer_load_dwordx4 v4, s[16:19], s42 offen sc1 lds
    s_add_u32 m0, s61, 63488
    s_add_u32 s42, s54, 20480
    s_mul_i32 s43, s65, 4096
    s_add_u32 s42, s42, s43
    buffer_load_dwordx4 v4, s[16:19], s42 offen sc1 lds
    s_add_u32 m0, s61, 64512
    s_add_u32 s42, s55, 20480
    s_mul_i32 s43, s66, 4096
    s_add_u32 s42, s42, s43
    buffer_load_dwordx4 v4, s[16:19], s42 offen sc1 lds
    s_add_u32 m0, s61, 65536
    s_add_u32 s42, s56, 20480
    s_mul_i32 s43, s67, 4096
    s_add_u32 s42, s42, s43
    buffer_load_dwordx4 v4, s[16:19], s42 offen sc1 lds
    s_waitcnt vmcnt(25)
    s_barrier
    s_add_u32 m0, s61, 0
    s_add_u32 s42, s52, 26624
    buffer_load_dwordx4 v4, s[16:19], s42 offen sc1 lds
    s_add_u32 m0, s61, 1024
    s_add_u32 s42, s53, 26624
    buffer_load_dwordx4 v4, s[16:19], s42 offen sc1 lds
    s_add_u32 m0, s61, 2048
    s_add_u32 s42, s54, 26624
    buffer_load_dwordx4 v4, s[16:19], s42 offen sc1 lds
    s_add_u32 m0, s61, 3072
    s_add_u32 s42, s55, 26624
    buffer_load_dwordx4 v4, s[16:19], s42 offen sc1 lds
    s_add_u32 m0, s61, 4096
    s_add_u32 s42, s56, 26624
    buffer_load_dwordx4 v4, s[16:19], s42 offen sc1 lds
    s_waitcnt vmcnt(25)
    s_barrier
    s_add_u32 m0, s61, 10240
    s_add_u32 s42, s52, 32768
    buffer_load_dwordx4 v4, s[16:19], s42 offen sc1 lds
    s_add_u32 m0, s61, 11264
    s_add_u32 s42, s53, 32768
    buffer_load_dwordx4 v4, s[16:19], s42 offen sc1 lds
    s_add_u32 m0, s61, 12288
    s_add_u32 s42, s54, 32768
    buffer_load_dwordx4 v4, s[16:19], s42 offen sc1 lds
    s_add_u32 m0, s61, 13312
    s_add_u32 s42, s55, 32768
    buffer_load_dwordx4 v4, s[16:19], s42 offen sc1 lds
    s_add_u32 m0, s61, 14336
    s_add_u32 s42, s56, 32768
    buffer_load_dwordx4 v4, s[16:19], s42 offen sc1 lds
    s_waitcnt vmcnt(25)
    s_barrier
    s_add_u32 m0, s61, 20480
    s_add_u32 s42, s52, 34816
    s_mul_i32 s43, s63, 4096
    s_add_u32 s42, s42, s43
    buffer_load_dwordx4 v4, s[16:19], s42 offen sc1 lds
    s_add_u32 m0, s61, 21504
    s_add_u32 s42, s53, 34816
    s_mul_i32 s43, s64, 4096
    s_add_u32 s42, s42, s43
    buffer_load_dwordx4 v4, s[16:19], s42 offen sc1 lds
    s_add_u32 m0, s61, 22528
    s_add_u32 s42, s54, 34816
    s_mul_i32 s43, s65, 4096
    s_add_u32 s42, s42, s43
    buffer_load_dwordx4 v4, s[16:19], s42 offen sc1 lds
    s_add_u32 m0, s61, 23552
    s_add_u32 s42, s55, 34816
    s_mul_i32 s43, s66, 4096
    s_add_u32 s42, s42, s43
    buffer_load_dwordx4 v4, s[16:19], s42 offen sc1 lds
    s_add_u32 m0, s61, 24576
    s_add_u32 s42, s56, 34816
    s_mul_i32 s43, s67, 4096
    s_add_u32 s42, s42, s43
    buffer_load_dwordx4 v4, s[16:19], s42 offen sc1 lds
    s_waitcnt vmcnt(25)
    s_barrier
    s_add_u32 m0, s61, 30720
    s_add_u32 s42, s52, 40960
    buffer_load_dwordx4 v4, s[16:19], s42 offen sc1 lds
    s_add_u32 m0, s61, 31744
    s_add_u32 s42, s53, 40960
    buffer_load_dwordx4 v4, s[16:19], s42 offen sc1 lds
    s_add_u32 m0, s61, 32768
    s_add_u32 s42, s54, 40960
    buffer_load_dwordx4 v4, s[16:19], s42 offen sc1 lds
    s_add_u32 m0, s61, 33792
    s_add_u32 s42, s55, 40960
    buffer_load_dwordx4 v4, s[16:19], s42 offen sc1 lds
    s_add_u32 m0, s61, 34816
    s_add_u32 s42, s56, 40960
    buffer_load_dwordx4 v4, s[16:19], s42 offen sc1 lds
    s_waitcnt vmcnt(25)
    s_barrier
    s_add_u32 m0, s61, 40960
    s_add_u32 s42, s52, 47104
    buffer_load_dwordx4 v4, s[16:19], s42 offen sc1 lds
    s_add_u32 m0, s61, 41984
    s_add_u32 s42, s53, 47104
    buffer_load_dwordx4 v4, s[16:19], s42 offen sc1 lds
    s_add_u32 m0, s61, 43008
    s_add_u32 s42, s54, 47104
    buffer_load_dwordx4 v4, s[16:19], s42 offen sc1 lds
    s_add_u32 m0, s61, 44032
    s_add_u32 s42, s55, 47104
    buffer_load_dwordx4 v4, s[16:19], s42 offen sc1 lds
    s_add_u32 m0, s61, 45056
    s_add_u32 s42, s56, 47104
    buffer_load_dwordx4 v4, s[16:19], s42 offen sc1 lds
    s_waitcnt vmcnt(25)
    s_barrier
    s_add_u32 m0, s61, 51200
    s_add_u32 s42, s52, 53248
    buffer_load_dwordx4 v4, s[16:19], s42 offen sc1 lds
    s_add_u32 m0, s61, 52224
    s_add_u32 s42, s53, 53248
    buffer_load_dwordx4 v4, s[16:19], s42 offen sc1 lds
    s_add_u32 m0, s61, 53248
    s_add_u32 s42, s54, 53248
    buffer_load_dwordx4 v4, s[16:19], s42 offen sc1 lds
    s_add_u32 m0, s61, 54272
    s_add_u32 s42, s55, 53248
    buffer_load_dwordx4 v4, s[16:19], s42 offen sc1 lds
    s_add_u32 m0, s61, 55296
    s_add_u32 s42, s56, 53248
    buffer_load_dwordx4 v4, s[16:19], s42 offen sc1 lds
    s_waitcnt vmcnt(25)
    s_barrier
    s_waitcnt vmcnt(20)
    s_barrier
    s_waitcnt vmcnt(15)
    s_barrier
    s_waitcnt vmcnt(10)
    s_barrier
    s_waitcnt vmcnt(5)
    s_barrier
    s_waitcnt vmcnt(0)
    s_barrier
    s_branch sequential_preLN__grouped_kv_mqa__dense_activation_silu__prompt_kernel_w2_done
sequential_preLN__grouped_kv_mqa__dense_activation_silu__prompt_kernel_w2_x:
    s_lshl_b32 s61, s50, 12
    s_lshl_b32 s42, s37, 2
    s_lshl_b32 s43, s50, 1
    s_add_u32 s42, s42, s43
    s_mul_i32 s52, s42, 55296
    s_add_u32 s52, s52, 10485760
    s_add_u32 s53, s52, 1024
    s_add_u32 s54, s52, 55296
    s_add_u32 s55, s54, 1024
    s_mov_b32 s63, 0
    s_mov_b32 s64, 1
    s_mov_b32 s65, 0
    s_mov_b32 s66, 1

    s_add_u32 s42, s14, 16384
    v_mov_b32 v250, 0
    s_mov_b32 s71, 0

sequential_preLN__grouped_kv_mqa__dense_activation_silu__prompt_kernel_poll7:
    buffer_load_dword v251, v250, s[16:19], s42 offen sc1
    s_add_u32 s71, s71, 1
    s_waitcnt vmcnt(0)
    v_readfirstlane_b32 s72, v251
    s_cmp_ge_u32 s72, 8
    s_cbranch_scc1 sequential_preLN__grouped_kv_mqa__dense_activation_silu__prompt_kernel_poll7_ok
    s_sleep 1
    s_cmp_lt_u32 s71, 200000
    s_cbranch_scc1 sequential_preLN__grouped_kv_mqa__dense_activation_silu__prompt_kernel_poll7

sequential_preLN__grouped_kv_mqa__dense_activation_silu__prompt_kernel_poll7_ok:
    s_add_u32 m0, s61, 0
    s_add_u32 s42, s52, 0
    buffer_load_dwordx4 v4, s[16:19], s42 offen sc1 lds
    s_add_u32 m0, s61, 1024
    s_add_u32 s42, s53, 0
    buffer_load_dwordx4 v4, s[16:19], s42 offen sc1 lds
    s_add_u32 m0, s61, 2048
    s_add_u32 s42, s54, 0
    buffer_load_dwordx4 v4, s[16:19], s42 offen sc1 lds
    s_add_u32 m0, s61, 3072
    s_add_u32 s42, s55, 0
    buffer_load_dwordx4 v4, s[16:19], s42 offen sc1 lds
    s_add_u32 m0, s61, 8192
    s_add_u32 s42, s52, 2048
    buffer_load_dwordx4 v4, s[16:19], s42 offen sc1 lds
    s_add_u32 m0, s61, 9216
    s_add_u32 s42, s53, 2048
    buffer_load_dwordx4 v4, s[16:19], s42 offen sc1 lds
    s_add_u32 m0, s61, 10240
    s_add_u32 s42, s54, 2048
    buffer_load_dwordx4 v4, s[16:19], s42 offen sc1 lds
    s_add_u32 m0, s61, 11264
    s_add_u32 s42, s55, 2048
    buffer_load_dwordx4 v4, s[16:19], s42 offen sc1 lds
    s_add_u32 m0, s61, 16384
    s_add_u32 s42, s52, 7168
    buffer_load_dwordx4 v4, s[16:19], s42 offen sc1 lds
    s_add_u32 m0, s61, 17408
    s_add_u32 s42, s53, 7168
    buffer_load_dwordx4 v4, s[16:19], s42 offen sc1 lds
    s_add_u32 m0, s61, 18432
    s_add_u32 s42, s54, 7168
    buffer_load_dwordx4 v4, s[16:19], s42 offen sc1 lds
    s_add_u32 m0, s61, 19456
    s_add_u32 s42, s55, 7168
    buffer_load_dwordx4 v4, s[16:19], s42 offen sc1 lds
    s_waitcnt vmcnt(8)
    s_barrier
    s_add_u32 m0, s61, 24576
    s_add_u32 s42, s52, 9216
    buffer_load_dwordx4 v4, s[16:19], s42 offen sc1 lds
    s_add_u32 m0, s61, 25600
    s_add_u32 s42, s53, 9216
    buffer_load_dwordx4 v4, s[16:19], s42 offen sc1 lds
    s_add_u32 m0, s61, 26624
    s_add_u32 s42, s54, 9216
    buffer_load_dwordx4 v4, s[16:19], s42 offen sc1 lds
    s_add_u32 m0, s61, 27648
    s_add_u32 s42, s55, 9216
    buffer_load_dwordx4 v4, s[16:19], s42 offen sc1 lds
    s_add_u32 m0, s61, 32768
    s_add_u32 s42, s52, 14336
    buffer_load_dwordx4 v4, s[16:19], s42 offen sc1 lds
    s_add_u32 m0, s61, 33792
    s_add_u32 s42, s53, 14336
    buffer_load_dwordx4 v4, s[16:19], s42 offen sc1 lds
    s_add_u32 m0, s61, 34816
    s_add_u32 s42, s54, 14336
    buffer_load_dwordx4 v4, s[16:19], s42 offen sc1 lds
    s_add_u32 m0, s61, 35840
    s_add_u32 s42, s55, 14336
    buffer_load_dwordx4 v4, s[16:19], s42 offen sc1 lds
    s_waitcnt vmcnt(12)
    s_barrier
    s_add_u32 m0, s61, 40960
    s_add_u32 s42, s52, 16384
    buffer_load_dwordx4 v4, s[16:19], s42 offen sc1 lds
    s_add_u32 m0, s61, 41984
    s_add_u32 s42, s53, 16384
    buffer_load_dwordx4 v4, s[16:19], s42 offen sc1 lds
    s_add_u32 m0, s61, 43008
    s_add_u32 s42, s54, 16384
    buffer_load_dwordx4 v4, s[16:19], s42 offen sc1 lds
    s_add_u32 m0, s61, 44032
    s_add_u32 s42, s55, 16384
    buffer_load_dwordx4 v4, s[16:19], s42 offen sc1 lds
    s_add_u32 m0, s61, 49152
    s_add_u32 s42, s52, 21504
    buffer_load_dwordx4 v4, s[16:19], s42 offen sc1 lds
    s_add_u32 m0, s61, 50176
    s_add_u32 s42, s53, 21504
    buffer_load_dwordx4 v4, s[16:19], s42 offen sc1 lds
    s_add_u32 m0, s61, 51200
    s_add_u32 s42, s54, 21504
    buffer_load_dwordx4 v4, s[16:19], s42 offen sc1 lds
    s_add_u32 m0, s61, 52224
    s_add_u32 s42, s55, 21504
    buffer_load_dwordx4 v4, s[16:19], s42 offen sc1 lds
    s_waitcnt vmcnt(16)
    s_barrier
    s_add_u32 m0, s61, 0
    s_add_u32 s42, s52, 23552
    buffer_load_dwordx4 v4, s[16:19], s42 offen sc1 lds
    s_add_u32 m0, s61, 1024
    s_add_u32 s42, s53, 23552
    buffer_load_dwordx4 v4, s[16:19], s42 offen sc1 lds
    s_add_u32 m0, s61, 2048
    s_add_u32 s42, s54, 23552
    buffer_load_dwordx4 v4, s[16:19], s42 offen sc1 lds
    s_add_u32 m0, s61, 3072
    s_add_u32 s42, s55, 23552
    buffer_load_dwordx4 v4, s[16:19], s42 offen sc1 lds
    s_add_u32 m0, s61, 8192
    s_add_u32 s42, s52, 28672
    buffer_load_dwordx4 v4, s[16:19], s42 offen sc1 lds
    s_add_u32 m0, s61, 9216
    s_add_u32 s42, s53, 28672
    buffer_load_dwordx4 v4, s[16:19], s42 offen sc1 lds
    s_add_u32 m0, s61, 10240
    s_add_u32 s42, s54, 28672
    buffer_load_dwordx4 v4, s[16:19], s42 offen sc1 lds
    s_add_u32 m0, s61, 11264
    s_add_u32 s42, s55, 28672
    buffer_load_dwordx4 v4, s[16:19], s42 offen sc1 lds
    s_waitcnt vmcnt(20)
    s_barrier
    s_add_u32 m0, s61, 16384
    s_add_u32 s42, s52, 30720
    buffer_load_dwordx4 v4, s[16:19], s42 offen sc1 lds
    s_add_u32 m0, s61, 17408
    s_add_u32 s42, s53, 30720
    buffer_load_dwordx4 v4, s[16:19], s42 offen sc1 lds
    s_add_u32 m0, s61, 18432
    s_add_u32 s42, s54, 30720
    buffer_load_dwordx4 v4, s[16:19], s42 offen sc1 lds
    s_add_u32 m0, s61, 19456
    s_add_u32 s42, s55, 30720
    buffer_load_dwordx4 v4, s[16:19], s42 offen sc1 lds
    s_waitcnt vmcnt(20)
    s_barrier
    s_add_u32 m0, s61, 24576
    s_add_u32 s42, s52, 35840
    buffer_load_dwordx4 v4, s[16:19], s42 offen sc1 lds
    s_add_u32 m0, s61, 25600
    s_add_u32 s42, s53, 35840
    buffer_load_dwordx4 v4, s[16:19], s42 offen sc1 lds
    s_add_u32 m0, s61, 26624
    s_add_u32 s42, s54, 35840
    buffer_load_dwordx4 v4, s[16:19], s42 offen sc1 lds
    s_add_u32 m0, s61, 27648
    s_add_u32 s42, s55, 35840
    buffer_load_dwordx4 v4, s[16:19], s42 offen sc1 lds
    s_waitcnt vmcnt(20)
    s_barrier
    s_add_u32 m0, s61, 32768
    s_add_u32 s42, s52, 37888
    buffer_load_dwordx4 v4, s[16:19], s42 offen sc1 lds
    s_add_u32 m0, s61, 33792
    s_add_u32 s42, s53, 37888
    buffer_load_dwordx4 v4, s[16:19], s42 offen sc1 lds
    s_add_u32 m0, s61, 34816
    s_add_u32 s42, s54, 37888
    buffer_load_dwordx4 v4, s[16:19], s42 offen sc1 lds
    s_add_u32 m0, s61, 35840
    s_add_u32 s42, s55, 37888
    buffer_load_dwordx4 v4, s[16:19], s42 offen sc1 lds
    s_waitcnt vmcnt(20)
    s_barrier
    s_add_u32 m0, s61, 40960
    s_add_u32 s42, s52, 43008
    buffer_load_dwordx4 v4, s[16:19], s42 offen sc1 lds
    s_add_u32 m0, s61, 41984
    s_add_u32 s42, s53, 43008
    buffer_load_dwordx4 v4, s[16:19], s42 offen sc1 lds
    s_add_u32 m0, s61, 43008
    s_add_u32 s42, s54, 43008
    buffer_load_dwordx4 v4, s[16:19], s42 offen sc1 lds
    s_add_u32 m0, s61, 44032
    s_add_u32 s42, s55, 43008
    buffer_load_dwordx4 v4, s[16:19], s42 offen sc1 lds
    s_waitcnt vmcnt(20)
    s_barrier
    s_add_u32 m0, s61, 49152
    s_add_u32 s42, s52, 45056
    buffer_load_dwordx4 v4, s[16:19], s42 offen sc1 lds
    s_add_u32 m0, s61, 50176
    s_add_u32 s42, s53, 45056
    buffer_load_dwordx4 v4, s[16:19], s42 offen sc1 lds
    s_add_u32 m0, s61, 51200
    s_add_u32 s42, s54, 45056
    buffer_load_dwordx4 v4, s[16:19], s42 offen sc1 lds
    s_add_u32 m0, s61, 52224
    s_add_u32 s42, s55, 45056
    buffer_load_dwordx4 v4, s[16:19], s42 offen sc1 lds
    s_waitcnt vmcnt(20)
    s_barrier
    s_add_u32 m0, s61, 0
    s_add_u32 s42, s52, 49152
    buffer_load_dwordx4 v4, s[16:19], s42 offen sc1 lds
    s_add_u32 m0, s61, 1024
    s_add_u32 s42, s53, 49152
    buffer_load_dwordx4 v4, s[16:19], s42 offen sc1 lds
    s_add_u32 m0, s61, 2048
    s_add_u32 s42, s54, 49152
    buffer_load_dwordx4 v4, s[16:19], s42 offen sc1 lds
    s_add_u32 m0, s61, 3072
    s_add_u32 s42, s55, 49152
    buffer_load_dwordx4 v4, s[16:19], s42 offen sc1 lds
    s_waitcnt vmcnt(20)
    s_barrier
    s_add_u32 m0, s61, 8192
    s_add_u32 s42, s52, 51200
    buffer_load_dwordx4 v4, s[16:19], s42 offen sc1 lds
    s_add_u32 m0, s61, 9216
    s_add_u32 s42, s53, 51200
    buffer_load_dwordx4 v4, s[16:19], s42 offen sc1 lds
    s_add_u32 m0, s61, 10240
    s_add_u32 s42, s54, 51200
    buffer_load_dwordx4 v4, s[16:19], s42 offen sc1 lds
    s_add_u32 m0, s61, 11264
    s_add_u32 s42, s55, 51200
    buffer_load_dwordx4 v4, s[16:19], s42 offen sc1 lds
    s_waitcnt vmcnt(20)
    s_barrier
    s_add_u32 s42, s14, 8192
    v_mov_b32 v250, 0
    s_mov_b32 s71, 0

sequential_preLN__grouped_kv_mqa__dense_activation_silu__prompt_kernel_poll8:
    buffer_load_dword v251, v250, s[16:19], s42 offen sc1
    s_add_u32 s71, s71, 1
    s_waitcnt vmcnt(0)
    v_readfirstlane_b32 s72, v251
    s_cmp_ge_u32 s72, 8
    s_cbranch_scc1 sequential_preLN__grouped_kv_mqa__dense_activation_silu__prompt_kernel_poll8_ok
    s_sleep 1
    s_cmp_lt_u32 s71, 200000
    s_cbranch_scc1 sequential_preLN__grouped_kv_mqa__dense_activation_silu__prompt_kernel_poll8

sequential_preLN__grouped_kv_mqa__dense_activation_silu__prompt_kernel_poll8_ok:
    s_add_u32 m0, s61, 16384
    s_add_u32 s42, s52, 4096
    buffer_load_dwordx4 v4, s[16:19], s42 offen sc1 lds
    s_add_u32 m0, s61, 17408
    s_add_u32 s42, s53, 4096
    buffer_load_dwordx4 v4, s[16:19], s42 offen sc1 lds
    s_add_u32 m0, s61, 18432
    s_add_u32 s42, s54, 4096
    buffer_load_dwordx4 v4, s[16:19], s42 offen sc1 lds
    s_add_u32 m0, s61, 19456
    s_add_u32 s42, s55, 4096
    buffer_load_dwordx4 v4, s[16:19], s42 offen sc1 lds
    s_waitcnt vmcnt(20)
    s_barrier
    s_add_u32 m0, s61, 24576
    s_add_u32 s42, s52, 6144
    s_mul_i32 s43, s63, 4096
    s_add_u32 s42, s42, s43
    buffer_load_dwordx4 v4, s[16:19], s42 offen sc1 lds
    s_add_u32 m0, s61, 25600
    s_add_u32 s42, s53, 6144
    s_mul_i32 s43, s64, 4096
    s_add_u32 s42, s42, s43
    buffer_load_dwordx4 v4, s[16:19], s42 offen sc1 lds
    s_add_u32 m0, s61, 26624
    s_add_u32 s42, s54, 6144
    s_mul_i32 s43, s65, 4096
    s_add_u32 s42, s42, s43
    buffer_load_dwordx4 v4, s[16:19], s42 offen sc1 lds
    s_add_u32 m0, s61, 27648
    s_add_u32 s42, s55, 6144
    s_mul_i32 s43, s66, 4096
    s_add_u32 s42, s42, s43
    buffer_load_dwordx4 v4, s[16:19], s42 offen sc1 lds
    s_waitcnt vmcnt(20)
    s_barrier
    s_add_u32 m0, s61, 32768
    s_add_u32 s42, s52, 12288
    buffer_load_dwordx4 v4, s[16:19], s42 offen sc1 lds
    s_add_u32 m0, s61, 33792
    s_add_u32 s42, s53, 12288
    buffer_load_dwordx4 v4, s[16:19], s42 offen sc1 lds
    s_add_u32 m0, s61, 34816
    s_add_u32 s42, s54, 12288
    buffer_load_dwordx4 v4, s[16:19], s42 offen sc1 lds
    s_add_u32 m0, s61, 35840
    s_add_u32 s42, s55, 12288
    buffer_load_dwordx4 v4, s[16:19], s42 offen sc1 lds
    s_waitcnt vmcnt(20)
    s_barrier
    s_add_u32 m0, s61, 40960
    s_add_u32 s42, s52, 18432
    buffer_load_dwordx4 v4, s[16:19], s42 offen sc1 lds
    s_add_u32 m0, s61, 41984
    s_add_u32 s42, s53, 18432
    buffer_load_dwordx4 v4, s[16:19], s42 offen sc1 lds
    s_add_u32 m0, s61, 43008
    s_add_u32 s42, s54, 18432
    buffer_load_dwordx4 v4, s[16:19], s42 offen sc1 lds
    s_add_u32 m0, s61, 44032
    s_add_u32 s42, s55, 18432
    buffer_load_dwordx4 v4, s[16:19], s42 offen sc1 lds
    s_waitcnt vmcnt(20)
    s_barrier
    s_add_u32 m0, s61, 49152
    s_add_u32 s42, s52, 20480
    s_mul_i32 s43, s63, 4096
    s_add_u32 s42, s42, s43
    buffer_load_dwordx4 v4, s[16:19], s42 offen sc1 lds
    s_add_u32 m0, s61, 50176
    s_add_u32 s42, s53, 20480
    s_mul_i32 s43, s64, 4096
    s_add_u32 s42, s42, s43
    buffer_load_dwordx4 v4, s[16:19], s42 offen sc1 lds
    s_add_u32 m0, s61, 51200
    s_add_u32 s42, s54, 20480
    s_mul_i32 s43, s65, 4096
    s_add_u32 s42, s42, s43
    buffer_load_dwordx4 v4, s[16:19], s42 offen sc1 lds
    s_add_u32 m0, s61, 52224
    s_add_u32 s42, s55, 20480
    s_mul_i32 s43, s66, 4096
    s_add_u32 s42, s42, s43
    buffer_load_dwordx4 v4, s[16:19], s42 offen sc1 lds
    s_waitcnt vmcnt(20)
    s_barrier
    s_add_u32 m0, s61, 0
    s_add_u32 s42, s52, 26624
    buffer_load_dwordx4 v4, s[16:19], s42 offen sc1 lds
    s_add_u32 m0, s61, 1024
    s_add_u32 s42, s53, 26624
    buffer_load_dwordx4 v4, s[16:19], s42 offen sc1 lds
    s_add_u32 m0, s61, 2048
    s_add_u32 s42, s54, 26624
    buffer_load_dwordx4 v4, s[16:19], s42 offen sc1 lds
    s_add_u32 m0, s61, 3072
    s_add_u32 s42, s55, 26624
    buffer_load_dwordx4 v4, s[16:19], s42 offen sc1 lds
    s_waitcnt vmcnt(20)
    s_barrier
    s_add_u32 m0, s61, 8192
    s_add_u32 s42, s52, 32768
    buffer_load_dwordx4 v4, s[16:19], s42 offen sc1 lds
    s_add_u32 m0, s61, 9216
    s_add_u32 s42, s53, 32768
    buffer_load_dwordx4 v4, s[16:19], s42 offen sc1 lds
    s_add_u32 m0, s61, 10240
    s_add_u32 s42, s54, 32768
    buffer_load_dwordx4 v4, s[16:19], s42 offen sc1 lds
    s_add_u32 m0, s61, 11264
    s_add_u32 s42, s55, 32768
    buffer_load_dwordx4 v4, s[16:19], s42 offen sc1 lds
    s_waitcnt vmcnt(20)
    s_barrier
    s_add_u32 m0, s61, 16384
    s_add_u32 s42, s52, 34816
    s_mul_i32 s43, s63, 4096
    s_add_u32 s42, s42, s43
    buffer_load_dwordx4 v4, s[16:19], s42 offen sc1 lds
    s_add_u32 m0, s61, 17408
    s_add_u32 s42, s53, 34816
    s_mul_i32 s43, s64, 4096
    s_add_u32 s42, s42, s43
    buffer_load_dwordx4 v4, s[16:19], s42 offen sc1 lds
    s_add_u32 m0, s61, 18432
    s_add_u32 s42, s54, 34816
    s_mul_i32 s43, s65, 4096
    s_add_u32 s42, s42, s43
    buffer_load_dwordx4 v4, s[16:19], s42 offen sc1 lds
    s_add_u32 m0, s61, 19456
    s_add_u32 s42, s55, 34816
    s_mul_i32 s43, s66, 4096
    s_add_u32 s42, s42, s43
    buffer_load_dwordx4 v4, s[16:19], s42 offen sc1 lds
    s_waitcnt vmcnt(20)
    s_barrier
    s_add_u32 m0, s61, 24576
    s_add_u32 s42, s52, 40960
    buffer_load_dwordx4 v4, s[16:19], s42 offen sc1 lds
    s_add_u32 m0, s61, 25600
    s_add_u32 s42, s53, 40960
    buffer_load_dwordx4 v4, s[16:19], s42 offen sc1 lds
    s_add_u32 m0, s61, 26624
    s_add_u32 s42, s54, 40960
    buffer_load_dwordx4 v4, s[16:19], s42 offen sc1 lds
    s_add_u32 m0, s61, 27648
    s_add_u32 s42, s55, 40960
    buffer_load_dwordx4 v4, s[16:19], s42 offen sc1 lds
    s_waitcnt vmcnt(20)
    s_barrier
    s_add_u32 m0, s61, 32768
    s_add_u32 s42, s52, 47104
    buffer_load_dwordx4 v4, s[16:19], s42 offen sc1 lds
    s_add_u32 m0, s61, 33792
    s_add_u32 s42, s53, 47104
    buffer_load_dwordx4 v4, s[16:19], s42 offen sc1 lds
    s_add_u32 m0, s61, 34816
    s_add_u32 s42, s54, 47104
    buffer_load_dwordx4 v4, s[16:19], s42 offen sc1 lds
    s_add_u32 m0, s61, 35840
    s_add_u32 s42, s55, 47104
    buffer_load_dwordx4 v4, s[16:19], s42 offen sc1 lds
    s_waitcnt vmcnt(20)
    s_barrier
    s_add_u32 m0, s61, 40960
    s_add_u32 s42, s52, 53248
    buffer_load_dwordx4 v4, s[16:19], s42 offen sc1 lds
    s_add_u32 m0, s61, 41984
    s_add_u32 s42, s53, 53248
    buffer_load_dwordx4 v4, s[16:19], s42 offen sc1 lds
    s_add_u32 m0, s61, 43008
    s_add_u32 s42, s54, 53248
    buffer_load_dwordx4 v4, s[16:19], s42 offen sc1 lds
    s_add_u32 m0, s61, 44032
    s_add_u32 s42, s55, 53248
    buffer_load_dwordx4 v4, s[16:19], s42 offen sc1 lds
    s_waitcnt vmcnt(20)
    s_barrier
    s_waitcnt vmcnt(16)
    s_barrier
    s_waitcnt vmcnt(12)
    s_barrier
    s_waitcnt vmcnt(8)
    s_barrier
    s_waitcnt vmcnt(4)
    s_barrier
    s_waitcnt vmcnt(0)
    s_barrier
sequential_preLN__grouped_kv_mqa__dense_activation_silu__prompt_kernel_w2_done:
    s_endpgm
sequential_preLN__grouped_kv_mqa__dense_activation_silu__prompt_kernel_cons:
    s_mov_b32 s24, s4
    s_and_b32 s25, s5, 0xffff
    s_mov_b32 s26, 0x280000
    s_mov_b32 s27, 0x00020000
    v_and_b32 v2, 15, v1
    v_lshrrev_b32 v3, 4, v1
    s_and_b32 s44, s36, 1
    s_lshl_b32 s45, s37, 2
    s_lshl_b32 s42, s44, 1
    s_add_u32 s45, s45, s42
    v_mul_u32_u24 v5, 1280, v2
    v_lshl_add_u32 v5, v3, 3, v5
    s_mul_i32 s46, s45, 20480
    s_mul_i32 s42, s38, 160
    s_add_u32 s46, s46, s42
    s_add_u32 s47, s46, 20480
    s_mul_i32 s43, s38, 5
    s_lshl_b32 s42, s44, 12
    v_lshrrev_b32 v6, 1, v3
    v_lshl_add_u32 v6, v6, 4, v2
    v_lshlrev_b32 v6, 4, v6
    v_and_b32 v7, 1, v3

    v_mul_u32_u24 v7, 20480, v7
    v_add_u32 v8, v6, v7
    v_add_u32 v48, s42, v4
    v_add_u32 v49, 57344, v4
    v_add_u32 v50, 118784, v4
    s_cmp_ge_u32 s36, 2
    s_cbranch_scc1 sequential_preLN__grouped_kv_mqa__dense_activation_silu__prompt_kernel_c3b
    s_add_u32 s40, s43, 0
    s_lshl_b32 s40, s40, 9
    s_mul_i32 s41, s45, 20480
    s_add_u32 s40, s40, s41
    s_add_u32 s52, s40, 6291456
    s_add_u32 s55, s52, 20480

    s_add_u32 s40, s43, 1
    s_lshl_b32 s40, s40, 9
    s_mul_i32 s41, s45, 20480
    s_add_u32 s40, s40, s41
    s_add_u32 s53, s40, 6291456
    s_add_u32 s56, s53, 20480

    s_add_u32 s40, s43, 2
    s_lshl_b32 s40, s40, 9
    s_mul_i32 s41, s45, 20480
    s_add_u32 s40, s40, s41
    s_add_u32 s54, s40, 6291456
    s_add_u32 s57, s54, 20480

    buffer_load_dwordx2 v[36:37], v5, s[24:27], s46 offen offset:0
    buffer_load_dwordx2 v[40:41], v5, s[24:27], s46 offen offset:32
    buffer_load_dwordx2 v[44:45], v5, s[24:27], s46 offen offset:64
    buffer_load_dwordx2 v[38:39], v5, s[24:27], s47 offen offset:0
    buffer_load_dwordx2 v[42:43], v5, s[24:27], s47 offen offset:32
    buffer_load_dwordx2 v[46:47], v5, s[24:27], s47 offen offset:64
    s_barrier
    v_mov_b32 v9, 163824
    v_mov_b32 v10, 0
    v_mov_b32 v11, 0
    ds_write_b64 v9, v[10:11]
    ds_write_b64 v9, v[10:11] offset:8
    s_waitcnt lgkmcnt(0)

    s_barrier
    ds_read_b128 v[64:67], v48 offset:0
    ds_read_b128 v[68:71], v48 offset:2048
    ds_read_b128 v[72:75], v49 offset:0
    ds_read_b128 v[76:79], v49 offset:2048
    ds_read_b128 v[80:83], v49 offset:4096
    ds_read_b128 v[84:87], v48 offset:1024
    ds_read_b128 v[88:91], v48 offset:3072
    ds_read_b128 v[92:95], v49 offset:1024
    ds_read_b128 v[96:99], v49 offset:3072
    ds_read_b128 v[100:103], v49 offset:5120
    s_add_u32 s42, s14, 20480
    v_mov_b32 v250, 163824
    v_mov_b32 v251, 1
    s_waitcnt vmcnt(0)
    s_mov_b64 exec, 1
    ds_add_rtn_u32 v252, v250, v251
    v_mov_b32 v250, 0
    s_waitcnt lgkmcnt(0)
    v_readfirstlane_b32 s72, v252
    s_cmp_eq_u32 s72, 3
    s_cbranch_scc0 sequential_preLN__grouped_kv_mqa__dense_activation_silu__prompt_kernel_pub9
    buffer_atomic_add v251, v250, s[16:19], s42 offen sc1

sequential_preLN__grouped_kv_mqa__dense_activation_silu__prompt_kernel_pub9:
    s_mov_b64 exec, -1
    s_waitcnt lgkmcnt(0)
    s_barrier
    ds_read_b128 v[104:107], v48 offset:8192
    v_mfma_f32_16x16x32_bf16 v[12:15], v[72:75], v[64:67], 0
    ds_read_b128 v[108:111], v48 offset:10240
    v_mfma_f32_16x16x32_bf16 v[16:19], v[72:75], v[68:71], 0
    ds_read_b128 v[112:115], v49 offset:10240
    v_mfma_f32_16x16x32_bf16 v[20:23], v[76:79], v[64:67], 0
    ds_read_b128 v[116:119], v49 offset:12288
    v_mfma_f32_16x16x32_bf16 v[24:27], v[76:79], v[68:71], 0
    ds_read_b128 v[120:123], v49 offset:14336
    v_mfma_f32_16x16x32_bf16 v[28:31], v[80:83], v[64:67], 0
    ds_read_b128 v[124:127], v48 offset:9216
    v_mfma_f32_16x16x32_bf16 v[32:35], v[80:83], v[68:71], 0
    ds_read_b128 v[128:131], v48 offset:11264
    v_mfma_f32_16x16x32_bf16 v[12:15], v[92:95], v[84:87], v[12:15]
    ds_read_b128 v[132:135], v49 offset:11264
    v_mfma_f32_16x16x32_bf16 v[16:19], v[92:95], v[88:91], v[16:19]
    ds_read_b128 v[136:139], v49 offset:13312
    v_mfma_f32_16x16x32_bf16 v[20:23], v[96:99], v[84:87], v[20:23]
    ds_read_b128 v[140:143], v49 offset:15360
    v_mfma_f32_16x16x32_bf16 v[24:27], v[96:99], v[88:91], v[24:27]
    v_mfma_f32_16x16x32_bf16 v[28:31], v[100:103], v[84:87], v[28:31]
    v_mfma_f32_16x16x32_bf16 v[32:35], v[100:103], v[88:91], v[32:35]
    s_waitcnt lgkmcnt(0)
    s_barrier
    ds_read_b128 v[64:67], v48 offset:16384
    v_mfma_f32_16x16x32_bf16 v[12:15], v[112:115], v[104:107], v[12:15]
    ds_read_b128 v[68:71], v48 offset:18432
    v_mfma_f32_16x16x32_bf16 v[16:19], v[112:115], v[108:111], v[16:19]
    ds_read_b128 v[72:75], v49 offset:20480
    v_mfma_f32_16x16x32_bf16 v[20:23], v[116:119], v[104:107], v[20:23]
    ds_read_b128 v[76:79], v49 offset:22528
    v_mfma_f32_16x16x32_bf16 v[24:27], v[116:119], v[108:111], v[24:27]
    ds_read_b128 v[80:83], v49 offset:24576
    v_mfma_f32_16x16x32_bf16 v[28:31], v[120:123], v[104:107], v[28:31]
    ds_read_b128 v[84:87], v48 offset:17408
    v_mfma_f32_16x16x32_bf16 v[32:35], v[120:123], v[108:111], v[32:35]
    ds_read_b128 v[88:91], v48 offset:19456
    v_mfma_f32_16x16x32_bf16 v[12:15], v[132:135], v[124:127], v[12:15]
    ds_read_b128 v[92:95], v49 offset:21504
    v_mfma_f32_16x16x32_bf16 v[16:19], v[132:135], v[128:131], v[16:19]
    ds_read_b128 v[96:99], v49 offset:23552
    v_mfma_f32_16x16x32_bf16 v[20:23], v[136:139], v[124:127], v[20:23]
    ds_read_b128 v[100:103], v49 offset:25600
    v_mfma_f32_16x16x32_bf16 v[24:27], v[136:139], v[128:131], v[24:27]
    v_mfma_f32_16x16x32_bf16 v[28:31], v[140:143], v[124:127], v[28:31]
    v_mfma_f32_16x16x32_bf16 v[32:35], v[140:143], v[128:131], v[32:35]
    s_waitcnt lgkmcnt(0)
    s_barrier
    ds_read_b128 v[104:107], v48 offset:24576
    v_mfma_f32_16x16x32_bf16 v[12:15], v[72:75], v[64:67], v[12:15]
    ds_read_b128 v[108:111], v48 offset:26624
    v_mfma_f32_16x16x32_bf16 v[16:19], v[72:75], v[68:71], v[16:19]
    ds_read_b128 v[112:115], v49 offset:30720
    v_mfma_f32_16x16x32_bf16 v[20:23], v[76:79], v[64:67], v[20:23]
    ds_read_b128 v[116:119], v49 offset:32768
    v_mfma_f32_16x16x32_bf16 v[24:27], v[76:79], v[68:71], v[24:27]
    ds_read_b128 v[120:123], v49 offset:34816
    v_mfma_f32_16x16x32_bf16 v[28:31], v[80:83], v[64:67], v[28:31]
    ds_read_b128 v[124:127], v48 offset:25600
    v_mfma_f32_16x16x32_bf16 v[32:35], v[80:83], v[68:71], v[32:35]
    ds_read_b128 v[128:131], v48 offset:27648
    v_mfma_f32_16x16x32_bf16 v[12:15], v[92:95], v[84:87], v[12:15]
    ds_read_b128 v[132:135], v49 offset:31744
    v_mfma_f32_16x16x32_bf16 v[16:19], v[92:95], v[88:91], v[16:19]
    ds_read_b128 v[136:139], v49 offset:33792
    v_mfma_f32_16x16x32_bf16 v[20:23], v[96:99], v[84:87], v[20:23]
    ds_read_b128 v[140:143], v49 offset:35840
    v_mfma_f32_16x16x32_bf16 v[24:27], v[96:99], v[88:91], v[24:27]
    v_mfma_f32_16x16x32_bf16 v[28:31], v[100:103], v[84:87], v[28:31]
    v_mfma_f32_16x16x32_bf16 v[32:35], v[100:103], v[88:91], v[32:35]
    s_waitcnt lgkmcnt(0)
    s_barrier
    ds_read_b128 v[64:67], v48 offset:32768
    v_mfma_f32_16x16x32_bf16 v[12:15], v[112:115], v[104:107], v[12:15]
    ds_read_b128 v[68:71], v48 offset:34816
    v_mfma_f32_16x16x32_bf16 v[16:19], v[112:115], v[108:111], v[16:19]
    ds_read_b128 v[72:75], v49 offset:40960
    v_mfma_f32_16x16x32_bf16 v[20:23], v[116:119], v[104:107], v[20:23]
    ds_read_b128 v[76:79], v49 offset:43008
    v_mfma_f32_16x16x32_bf16 v[24:27], v[116:119], v[108:111], v[24:27]
    ds_read_b128 v[80:83], v49 offset:45056
    v_mfma_f32_16x16x32_bf16 v[28:31], v[120:123], v[104:107], v[28:31]
    ds_read_b128 v[84:87], v48 offset:33792
    v_mfma_f32_16x16x32_bf16 v[32:35], v[120:123], v[108:111], v[32:35]
    ds_read_b128 v[88:91], v48 offset:35840
    v_mfma_f32_16x16x32_bf16 v[12:15], v[132:135], v[124:127], v[12:15]
    ds_read_b128 v[92:95], v49 offset:41984
    v_mfma_f32_16x16x32_bf16 v[16:19], v[132:135], v[128:131], v[16:19]
    ds_read_b128 v[96:99], v49 offset:44032
    v_mfma_f32_16x16x32_bf16 v[20:23], v[136:139], v[124:127], v[20:23]
    ds_read_b128 v[100:103], v49 offset:46080
    v_mfma_f32_16x16x32_bf16 v[24:27], v[136:139], v[128:131], v[24:27]
    v_mfma_f32_16x16x32_bf16 v[28:31], v[140:143], v[124:127], v[28:31]
    v_mfma_f32_16x16x32_bf16 v[32:35], v[140:143], v[128:131], v[32:35]
    s_waitcnt lgkmcnt(0)
    s_barrier
    ds_read_b128 v[104:107], v48 offset:40960
    v_mfma_f32_16x16x32_bf16 v[12:15], v[72:75], v[64:67], v[12:15]
    ds_read_b128 v[108:111], v48 offset:43008
    v_mfma_f32_16x16x32_bf16 v[16:19], v[72:75], v[68:71], v[16:19]
    ds_read_b128 v[112:115], v49 offset:51200
    v_mfma_f32_16x16x32_bf16 v[20:23], v[76:79], v[64:67], v[20:23]
    ds_read_b128 v[116:119], v49 offset:53248
    v_mfma_f32_16x16x32_bf16 v[24:27], v[76:79], v[68:71], v[24:27]
    ds_read_b128 v[120:123], v49 offset:55296
    v_mfma_f32_16x16x32_bf16 v[28:31], v[80:83], v[64:67], v[28:31]
    ds_read_b128 v[124:127], v48 offset:41984
    v_mfma_f32_16x16x32_bf16 v[32:35], v[80:83], v[68:71], v[32:35]
    ds_read_b128 v[128:131], v48 offset:44032
    v_mfma_f32_16x16x32_bf16 v[12:15], v[92:95], v[84:87], v[12:15]
    ds_read_b128 v[132:135], v49 offset:52224
    v_mfma_f32_16x16x32_bf16 v[16:19], v[92:95], v[88:91], v[16:19]
    ds_read_b128 v[136:139], v49 offset:54272
    v_mfma_f32_16x16x32_bf16 v[20:23], v[96:99], v[84:87], v[20:23]
    ds_read_b128 v[140:143], v49 offset:56320
    v_mfma_f32_16x16x32_bf16 v[24:27], v[96:99], v[88:91], v[24:27]
    v_mfma_f32_16x16x32_bf16 v[28:31], v[100:103], v[84:87], v[28:31]
    v_mfma_f32_16x16x32_bf16 v[32:35], v[100:103], v[88:91], v[32:35]
    s_waitcnt lgkmcnt(0)
    s_barrier
    ds_read_b128 v[64:67], v48 offset:49152
    v_mfma_f32_16x16x32_bf16 v[12:15], v[112:115], v[104:107], v[12:15]
    ds_read_b128 v[68:71], v48 offset:51200
    v_mfma_f32_16x16x32_bf16 v[16:19], v[112:115], v[108:111], v[16:19]
    ds_read_b128 v[72:75], v50 offset:0
    v_mfma_f32_16x16x32_bf16 v[20:23], v[116:119], v[104:107], v[20:23]
    ds_read_b128 v[76:79], v50 offset:2048
    v_mfma_f32_16x16x32_bf16 v[24:27], v[116:119], v[108:111], v[24:27]
    ds_read_b128 v[80:83], v50 offset:4096
    v_mfma_f32_16x16x32_bf16 v[28:31], v[120:123], v[104:107], v[28:31]
    ds_read_b128 v[84:87], v48 offset:50176
    v_mfma_f32_16x16x32_bf16 v[32:35], v[120:123], v[108:111], v[32:35]
    ds_read_b128 v[88:91], v48 offset:52224
    v_mfma_f32_16x16x32_bf16 v[12:15], v[132:135], v[124:127], v[12:15]
    ds_read_b128 v[92:95], v50 offset:1024
    v_mfma_f32_16x16x32_bf16 v[16:19], v[132:135], v[128:131], v[16:19]
    ds_read_b128 v[96:99], v50 offset:3072
    v_mfma_f32_16x16x32_bf16 v[20:23], v[136:139], v[124:127], v[20:23]
    ds_read_b128 v[100:103], v50 offset:5120
    v_mfma_f32_16x16x32_bf16 v[24:27], v[136:139], v[128:131], v[24:27]
    v_mfma_f32_16x16x32_bf16 v[28:31], v[140:143], v[124:127], v[28:31]
    v_mfma_f32_16x16x32_bf16 v[32:35], v[140:143], v[128:131], v[32:35]
    s_waitcnt lgkmcnt(0)
    s_barrier
    ds_read_b128 v[104:107], v48 offset:0
    v_mfma_f32_16x16x32_bf16 v[12:15], v[72:75], v[64:67], v[12:15]
    ds_read_b128 v[108:111], v48 offset:2048
    v_mfma_f32_16x16x32_bf16 v[16:19], v[72:75], v[68:71], v[16:19]
    ds_read_b128 v[112:115], v49 offset:0
    v_mfma_f32_16x16x32_bf16 v[20:23], v[76:79], v[64:67], v[20:23]
    ds_read_b128 v[116:119], v49 offset:2048
    v_mfma_f32_16x16x32_bf16 v[24:27], v[76:79], v[68:71], v[24:27]
    ds_read_b128 v[120:123], v49 offset:4096
    v_mfma_f32_16x16x32_bf16 v[28:31], v[80:83], v[64:67], v[28:31]
    ds_read_b128 v[124:127], v48 offset:1024
    v_mfma_f32_16x16x32_bf16 v[32:35], v[80:83], v[68:71], v[32:35]
    ds_read_b128 v[128:131], v48 offset:3072
    v_mfma_f32_16x16x32_bf16 v[12:15], v[92:95], v[84:87], v[12:15]
    ds_read_b128 v[132:135], v49 offset:1024
    v_mfma_f32_16x16x32_bf16 v[16:19], v[92:95], v[88:91], v[16:19]
    ds_read_b128 v[136:139], v49 offset:3072
    v_mfma_f32_16x16x32_bf16 v[20:23], v[96:99], v[84:87], v[20:23]
    ds_read_b128 v[140:143], v49 offset:5120
    v_mfma_f32_16x16x32_bf16 v[24:27], v[96:99], v[88:91], v[24:27]
    v_mfma_f32_16x16x32_bf16 v[28:31], v[100:103], v[84:87], v[28:31]
    v_mfma_f32_16x16x32_bf16 v[32:35], v[100:103], v[88:91], v[32:35]
    s_waitcnt lgkmcnt(0)
    s_barrier
    ds_read_b128 v[64:67], v48 offset:8192
    v_mfma_f32_16x16x32_bf16 v[12:15], v[112:115], v[104:107], v[12:15]
    ds_read_b128 v[68:71], v48 offset:10240
    v_mfma_f32_16x16x32_bf16 v[16:19], v[112:115], v[108:111], v[16:19]
    ds_read_b128 v[72:75], v49 offset:10240
    v_mfma_f32_16x16x32_bf16 v[20:23], v[116:119], v[104:107], v[20:23]
    ds_read_b128 v[76:79], v49 offset:12288
    v_mfma_f32_16x16x32_bf16 v[24:27], v[116:119], v[108:111], v[24:27]
    ds_read_b128 v[80:83], v49 offset:14336
    v_mfma_f32_16x16x32_bf16 v[28:31], v[120:123], v[104:107], v[28:31]
    ds_read_b128 v[84:87], v48 offset:9216
    v_mfma_f32_16x16x32_bf16 v[32:35], v[120:123], v[108:111], v[32:35]
    ds_read_b128 v[88:91], v48 offset:11264
    v_mfma_f32_16x16x32_bf16 v[12:15], v[132:135], v[124:127], v[12:15]
    ds_read_b128 v[92:95], v49 offset:11264
    v_mfma_f32_16x16x32_bf16 v[16:19], v[132:135], v[128:131], v[16:19]
    ds_read_b128 v[96:99], v49 offset:13312
    v_mfma_f32_16x16x32_bf16 v[20:23], v[136:139], v[124:127], v[20:23]
    ds_read_b128 v[100:103], v49 offset:15360
    v_mfma_f32_16x16x32_bf16 v[24:27], v[136:139], v[128:131], v[24:27]
    v_mfma_f32_16x16x32_bf16 v[28:31], v[140:143], v[124:127], v[28:31]
    v_mfma_f32_16x16x32_bf16 v[32:35], v[140:143], v[128:131], v[32:35]
    s_waitcnt lgkmcnt(0)
    s_barrier
    ds_read_b128 v[104:107], v48 offset:16384
    v_mfma_f32_16x16x32_bf16 v[12:15], v[72:75], v[64:67], v[12:15]
    ds_read_b128 v[108:111], v48 offset:18432
    v_mfma_f32_16x16x32_bf16 v[16:19], v[72:75], v[68:71], v[16:19]
    ds_read_b128 v[112:115], v49 offset:20480
    v_mfma_f32_16x16x32_bf16 v[20:23], v[76:79], v[64:67], v[20:23]
    ds_read_b128 v[116:119], v49 offset:22528
    v_mfma_f32_16x16x32_bf16 v[24:27], v[76:79], v[68:71], v[24:27]
    ds_read_b128 v[120:123], v49 offset:24576
    v_mfma_f32_16x16x32_bf16 v[28:31], v[80:83], v[64:67], v[28:31]
    ds_read_b128 v[124:127], v48 offset:17408
    v_mfma_f32_16x16x32_bf16 v[32:35], v[80:83], v[68:71], v[32:35]
    ds_read_b128 v[128:131], v48 offset:19456
    v_mfma_f32_16x16x32_bf16 v[12:15], v[92:95], v[84:87], v[12:15]
    ds_read_b128 v[132:135], v49 offset:21504
    v_mfma_f32_16x16x32_bf16 v[16:19], v[92:95], v[88:91], v[16:19]
    ds_read_b128 v[136:139], v49 offset:23552
    v_mfma_f32_16x16x32_bf16 v[20:23], v[96:99], v[84:87], v[20:23]
    ds_read_b128 v[140:143], v49 offset:25600
    v_mfma_f32_16x16x32_bf16 v[24:27], v[96:99], v[88:91], v[24:27]
    v_mfma_f32_16x16x32_bf16 v[28:31], v[100:103], v[84:87], v[28:31]
    v_mfma_f32_16x16x32_bf16 v[32:35], v[100:103], v[88:91], v[32:35]
    s_waitcnt lgkmcnt(0)
    s_barrier
    v_mfma_f32_16x16x32_bf16 v[12:15], v[112:115], v[104:107], v[12:15]
    v_mfma_f32_16x16x32_bf16 v[16:19], v[112:115], v[108:111], v[16:19]
    v_mfma_f32_16x16x32_bf16 v[20:23], v[116:119], v[104:107], v[20:23]
    v_mfma_f32_16x16x32_bf16 v[24:27], v[116:119], v[108:111], v[24:27]
    v_mfma_f32_16x16x32_bf16 v[28:31], v[120:123], v[104:107], v[28:31]
    v_mfma_f32_16x16x32_bf16 v[32:35], v[120:123], v[108:111], v[32:35]
    v_mfma_f32_16x16x32_bf16 v[12:15], v[132:135], v[124:127], v[12:15]
    v_mfma_f32_16x16x32_bf16 v[16:19], v[132:135], v[128:131], v[16:19]
    v_mfma_f32_16x16x32_bf16 v[20:23], v[136:139], v[124:127], v[20:23]
    v_mfma_f32_16x16x32_bf16 v[24:27], v[136:139], v[128:131], v[24:27]
    v_mfma_f32_16x16x32_bf16 v[28:31], v[140:143], v[124:127], v[28:31]
    v_mfma_f32_16x16x32_bf16 v[32:35], v[140:143], v[128:131], v[32:35]
    s_waitcnt vmcnt(0)
    v_lshlrev_b32 v64, 16, v36
    v_and_b32 v65, 0xffff0000, v36
    v_lshlrev_b32 v66, 16, v37
    v_and_b32 v67, 0xffff0000, v37
    v_lshlrev_b32 v68, 16, v38
    v_and_b32 v69, 0xffff0000, v38
    v_lshlrev_b32 v70, 16, v39
    v_and_b32 v71, 0xffff0000, v39
    v_lshlrev_b32 v72, 16, v40
    v_and_b32 v73, 0xffff0000, v40
    v_lshlrev_b32 v74, 16, v41
    v_and_b32 v75, 0xffff0000, v41
    v_lshlrev_b32 v76, 16, v42
    v_and_b32 v77, 0xffff0000, v42
    v_lshlrev_b32 v78, 16, v43
    v_and_b32 v79, 0xffff0000, v43
    v_lshlrev_b32 v80, 16, v44
    v_and_b32 v81, 0xffff0000, v44
    v_lshlrev_b32 v82, 16, v45
    v_and_b32 v83, 0xffff0000, v45
    v_lshlrev_b32 v84, 16, v46
    v_and_b32 v85, 0xffff0000, v46
    v_lshlrev_b32 v86, 16, v47
    v_and_b32 v87, 0xffff0000, v47
    v_add_f32 v12, v12, v64
    v_add_f32 v13, v13, v65
    v_add_f32 v14, v14, v66
    v_add_f32 v15, v15, v67
    v_cvt_pk_bf16_f32 v36, v12, v13
    v_cvt_pk_bf16_f32 v37, v14, v15
    v_add_f32 v16, v16, v68
    v_add_f32 v17, v17, v69
    v_add_f32 v18, v18, v70
    v_add_f32 v19, v19, v71
    v_cvt_pk_bf16_f32 v38, v16, v17
    v_cvt_pk_bf16_f32 v39, v18, v19
    v_add_f32 v20, v20, v72
    v_add_f32 v21, v21, v73
    v_add_f32 v22, v22, v74
    v_add_f32 v23, v23, v75
    v_cvt_pk_bf16_f32 v40, v20, v21
    v_cvt_pk_bf16_f32 v41, v22, v23
    v_add_f32 v24, v24, v76
    v_add_f32 v25, v25, v77
    v_add_f32 v26, v26, v78
    v_add_f32 v27, v27, v79
    v_cvt_pk_bf16_f32 v42, v24, v25
    v_cvt_pk_bf16_f32 v43, v26, v27
    v_add_f32 v28, v28, v80
    v_add_f32 v29, v29, v81
    v_add_f32 v30, v30, v82
    v_add_f32 v31, v31, v83
    v_cvt_pk_bf16_f32 v44, v28, v29
    v_cvt_pk_bf16_f32 v45, v30, v31
    v_add_f32 v32, v32, v84
    v_add_f32 v33, v33, v85
    v_add_f32 v34, v34, v86
    v_add_f32 v35, v35, v87
    v_cvt_pk_bf16_f32 v46, v32, v33
    v_cvt_pk_bf16_f32 v47, v34, v35
    v_lshlrev_b32 v64, 16, v36
    v_and_b32 v65, 0xffff0000, v36
    v_lshlrev_b32 v66, 16, v37
    v_and_b32 v67, 0xffff0000, v37
    v_lshlrev_b32 v68, 16, v38
    v_and_b32 v69, 0xffff0000, v38
    v_lshlrev_b32 v70, 16, v39
    v_and_b32 v71, 0xffff0000, v39
    v_lshlrev_b32 v72, 16, v40
    v_and_b32 v73, 0xffff0000, v40
    v_lshlrev_b32 v74, 16, v41
    v_and_b32 v75, 0xffff0000, v41
    v_lshlrev_b32 v76, 16, v42
    v_and_b32 v77, 0xffff0000, v42
    v_lshlrev_b32 v78, 16, v43
    v_and_b32 v79, 0xffff0000, v43
    v_lshlrev_b32 v80, 16, v44
    v_and_b32 v81, 0xffff0000, v44
    v_lshlrev_b32 v82, 16, v45
    v_and_b32 v83, 0xffff0000, v45
    v_lshlrev_b32 v84, 16, v46
    v_and_b32 v85, 0xffff0000, v46
    v_lshlrev_b32 v86, 16, v47
    v_and_b32 v87, 0xffff0000, v47
    v_permlane16_swap_b32 v36, v38
    v_permlane16_swap_b32 v37, v39
    buffer_store_dwordx4 v[36:39], v8, s[16:19], s52 offen sc1
    v_permlane16_swap_b32 v40, v42
    v_permlane16_swap_b32 v41, v43
    buffer_store_dwordx4 v[40:43], v8, s[16:19], s53 offen sc1
    v_permlane16_swap_b32 v44, v46
    v_permlane16_swap_b32 v45, v47
    buffer_store_dwordx4 v[44:47], v8, s[16:19], s54 offen sc1
    v_add_f32 v12, v64, v65
    v_mul_f32 v13, v64, v64
    v_fmac_f32 v13, v65, v65
    v_add_f32 v12, v12, v66
    v_fmac_f32 v13, v66, v66
    v_add_f32 v12, v12, v67
    v_fmac_f32 v13, v67, v67
    v_add_f32 v12, v12, v72
    v_fmac_f32 v13, v72, v72
    v_add_f32 v12, v12, v73
    v_fmac_f32 v13, v73, v73
    v_add_f32 v12, v12, v74
    v_fmac_f32 v13, v74, v74
    v_add_f32 v12, v12, v75
    v_fmac_f32 v13, v75, v75
    v_add_f32 v12, v12, v80
    v_fmac_f32 v13, v80, v80
    v_add_f32 v12, v12, v81
    v_fmac_f32 v13, v81, v81
    v_add_f32 v12, v12, v82
    v_fmac_f32 v13, v82, v82
    v_add_f32 v12, v12, v83
    v_fmac_f32 v13, v83, v83
    v_add_f32 v14, v68, v69
    v_mul_f32 v15, v68, v68
    v_fmac_f32 v15, v69, v69
    v_add_f32 v14, v14, v70
    v_fmac_f32 v15, v70, v70
    v_add_f32 v14, v14, v71
    v_fmac_f32 v15, v71, v71
    v_add_f32 v14, v14, v76
    v_fmac_f32 v15, v76, v76
    v_add_f32 v14, v14, v77
    v_fmac_f32 v15, v77, v77
    v_add_f32 v14, v14, v78
    v_fmac_f32 v15, v78, v78
    v_add_f32 v14, v14, v79
    v_fmac_f32 v15, v79, v79
    v_add_f32 v14, v14, v84
    v_fmac_f32 v15, v84, v84
    v_add_f32 v14, v14, v85
    v_fmac_f32 v15, v85, v85
    v_add_f32 v14, v14, v86
    v_fmac_f32 v15, v86, v86
    v_add_f32 v14, v14, v87
    v_fmac_f32 v15, v87, v87
    v_mov_b32 v16, v12
    v_mov_b32 v17, v13
    v_mov_b32 v18, v14
    v_mov_b32 v19, v15
    s_nop 1
    v_permlane16_swap_b32 v12, v16
    v_permlane16_swap_b32 v13, v17
    v_permlane16_swap_b32 v14, v18
    v_permlane16_swap_b32 v15, v19
    s_nop 1
    v_add_f32 v12, v12, v16
    v_add_f32 v13, v13, v17
    v_add_f32 v14, v14, v18
    v_add_f32 v15, v15, v19
    v_mov_b32 v16, v12
    v_mov_b32 v17, v13
    v_mov_b32 v18, v14
    v_mov_b32 v19, v15
    s_nop 1
    v_permlane32_swap_b32 v12, v16
    v_permlane32_swap_b32 v13, v17
    v_permlane32_swap_b32 v14, v18
    v_permlane32_swap_b32 v15, v19
    s_nop 1
    v_add_f32 v12, v12, v16
    v_add_f32 v13, v13, v17
    v_add_f32 v14, v14, v18
    v_add_f32 v15, v15, v19
    v_lshlrev_b32 v9, 7, v2
    v_cmp_eq_u32 vcc, 0, v3
    v_mov_b32 v10, 0x7fffff00
    s_lshl_b32 s40, s45, 11
    s_lshl_b32 s41, s38, 4
    s_add_u32 s40, s40, s41
    s_add_u32 s40, s40, 9437184
    v_cndmask_b32 v9, v10, v9, vcc
    buffer_store_dwordx2 v[12:13], v9, s[16:19], s40 offen sc1
    buffer_store_dwordx2 v[14:15], v9, s[16:19], s40 offen offset:2048 sc1
    s_add_u32 s42, s14, 4096

    v_mov_b32 v250, 163828
    v_mov_b32 v251, 1
    s_waitcnt vmcnt(0)
    s_mov_b64 exec, 1
    ds_add_rtn_u32 v252, v250, v251
    v_mov_b32 v250, 0
    s_waitcnt lgkmcnt(0)
    v_readfirstlane_b32 s72, v252
    s_cmp_eq_u32 s72, 3
    s_cbranch_scc0 sequential_preLN__grouped_kv_mqa__dense_activation_silu__prompt_kernel_pub10
    buffer_atomic_add v251, v250, s[16:19], s42 offen sc1

sequential_preLN__grouped_kv_mqa__dense_activation_silu__prompt_kernel_pub10:
    s_mov_b64 exec, -1
    s_branch sequential_preLN__grouped_kv_mqa__dense_activation_silu__prompt_kernel_c4
sequential_preLN__grouped_kv_mqa__dense_activation_silu__prompt_kernel_c3b:
    s_add_u32 s40, s43, 3
    s_lshl_b32 s40, s40, 9
    s_mul_i32 s41, s45, 20480
    s_add_u32 s40, s40, s41
    s_add_u32 s52, s40, 6291456
    s_add_u32 s55, s52, 20480

    s_add_u32 s40, s43, 4
    s_lshl_b32 s40, s40, 9
    s_mul_i32 s41, s45, 20480
    s_add_u32 s40, s40, s41
    s_add_u32 s53, s40, 6291456
    s_add_u32 s56, s53, 20480

    buffer_load_dwordx2 v[36:37], v5, s[24:27], s46 offen offset:96
    buffer_load_dwordx2 v[40:41], v5, s[24:27], s46 offen offset:128
    buffer_load_dwordx2 v[38:39], v5, s[24:27], s47 offen offset:96
    buffer_load_dwordx2 v[42:43], v5, s[24:27], s47 offen offset:128
    s_barrier
    v_mov_b32 v9, 163824
    v_mov_b32 v10, 0
    v_mov_b32 v11, 0
    ds_write_b64 v9, v[10:11]
    ds_write_b64 v9, v[10:11] offset:8
    s_waitcnt lgkmcnt(0)

    s_barrier
    ds_read_b128 v[64:67], v48 offset:0
    ds_read_b128 v[68:71], v48 offset:2048
    ds_read_b128 v[72:75], v49 offset:6144
    ds_read_b128 v[76:79], v49 offset:8192
    ds_read_b128 v[84:87], v48 offset:1024
    ds_read_b128 v[88:91], v48 offset:3072
    ds_read_b128 v[92:95], v49 offset:7168
    ds_read_b128 v[96:99], v49 offset:9216
    s_add_u32 s42, s14, 20480
    v_mov_b32 v250, 163824
    v_mov_b32 v251, 1
    s_waitcnt vmcnt(0)
    s_mov_b64 exec, 1
    ds_add_rtn_u32 v252, v250, v251
    v_mov_b32 v250, 0
    s_waitcnt lgkmcnt(0)
    v_readfirstlane_b32 s72, v252
    s_cmp_eq_u32 s72, 3
    s_cbranch_scc0 sequential_preLN__grouped_kv_mqa__dense_activation_silu__prompt_kernel_pub11
    buffer_atomic_add v251, v250, s[16:19], s42 offen sc1

sequential_preLN__grouped_kv_mqa__dense_activation_silu__prompt_kernel_pub11:
    s_mov_b64 exec, -1
    s_waitcnt lgkmcnt(0)
    s_barrier
    ds_read_b128 v[104:107], v48 offset:8192
    v_mfma_f32_16x16x32_bf16 v[12:15], v[72:75], v[64:67], 0
    ds_read_b128 v[108:111], v48 offset:10240
    v_mfma_f32_16x16x32_bf16 v[16:19], v[72:75], v[68:71], 0
    ds_read_b128 v[112:115], v49 offset:16384
    v_mfma_f32_16x16x32_bf16 v[20:23], v[76:79], v[64:67], 0
    ds_read_b128 v[116:119], v49 offset:18432
    v_mfma_f32_16x16x32_bf16 v[24:27], v[76:79], v[68:71], 0
    ds_read_b128 v[124:127], v48 offset:9216
    v_mfma_f32_16x16x32_bf16 v[12:15], v[92:95], v[84:87], v[12:15]
    ds_read_b128 v[128:131], v48 offset:11264
    v_mfma_f32_16x16x32_bf16 v[16:19], v[92:95], v[88:91], v[16:19]
    ds_read_b128 v[132:135], v49 offset:17408
    v_mfma_f32_16x16x32_bf16 v[20:23], v[96:99], v[84:87], v[20:23]
    ds_read_b128 v[136:139], v49 offset:19456
    v_mfma_f32_16x16x32_bf16 v[24:27], v[96:99], v[88:91], v[24:27]
    s_waitcnt lgkmcnt(0)
    s_barrier
    ds_read_b128 v[64:67], v48 offset:16384
    v_mfma_f32_16x16x32_bf16 v[12:15], v[112:115], v[104:107], v[12:15]
    ds_read_b128 v[68:71], v48 offset:18432
    v_mfma_f32_16x16x32_bf16 v[16:19], v[112:115], v[108:111], v[16:19]
    ds_read_b128 v[72:75], v49 offset:26624
    v_mfma_f32_16x16x32_bf16 v[20:23], v[116:119], v[104:107], v[20:23]
    ds_read_b128 v[76:79], v49 offset:28672
    v_mfma_f32_16x16x32_bf16 v[24:27], v[116:119], v[108:111], v[24:27]
    ds_read_b128 v[84:87], v48 offset:17408
    v_mfma_f32_16x16x32_bf16 v[12:15], v[132:135], v[124:127], v[12:15]
    ds_read_b128 v[88:91], v48 offset:19456
    v_mfma_f32_16x16x32_bf16 v[16:19], v[132:135], v[128:131], v[16:19]
    ds_read_b128 v[92:95], v49 offset:27648
    v_mfma_f32_16x16x32_bf16 v[20:23], v[136:139], v[124:127], v[20:23]
    ds_read_b128 v[96:99], v49 offset:29696
    v_mfma_f32_16x16x32_bf16 v[24:27], v[136:139], v[128:131], v[24:27]
    s_waitcnt lgkmcnt(0)
    s_barrier
    ds_read_b128 v[104:107], v48 offset:24576
    v_mfma_f32_16x16x32_bf16 v[12:15], v[72:75], v[64:67], v[12:15]
    ds_read_b128 v[108:111], v48 offset:26624
    v_mfma_f32_16x16x32_bf16 v[16:19], v[72:75], v[68:71], v[16:19]
    ds_read_b128 v[112:115], v49 offset:36864
    v_mfma_f32_16x16x32_bf16 v[20:23], v[76:79], v[64:67], v[20:23]
    ds_read_b128 v[116:119], v49 offset:38912
    v_mfma_f32_16x16x32_bf16 v[24:27], v[76:79], v[68:71], v[24:27]
    ds_read_b128 v[124:127], v48 offset:25600
    v_mfma_f32_16x16x32_bf16 v[12:15], v[92:95], v[84:87], v[12:15]
    ds_read_b128 v[128:131], v48 offset:27648
    v_mfma_f32_16x16x32_bf16 v[16:19], v[92:95], v[88:91], v[16:19]
    ds_read_b128 v[132:135], v49 offset:37888
    v_mfma_f32_16x16x32_bf16 v[20:23], v[96:99], v[84:87], v[20:23]
    ds_read_b128 v[136:139], v49 offset:39936
    v_mfma_f32_16x16x32_bf16 v[24:27], v[96:99], v[88:91], v[24:27]
    s_waitcnt lgkmcnt(0)
    s_barrier
    ds_read_b128 v[64:67], v48 offset:32768
    v_mfma_f32_16x16x32_bf16 v[12:15], v[112:115], v[104:107], v[12:15]
    ds_read_b128 v[68:71], v48 offset:34816
    v_mfma_f32_16x16x32_bf16 v[16:19], v[112:115], v[108:111], v[16:19]
    ds_read_b128 v[72:75], v49 offset:47104
    v_mfma_f32_16x16x32_bf16 v[20:23], v[116:119], v[104:107], v[20:23]
    ds_read_b128 v[76:79], v49 offset:49152
    v_mfma_f32_16x16x32_bf16 v[24:27], v[116:119], v[108:111], v[24:27]
    ds_read_b128 v[84:87], v48 offset:33792
    v_mfma_f32_16x16x32_bf16 v[12:15], v[132:135], v[124:127], v[12:15]
    ds_read_b128 v[88:91], v48 offset:35840
    v_mfma_f32_16x16x32_bf16 v[16:19], v[132:135], v[128:131], v[16:19]
    ds_read_b128 v[92:95], v49 offset:48128
    v_mfma_f32_16x16x32_bf16 v[20:23], v[136:139], v[124:127], v[20:23]
    ds_read_b128 v[96:99], v49 offset:50176
    v_mfma_f32_16x16x32_bf16 v[24:27], v[136:139], v[128:131], v[24:27]
    s_waitcnt lgkmcnt(0)
    s_barrier
    ds_read_b128 v[104:107], v48 offset:40960
    v_mfma_f32_16x16x32_bf16 v[12:15], v[72:75], v[64:67], v[12:15]
    ds_read_b128 v[108:111], v48 offset:43008
    v_mfma_f32_16x16x32_bf16 v[16:19], v[72:75], v[68:71], v[16:19]
    ds_read_b128 v[112:115], v49 offset:57344
    v_mfma_f32_16x16x32_bf16 v[20:23], v[76:79], v[64:67], v[20:23]
    ds_read_b128 v[116:119], v49 offset:59392
    v_mfma_f32_16x16x32_bf16 v[24:27], v[76:79], v[68:71], v[24:27]
    ds_read_b128 v[124:127], v48 offset:41984
    v_mfma_f32_16x16x32_bf16 v[12:15], v[92:95], v[84:87], v[12:15]
    ds_read_b128 v[128:131], v48 offset:44032
    v_mfma_f32_16x16x32_bf16 v[16:19], v[92:95], v[88:91], v[16:19]
    ds_read_b128 v[132:135], v49 offset:58368
    v_mfma_f32_16x16x32_bf16 v[20:23], v[96:99], v[84:87], v[20:23]
    ds_read_b128 v[136:139], v49 offset:60416
    v_mfma_f32_16x16x32_bf16 v[24:27], v[96:99], v[88:91], v[24:27]
    s_waitcnt lgkmcnt(0)
    s_barrier
    ds_read_b128 v[64:67], v48 offset:49152
    v_mfma_f32_16x16x32_bf16 v[12:15], v[112:115], v[104:107], v[12:15]
    ds_read_b128 v[68:71], v48 offset:51200
    v_mfma_f32_16x16x32_bf16 v[16:19], v[112:115], v[108:111], v[16:19]
    ds_read_b128 v[72:75], v50 offset:6144
    v_mfma_f32_16x16x32_bf16 v[20:23], v[116:119], v[104:107], v[20:23]
    ds_read_b128 v[76:79], v50 offset:8192
    v_mfma_f32_16x16x32_bf16 v[24:27], v[116:119], v[108:111], v[24:27]
    ds_read_b128 v[84:87], v48 offset:50176
    v_mfma_f32_16x16x32_bf16 v[12:15], v[132:135], v[124:127], v[12:15]
    ds_read_b128 v[88:91], v48 offset:52224
    v_mfma_f32_16x16x32_bf16 v[16:19], v[132:135], v[128:131], v[16:19]
    ds_read_b128 v[92:95], v50 offset:7168
    v_mfma_f32_16x16x32_bf16 v[20:23], v[136:139], v[124:127], v[20:23]
    ds_read_b128 v[96:99], v50 offset:9216
    v_mfma_f32_16x16x32_bf16 v[24:27], v[136:139], v[128:131], v[24:27]
    s_waitcnt lgkmcnt(0)
    s_barrier
    ds_read_b128 v[104:107], v48 offset:0
    v_mfma_f32_16x16x32_bf16 v[12:15], v[72:75], v[64:67], v[12:15]
    ds_read_b128 v[108:111], v48 offset:2048
    v_mfma_f32_16x16x32_bf16 v[16:19], v[72:75], v[68:71], v[16:19]
    ds_read_b128 v[112:115], v49 offset:6144
    v_mfma_f32_16x16x32_bf16 v[20:23], v[76:79], v[64:67], v[20:23]
    ds_read_b128 v[116:119], v49 offset:8192
    v_mfma_f32_16x16x32_bf16 v[24:27], v[76:79], v[68:71], v[24:27]
    ds_read_b128 v[124:127], v48 offset:1024
    v_mfma_f32_16x16x32_bf16 v[12:15], v[92:95], v[84:87], v[12:15]
    ds_read_b128 v[128:131], v48 offset:3072
    v_mfma_f32_16x16x32_bf16 v[16:19], v[92:95], v[88:91], v[16:19]
    ds_read_b128 v[132:135], v49 offset:7168
    v_mfma_f32_16x16x32_bf16 v[20:23], v[96:99], v[84:87], v[20:23]
    ds_read_b128 v[136:139], v49 offset:9216
    v_mfma_f32_16x16x32_bf16 v[24:27], v[96:99], v[88:91], v[24:27]
    s_waitcnt lgkmcnt(0)
    s_barrier
    ds_read_b128 v[64:67], v48 offset:8192
    v_mfma_f32_16x16x32_bf16 v[12:15], v[112:115], v[104:107], v[12:15]
    ds_read_b128 v[68:71], v48 offset:10240
    v_mfma_f32_16x16x32_bf16 v[16:19], v[112:115], v[108:111], v[16:19]
    ds_read_b128 v[72:75], v49 offset:16384
    v_mfma_f32_16x16x32_bf16 v[20:23], v[116:119], v[104:107], v[20:23]
    ds_read_b128 v[76:79], v49 offset:18432
    v_mfma_f32_16x16x32_bf16 v[24:27], v[116:119], v[108:111], v[24:27]
    ds_read_b128 v[84:87], v48 offset:9216
    v_mfma_f32_16x16x32_bf16 v[12:15], v[132:135], v[124:127], v[12:15]
    ds_read_b128 v[88:91], v48 offset:11264
    v_mfma_f32_16x16x32_bf16 v[16:19], v[132:135], v[128:131], v[16:19]
    ds_read_b128 v[92:95], v49 offset:17408
    v_mfma_f32_16x16x32_bf16 v[20:23], v[136:139], v[124:127], v[20:23]
    ds_read_b128 v[96:99], v49 offset:19456
    v_mfma_f32_16x16x32_bf16 v[24:27], v[136:139], v[128:131], v[24:27]
    s_waitcnt lgkmcnt(0)
    s_barrier
    ds_read_b128 v[104:107], v48 offset:16384
    v_mfma_f32_16x16x32_bf16 v[12:15], v[72:75], v[64:67], v[12:15]
    ds_read_b128 v[108:111], v48 offset:18432
    v_mfma_f32_16x16x32_bf16 v[16:19], v[72:75], v[68:71], v[16:19]
    ds_read_b128 v[112:115], v49 offset:26624
    v_mfma_f32_16x16x32_bf16 v[20:23], v[76:79], v[64:67], v[20:23]
    ds_read_b128 v[116:119], v49 offset:28672
    v_mfma_f32_16x16x32_bf16 v[24:27], v[76:79], v[68:71], v[24:27]
    ds_read_b128 v[124:127], v48 offset:17408
    v_mfma_f32_16x16x32_bf16 v[12:15], v[92:95], v[84:87], v[12:15]
    ds_read_b128 v[128:131], v48 offset:19456
    v_mfma_f32_16x16x32_bf16 v[16:19], v[92:95], v[88:91], v[16:19]
    ds_read_b128 v[132:135], v49 offset:27648
    v_mfma_f32_16x16x32_bf16 v[20:23], v[96:99], v[84:87], v[20:23]
    ds_read_b128 v[136:139], v49 offset:29696
    v_mfma_f32_16x16x32_bf16 v[24:27], v[96:99], v[88:91], v[24:27]
    s_waitcnt lgkmcnt(0)
    s_barrier
    v_mfma_f32_16x16x32_bf16 v[12:15], v[112:115], v[104:107], v[12:15]
    v_mfma_f32_16x16x32_bf16 v[16:19], v[112:115], v[108:111], v[16:19]
    v_mfma_f32_16x16x32_bf16 v[20:23], v[116:119], v[104:107], v[20:23]
    v_mfma_f32_16x16x32_bf16 v[24:27], v[116:119], v[108:111], v[24:27]
    v_mfma_f32_16x16x32_bf16 v[12:15], v[132:135], v[124:127], v[12:15]
    v_mfma_f32_16x16x32_bf16 v[16:19], v[132:135], v[128:131], v[16:19]
    v_mfma_f32_16x16x32_bf16 v[20:23], v[136:139], v[124:127], v[20:23]
    v_mfma_f32_16x16x32_bf16 v[24:27], v[136:139], v[128:131], v[24:27]
    s_waitcnt vmcnt(0)
    v_lshlrev_b32 v64, 16, v36
    v_and_b32 v65, 0xffff0000, v36
    v_lshlrev_b32 v66, 16, v37
    v_and_b32 v67, 0xffff0000, v37
    v_lshlrev_b32 v68, 16, v38
    v_and_b32 v69, 0xffff0000, v38
    v_lshlrev_b32 v70, 16, v39
    v_and_b32 v71, 0xffff0000, v39
    v_lshlrev_b32 v72, 16, v40
    v_and_b32 v73, 0xffff0000, v40
    v_lshlrev_b32 v74, 16, v41
    v_and_b32 v75, 0xffff0000, v41
    v_lshlrev_b32 v76, 16, v42
    v_and_b32 v77, 0xffff0000, v42
    v_lshlrev_b32 v78, 16, v43
    v_and_b32 v79, 0xffff0000, v43
    v_add_f32 v12, v12, v64
    v_add_f32 v13, v13, v65
    v_add_f32 v14, v14, v66
    v_add_f32 v15, v15, v67
    v_cvt_pk_bf16_f32 v36, v12, v13
    v_cvt_pk_bf16_f32 v37, v14, v15
    v_add_f32 v16, v16, v68
    v_add_f32 v17, v17, v69
    v_add_f32 v18, v18, v70
    v_add_f32 v19, v19, v71
    v_cvt_pk_bf16_f32 v38, v16, v17
    v_cvt_pk_bf16_f32 v39, v18, v19
    v_add_f32 v20, v20, v72
    v_add_f32 v21, v21, v73
    v_add_f32 v22, v22, v74
    v_add_f32 v23, v23, v75
    v_cvt_pk_bf16_f32 v40, v20, v21
    v_cvt_pk_bf16_f32 v41, v22, v23
    v_add_f32 v24, v24, v76
    v_add_f32 v25, v25, v77
    v_add_f32 v26, v26, v78
    v_add_f32 v27, v27, v79
    v_cvt_pk_bf16_f32 v42, v24, v25
    v_cvt_pk_bf16_f32 v43, v26, v27
    v_lshlrev_b32 v64, 16, v36
    v_and_b32 v65, 0xffff0000, v36
    v_lshlrev_b32 v66, 16, v37
    v_and_b32 v67, 0xffff0000, v37
    v_lshlrev_b32 v68, 16, v38
    v_and_b32 v69, 0xffff0000, v38
    v_lshlrev_b32 v70, 16, v39
    v_and_b32 v71, 0xffff0000, v39
    v_lshlrev_b32 v72, 16, v40
    v_and_b32 v73, 0xffff0000, v40
    v_lshlrev_b32 v74, 16, v41
    v_and_b32 v75, 0xffff0000, v41
    v_lshlrev_b32 v76, 16, v42
    v_and_b32 v77, 0xffff0000, v42
    v_lshlrev_b32 v78, 16, v43
    v_and_b32 v79, 0xffff0000, v43
    v_permlane16_swap_b32 v36, v38
    v_permlane16_swap_b32 v37, v39
    buffer_store_dwordx4 v[36:39], v8, s[16:19], s52 offen sc1
    v_permlane16_swap_b32 v40, v42
    v_permlane16_swap_b32 v41, v43
    buffer_store_dwordx4 v[40:43], v8, s[16:19], s53 offen sc1
    v_add_f32 v12, v64, v65
    v_mul_f32 v13, v64, v64
    v_fmac_f32 v13, v65, v65
    v_add_f32 v12, v12, v66
    v_fmac_f32 v13, v66, v66
    v_add_f32 v12, v12, v67
    v_fmac_f32 v13, v67, v67
    v_add_f32 v12, v12, v72
    v_fmac_f32 v13, v72, v72
    v_add_f32 v12, v12, v73
    v_fmac_f32 v13, v73, v73
    v_add_f32 v12, v12, v74
    v_fmac_f32 v13, v74, v74
    v_add_f32 v12, v12, v75
    v_fmac_f32 v13, v75, v75
    v_add_f32 v14, v68, v69
    v_mul_f32 v15, v68, v68
    v_fmac_f32 v15, v69, v69
    v_add_f32 v14, v14, v70
    v_fmac_f32 v15, v70, v70
    v_add_f32 v14, v14, v71
    v_fmac_f32 v15, v71, v71
    v_add_f32 v14, v14, v76
    v_fmac_f32 v15, v76, v76
    v_add_f32 v14, v14, v77
    v_fmac_f32 v15, v77, v77
    v_add_f32 v14, v14, v78
    v_fmac_f32 v15, v78, v78
    v_add_f32 v14, v14, v79
    v_fmac_f32 v15, v79, v79
    v_mov_b32 v16, v12
    v_mov_b32 v17, v13
    v_mov_b32 v18, v14
    v_mov_b32 v19, v15
    s_nop 1
    v_permlane16_swap_b32 v12, v16
    v_permlane16_swap_b32 v13, v17
    v_permlane16_swap_b32 v14, v18
    v_permlane16_swap_b32 v15, v19
    s_nop 1
    v_add_f32 v12, v12, v16
    v_add_f32 v13, v13, v17
    v_add_f32 v14, v14, v18
    v_add_f32 v15, v15, v19
    v_mov_b32 v16, v12
    v_mov_b32 v17, v13
    v_mov_b32 v18, v14
    v_mov_b32 v19, v15
    s_nop 1
    v_permlane32_swap_b32 v12, v16
    v_permlane32_swap_b32 v13, v17
    v_permlane32_swap_b32 v14, v18
    v_permlane32_swap_b32 v15, v19
    s_nop 1
    v_add_f32 v12, v12, v16
    v_add_f32 v13, v13, v17
    v_add_f32 v14, v14, v18
    v_add_f32 v15, v15, v19
    v_lshlrev_b32 v9, 7, v2
    v_cmp_eq_u32 vcc, 0, v3
    v_mov_b32 v10, 0x7fffff00
    s_lshl_b32 s40, s45, 11
    s_lshl_b32 s41, s38, 4
    s_add_u32 s40, s40, s41
    s_add_u32 s40, s40, 9437192
    v_cndmask_b32 v9, v10, v9, vcc
    buffer_store_dwordx2 v[12:13], v9, s[16:19], s40 offen sc1
    buffer_store_dwordx2 v[14:15], v9, s[16:19], s40 offen offset:2048 sc1
    s_add_u32 s42, s14, 4096

    v_mov_b32 v250, 163828
    v_mov_b32 v251, 1
    s_waitcnt vmcnt(0)
    s_mov_b64 exec, 1
    ds_add_rtn_u32 v252, v250, v251
    v_mov_b32 v250, 0
    s_waitcnt lgkmcnt(0)
    v_readfirstlane_b32 s72, v252
    s_cmp_eq_u32 s72, 3
    s_cbranch_scc0 sequential_preLN__grouped_kv_mqa__dense_activation_silu__prompt_kernel_pub12
    buffer_atomic_add v251, v250, s[16:19], s42 offen sc1

sequential_preLN__grouped_kv_mqa__dense_activation_silu__prompt_kernel_pub12:
    s_mov_b64 exec, -1
sequential_preLN__grouped_kv_mqa__dense_activation_silu__prompt_kernel_c4:
    s_mul_i32 s42, s38, 7
    s_mul_i32 s43, s38, 6
    s_add_u32 s43, s43, 6
    s_cmp_lt_u32 s38, 6
    s_cselect_b32 s44, s42, s43
    s_cselect_b32 s45, 7, 6

    s_lshl_b32 s46, s37, 2
    s_add_u32 s47, s46, s36
    v_add_u32 v6, 61440, v4
    s_lshl_b32 s42, s36, 12
    s_add_u32 s42, s42, 81920
    v_add_u32 v7, s42, v4
    v_add_u32 v10, 81920, v4
    s_mul_i32 s42, s36, 20480
    v_add_u32 v8, s42, v4
    s_cmp_eq_u32 s36, 3
    s_cbranch_scc0 sequential_preLN__grouped_kv_mqa__dense_activation_silu__prompt_kernel_nocs

    v_mov_b32 v250, 0
    s_mov_b32 s71, 0

sequential_preLN__grouped_kv_mqa__dense_activation_silu__prompt_kernel_poll13:
    buffer_load_dword v251, v250, s[16:19], s15 offen sc1
    s_add_u32 s71, s71, 1
    s_waitcnt vmcnt(0)
    v_readfirstlane_b32 s72, v251
    s_cmp_ge_u32 s72, 256
    s_cbranch_scc1 sequential_preLN__grouped_kv_mqa__dense_activation_silu__prompt_kernel_poll13_ok
    s_sleep 1
    s_cmp_lt_u32 s71, 200000
    s_cbranch_scc1 sequential_preLN__grouped_kv_mqa__dense_activation_silu__prompt_kernel_poll13

sequential_preLN__grouped_kv_mqa__dense_activation_silu__prompt_kernel_poll13_ok:
    s_lshl_b32 s42, s44, 7
    s_add_u32 s42, s42, 9961472

    buffer_load_dwordx4 v[16:19], v4, s[16:19], s42 offen sc1
    s_add_u32 s42, s42, 6912
    buffer_load_dwordx4 v[20:23], v4, s[16:19], s42 offen sc1
    s_add_u32 s42, s42, 6912
    buffer_load_dwordx4 v[24:27], v4, s[16:19], s42 offen sc1
    s_add_u32 s42, s42, 6912
    buffer_load_dwordx4 v[28:31], v4, s[16:19], s42 offen sc1
    s_add_u32 s42, s42, 6912
    buffer_load_dwordx4 v[32:35], v4, s[16:19], s42 offen sc1
    s_add_u32 s42, s42, 6912
    buffer_load_dwordx4 v[36:39], v4, s[16:19], s42 offen sc1
    s_add_u32 s42, s42, 6912
    buffer_load_dwordx4 v[40:43], v4, s[16:19], s42 offen sc1
    s_add_u32 s42, s42, 6912
    buffer_load_dwordx4 v[44:47], v4, s[16:19], s42 offen sc1
    s_add_u32 s42, s42, 6912
    buffer_load_dwordx4 v[48:51], v4, s[16:19], s42 offen sc1
    s_add_u32 s42, s42, 6912
    buffer_load_dwordx4 v[52:55], v4, s[16:19], s42 offen sc1
    s_add_u32 s42, s42, 6912
    buffer_load_dwordx4 v[56:59], v4, s[16:19], s42 offen sc1
    s_add_u32 s42, s42, 6912
    buffer_load_dwordx4 v[60:63], v4, s[16:19], s42 offen sc1
    s_add_u32 s42, s42, 6912
    buffer_load_dwordx4 v[64:67], v4, s[16:19], s42 offen sc1
    s_add_u32 s42, s42, 6912
    buffer_load_dwordx4 v[68:71], v4, s[16:19], s42 offen sc1
    s_add_u32 s42, s42, 6912
    buffer_load_dwordx4 v[72:75], v4, s[16:19], s42 offen sc1
    s_add_u32 s42, s42, 6912
    buffer_load_dwordx4 v[76:79], v4, s[16:19], s42 offen sc1
    s_add_u32 s42, s42, 6912
    buffer_load_dwordx4 v[80:83], v4, s[16:19], s42 offen sc1
    s_add_u32 s42, s42, 6912
    buffer_load_dwordx4 v[84:87], v4, s[16:19], s42 offen sc1
    s_add_u32 s42, s42, 6912
    buffer_load_dwordx4 v[88:91], v4, s[16:19], s42 offen sc1
    s_add_u32 s42, s42, 6912
    buffer_load_dwordx4 v[92:95], v4, s[16:19], s42 offen sc1
    s_add_u32 s42, s42, 6912
    s_waitcnt vmcnt(18)
    v_pk_add_f32 v[16:17], v[16:17], v[20:21]
    v_pk_add_f32 v[18:19], v[18:19], v[22:23]
    s_waitcnt vmcnt(17)
    v_pk_add_f32 v[16:17], v[16:17], v[24:25]
    v_pk_add_f32 v[18:19], v[18:19], v[26:27]
    s_waitcnt vmcnt(16)
    v_pk_add_f32 v[16:17], v[16:17], v[28:29]
    v_pk_add_f32 v[18:19], v[18:19], v[30:31]
    s_waitcnt vmcnt(15)
    v_pk_add_f32 v[16:17], v[16:17], v[32:33]
    v_pk_add_f32 v[18:19], v[18:19], v[34:35]
    s_waitcnt vmcnt(14)
    v_pk_add_f32 v[16:17], v[16:17], v[36:37]
    v_pk_add_f32 v[18:19], v[18:19], v[38:39]
    s_waitcnt vmcnt(13)
    v_pk_add_f32 v[16:17], v[16:17], v[40:41]
    v_pk_add_f32 v[18:19], v[18:19], v[42:43]
    s_waitcnt vmcnt(12)
    v_pk_add_f32 v[16:17], v[16:17], v[44:45]
    v_pk_add_f32 v[18:19], v[18:19], v[46:47]
    s_waitcnt vmcnt(11)
    v_pk_add_f32 v[16:17], v[16:17], v[48:49]
    v_pk_add_f32 v[18:19], v[18:19], v[50:51]
    s_waitcnt vmcnt(10)
    v_pk_add_f32 v[16:17], v[16:17], v[52:53]
    v_pk_add_f32 v[18:19], v[18:19], v[54:55]
    s_waitcnt vmcnt(9)
    v_pk_add_f32 v[16:17], v[16:17], v[56:57]
    v_pk_add_f32 v[18:19], v[18:19], v[58:59]
    s_waitcnt vmcnt(8)
    v_pk_add_f32 v[16:17], v[16:17], v[60:61]
    v_pk_add_f32 v[18:19], v[18:19], v[62:63]
    s_waitcnt vmcnt(7)
    v_pk_add_f32 v[16:17], v[16:17], v[64:65]
    v_pk_add_f32 v[18:19], v[18:19], v[66:67]
    s_waitcnt vmcnt(6)
    v_pk_add_f32 v[16:17], v[16:17], v[68:69]
    v_pk_add_f32 v[18:19], v[18:19], v[70:71]
    s_waitcnt vmcnt(5)
    v_pk_add_f32 v[16:17], v[16:17], v[72:73]
    v_pk_add_f32 v[18:19], v[18:19], v[74:75]
    s_waitcnt vmcnt(4)
    v_pk_add_f32 v[16:17], v[16:17], v[76:77]
    v_pk_add_f32 v[18:19], v[18:19], v[78:79]
    s_waitcnt vmcnt(3)
    v_pk_add_f32 v[16:17], v[16:17], v[80:81]
    v_pk_add_f32 v[18:19], v[18:19], v[82:83]
    s_waitcnt vmcnt(2)
    v_pk_add_f32 v[16:17], v[16:17], v[84:85]
    v_pk_add_f32 v[18:19], v[18:19], v[86:87]
    s_waitcnt vmcnt(1)
    v_pk_add_f32 v[16:17], v[16:17], v[88:89]
    v_pk_add_f32 v[18:19], v[18:19], v[90:91]
    s_waitcnt vmcnt(0)
    v_pk_add_f32 v[16:17], v[16:17], v[92:93]
    v_pk_add_f32 v[18:19], v[18:19], v[94:95]
    v_add_u32 v9, 147456, v4
    ds_write_b128 v9, v[16:19]

sequential_preLN__grouped_kv_mqa__dense_activation_silu__prompt_kernel_nocs:
    s_add_u32 s42, s46, 0
    s_mul_i32 s42, s42, 54
    s_add_u32 s42, s42, s44
    s_add_u32 s42, s42, s36
    s_lshl_b32 s42, s42, 10
    s_add_u32 s52, s42, 10485760

    s_add_u32 s42, s46, 1
    s_mul_i32 s42, s42, 54
    s_add_u32 s42, s42, s44
    s_add_u32 s42, s42, s36
    s_lshl_b32 s42, s42, 10
    s_add_u32 s53, s42, 10485760

    s_add_u32 s42, s46, 2
    s_mul_i32 s42, s42, 54
    s_add_u32 s42, s42, s44
    s_add_u32 s42, s42, s36
    s_lshl_b32 s42, s42, 10
    s_add_u32 s54, s42, 10485760

    s_add_u32 s42, s46, 3
    s_mul_i32 s42, s42, 54
    s_add_u32 s42, s42, s44
    s_add_u32 s42, s42, s36
    s_lshl_b32 s42, s42, 10
    s_add_u32 s55, s42, 10485760

    s_mul_i32 s42, s47, 54
    s_add_u32 s42, s42, s44
    s_add_u32 s42, s42, 4
    s_lshl_b32 s42, s42, 10
    s_add_u32 s56, s42, 10485760

    s_mul_i32 s42, s47, 54
    s_add_u32 s42, s42, s44
    s_add_u32 s42, s42, 5
    s_lshl_b32 s42, s42, 10
    s_add_u32 s57, s42, 10485760

    s_mul_i32 s42, s47, 54
    s_add_u32 s42, s42, s44
    s_add_u32 s42, s42, 6
    s_lshl_b32 s42, s42, 10
    s_add_u32 s58, s42, 10485760

    s_cmp_eq_u32 s45, 7
    s_cselect_b32 s58, s58, 0x7f000000
    s_waitcnt lgkmcnt(0)
    s_barrier
    s_lshl_b32 s42, s47, 11
    s_add_u32 s42, s42, 9437184
    v_lshlrev_b32 v9, 7, v2
    v_lshl_add_u32 v9, v3, 5, v9
    buffer_load_dwordx4 v[204:207], v9, s[16:19], s42 offen sc1
    buffer_load_dwordx4 v[208:211], v9, s[16:19], s42 offen offset:16 sc1
    ds_read_b128 v[16:19], v4 offset:0
    ds_read_b128 v[20:23], v4 offset:20480
    ds_read_b128 v[24:27], v4 offset:40960
    ds_read_b128 v[28:31], v6 offset:0
    ds_read_b128 v[32:35], v7 offset:0
    ds_read_b128 v[36:39], v7 offset:2048
    ds_read_b128 v[44:47], v4 offset:1024
    ds_read_b128 v[48:51], v4 offset:21504
    ds_read_b128 v[52:55], v4 offset:41984
    ds_read_b128 v[56:59], v6 offset:1024
    ds_read_b128 v[60:63], v7 offset:1024
    ds_read_b128 v[64:67], v7 offset:3072
    s_waitcnt lgkmcnt(0)
    s_barrier
    v_mfma_f32_16x16x32_bf16 v[128:131], v[32:35], v[16:19], 0
    ds_read_b128 v[72:75], v4 offset:2048
    v_mfma_f32_16x16x32_bf16 v[132:135], v[32:35], v[20:23], 0
    ds_read_b128 v[76:79], v4 offset:22528
    v_mfma_f32_16x16x32_bf16 v[136:139], v[32:35], v[24:27], 0
    ds_read_b128 v[80:83], v4 offset:43008
    v_mfma_f32_16x16x32_bf16 v[140:143], v[32:35], v[28:31], 0
    ds_read_b128 v[84:87], v6 offset:2048
    v_mfma_f32_16x16x32_bf16 v[144:147], v[36:39], v[16:19], 0
    ds_read_b128 v[88:91], v7 offset:16384
    v_mfma_f32_16x16x32_bf16 v[148:151], v[36:39], v[20:23], 0
    ds_read_b128 v[92:95], v7 offset:18432
    v_mfma_f32_16x16x32_bf16 v[152:155], v[36:39], v[24:27], 0
    v_mfma_f32_16x16x32_bf16 v[156:159], v[36:39], v[28:31], 0
    ds_read_b128 v[100:103], v4 offset:3072
    v_mfma_f32_16x16x32_bf16 v[128:131], v[60:63], v[44:47], v[128:131]
    ds_read_b128 v[104:107], v4 offset:23552
    v_mfma_f32_16x16x32_bf16 v[132:135], v[60:63], v[48:51], v[132:135]
    ds_read_b128 v[108:111], v4 offset:44032
    v_mfma_f32_16x16x32_bf16 v[136:139], v[60:63], v[52:55], v[136:139]
    ds_read_b128 v[112:115], v6 offset:3072
    v_mfma_f32_16x16x32_bf16 v[140:143], v[60:63], v[56:59], v[140:143]
    ds_read_b128 v[116:119], v7 offset:17408
    v_mfma_f32_16x16x32_bf16 v[144:147], v[64:67], v[44:47], v[144:147]
    ds_read_b128 v[120:123], v7 offset:19456
    v_mfma_f32_16x16x32_bf16 v[148:151], v[64:67], v[48:51], v[148:151]
    v_mfma_f32_16x16x32_bf16 v[152:155], v[64:67], v[52:55], v[152:155]
    v_mfma_f32_16x16x32_bf16 v[156:159], v[64:67], v[56:59], v[156:159]
    s_waitcnt lgkmcnt(0)
    s_barrier
    v_mfma_f32_16x16x32_bf16 v[128:131], v[88:91], v[72:75], v[128:131]
    ds_read_b128 v[16:19], v4 offset:4096
    v_mfma_f32_16x16x32_bf16 v[132:135], v[88:91], v[76:79], v[132:135]
    ds_read_b128 v[20:23], v4 offset:24576
    v_mfma_f32_16x16x32_bf16 v[136:139], v[88:91], v[80:83], v[136:139]
    ds_read_b128 v[24:27], v4 offset:45056
    v_mfma_f32_16x16x32_bf16 v[140:143], v[88:91], v[84:87], v[140:143]
    ds_read_b128 v[28:31], v6 offset:4096
    v_mfma_f32_16x16x32_bf16 v[144:147], v[92:95], v[72:75], v[144:147]
    ds_read_b128 v[32:35], v7 offset:32768
    v_mfma_f32_16x16x32_bf16 v[148:151], v[92:95], v[76:79], v[148:151]
    ds_read_b128 v[36:39], v7 offset:34816
    v_mfma_f32_16x16x32_bf16 v[152:155], v[92:95], v[80:83], v[152:155]
    v_mfma_f32_16x16x32_bf16 v[156:159], v[92:95], v[84:87], v[156:159]
    ds_read_b128 v[44:47], v4 offset:5120
    v_mfma_f32_16x16x32_bf16 v[128:131], v[116:119], v[100:103], v[128:131]
    ds_read_b128 v[48:51], v4 offset:25600
    v_mfma_f32_16x16x32_bf16 v[132:135], v[116:119], v[104:107], v[132:135]
    ds_read_b128 v[52:55], v4 offset:46080
    v_mfma_f32_16x16x32_bf16 v[136:139], v[116:119], v[108:111], v[136:139]
    ds_read_b128 v[56:59], v6 offset:5120
    v_mfma_f32_16x16x32_bf16 v[140:143], v[116:119], v[112:115], v[140:143]
    ds_read_b128 v[60:63], v7 offset:33792
    v_mfma_f32_16x16x32_bf16 v[144:147], v[120:123], v[100:103], v[144:147]
    ds_read_b128 v[64:67], v7 offset:35840
    v_mfma_f32_16x16x32_bf16 v[148:151], v[120:123], v[104:107], v[148:151]
    v_mfma_f32_16x16x32_bf16 v[152:155], v[120:123], v[108:111], v[152:155]
    v_mfma_f32_16x16x32_bf16 v[156:159], v[120:123], v[112:115], v[156:159]
    s_waitcnt lgkmcnt(0)
    s_barrier
    v_mfma_f32_16x16x32_bf16 v[128:131], v[32:35], v[16:19], v[128:131]
    s_waitcnt vmcnt(0)
    v_add_f32 v204, v204, v206
    ds_read_b128 v[72:75], v4 offset:6144
    v_mfma_f32_16x16x32_bf16 v[132:135], v[32:35], v[20:23], v[132:135]
    v_add_f32 v205, v205, v207
    v_add_f32 v208, v208, v210
    ds_read_b128 v[76:79], v4 offset:26624
    v_mfma_f32_16x16x32_bf16 v[136:139], v[32:35], v[24:27], v[136:139]
    v_add_f32 v209, v209, v211
    v_add_f32 v204, v204, v208
    ds_read_b128 v[80:83], v4 offset:47104
    v_mfma_f32_16x16x32_bf16 v[140:143], v[32:35], v[28:31], v[140:143]
    v_add_f32 v205, v205, v209
    v_mov_b32 v206, v204
    ds_read_b128 v[84:87], v6 offset:6144
    v_mfma_f32_16x16x32_bf16 v[144:147], v[36:39], v[16:19], v[144:147]
    v_mov_b32 v207, v205
    s_nop 1
    ds_read_b128 v[88:91], v7 offset:49152
    v_mfma_f32_16x16x32_bf16 v[148:151], v[36:39], v[20:23], v[148:151]
    v_permlane16_swap_b32 v204, v206
    v_permlane16_swap_b32 v205, v207
    ds_read_b128 v[92:95], v7 offset:51200
    v_mfma_f32_16x16x32_bf16 v[152:155], v[36:39], v[24:27], v[152:155]
    s_nop 1
    v_add_f32 v204, v204, v206
    v_mfma_f32_16x16x32_bf16 v[156:159], v[36:39], v[28:31], v[156:159]
    v_add_f32 v205, v205, v207
    v_mov_b32 v206, v204
    ds_read_b128 v[100:103], v4 offset:7168
    v_mfma_f32_16x16x32_bf16 v[128:131], v[60:63], v[44:47], v[128:131]
    v_mov_b32 v207, v205
    s_nop 1
    ds_read_b128 v[104:107], v4 offset:27648
    v_mfma_f32_16x16x32_bf16 v[132:135], v[60:63], v[48:51], v[132:135]
    v_permlane32_swap_b32 v204, v206
    v_permlane32_swap_b32 v205, v207
    ds_read_b128 v[108:111], v4 offset:48128
    v_mfma_f32_16x16x32_bf16 v[136:139], v[60:63], v[52:55], v[136:139]
    s_nop 1
    v_add_f32 v204, v204, v206
    ds_read_b128 v[112:115], v6 offset:7168
    v_mfma_f32_16x16x32_bf16 v[140:143], v[60:63], v[56:59], v[140:143]
    v_add_f32 v205, v205, v207
    v_mul_f32 v204, 0x3acccccd, v204
    ds_read_b128 v[116:119], v7 offset:50176
    v_mfma_f32_16x16x32_bf16 v[144:147], v[64:67], v[44:47], v[144:147]
    v_mul_f32 v205, 0x3acccccd, v205
    v_fma_f32 v205, -v204, v204, v205
    ds_read_b128 v[120:123], v7 offset:52224
    v_mfma_f32_16x16x32_bf16 v[148:151], v[64:67], v[48:51], v[148:151]
    v_max_f32 v205, 0, v205
    v_add_f32 v205, 0x3727c5ac, v205
    v_mfma_f32_16x16x32_bf16 v[152:155], v[64:67], v[52:55], v[152:155]
    s_lshl_b32 s42, s36, 7
    v_lshl_add_u32 v9, v2, 3, s42
    v_mfma_f32_16x16x32_bf16 v[156:159], v[64:67], v[56:59], v[156:159]
    v_add_u32 v9, 148480, v9
    ds_write_b64 v9, v[204:205]
    s_waitcnt lgkmcnt(0)
    s_barrier
    v_mfma_f32_16x16x32_bf16 v[128:131], v[88:91], v[72:75], v[128:131]
    ds_read_b128 v[16:19], v4 offset:8192
    v_mfma_f32_16x16x32_bf16 v[132:135], v[88:91], v[76:79], v[132:135]
    ds_read_b128 v[20:23], v4 offset:28672
    v_mfma_f32_16x16x32_bf16 v[136:139], v[88:91], v[80:83], v[136:139]
    ds_read_b128 v[24:27], v4 offset:49152
    v_mfma_f32_16x16x32_bf16 v[140:143], v[88:91], v[84:87], v[140:143]
    ds_read_b128 v[28:31], v6 offset:8192
    v_mfma_f32_16x16x32_bf16 v[144:147], v[92:95], v[72:75], v[144:147]
    ds_read_b128 v[32:35], v7 offset:0
    v_mfma_f32_16x16x32_bf16 v[148:151], v[92:95], v[76:79], v[148:151]
    ds_read_b128 v[36:39], v7 offset:2048
    v_mfma_f32_16x16x32_bf16 v[152:155], v[92:95], v[80:83], v[152:155]
    v_mfma_f32_16x16x32_bf16 v[156:159], v[92:95], v[84:87], v[156:159]
    ds_read_b128 v[44:47], v4 offset:9216
    v_mfma_f32_16x16x32_bf16 v[128:131], v[116:119], v[100:103], v[128:131]
    ds_read_b128 v[48:51], v4 offset:29696
    v_mfma_f32_16x16x32_bf16 v[132:135], v[116:119], v[104:107], v[132:135]
    ds_read_b128 v[52:55], v4 offset:50176
    v_mfma_f32_16x16x32_bf16 v[136:139], v[116:119], v[108:111], v[136:139]
    ds_read_b128 v[56:59], v6 offset:9216
    v_mfma_f32_16x16x32_bf16 v[140:143], v[116:119], v[112:115], v[140:143]
    ds_read_b128 v[60:63], v7 offset:1024
    v_mfma_f32_16x16x32_bf16 v[144:147], v[120:123], v[100:103], v[144:147]
    ds_read_b128 v[64:67], v7 offset:3072
    v_mfma_f32_16x16x32_bf16 v[148:151], v[120:123], v[104:107], v[148:151]
    v_mfma_f32_16x16x32_bf16 v[152:155], v[120:123], v[108:111], v[152:155]
    v_mfma_f32_16x16x32_bf16 v[156:159], v[120:123], v[112:115], v[156:159]
    s_waitcnt lgkmcnt(0)
    s_barrier
    ds_read_b128 v[72:75], v4 offset:10240
    v_mfma_f32_16x16x32_bf16 v[128:131], v[32:35], v[16:19], v[128:131]
    ds_read_b128 v[76:79], v4 offset:30720
    ds_read_b128 v[80:83], v4 offset:51200
    v_mfma_f32_16x16x32_bf16 v[132:135], v[32:35], v[20:23], v[132:135]
    ds_read_b128 v[84:87], v6 offset:10240
    v_mfma_f32_16x16x32_bf16 v[136:139], v[32:35], v[24:27], v[136:139]
    ds_read_b128 v[88:91], v7 offset:16384
    ds_read_b128 v[92:95], v7 offset:18432
    v_mfma_f32_16x16x32_bf16 v[140:143], v[32:35], v[28:31], v[140:143]
    ds_read_b128 v[100:103], v4 offset:11264
    ds_read_b128 v[104:107], v4 offset:31744
    v_mfma_f32_16x16x32_bf16 v[144:147], v[36:39], v[16:19], v[144:147]
    ds_read_b128 v[108:111], v4 offset:52224
    v_mfma_f32_16x16x32_bf16 v[148:151], v[36:39], v[20:23], v[148:151]
    ds_read_b128 v[112:115], v6 offset:11264
    ds_read_b128 v[116:119], v7 offset:17408
    v_mfma_f32_16x16x32_bf16 v[152:155], v[36:39], v[24:27], v[152:155]
    ds_read_b128 v[120:123], v7 offset:19456
    v_lshlrev_b32 v9, 3, v2
    v_mfma_f32_16x16x32_bf16 v[156:159], v[36:39], v[28:31], v[156:159]
    v_add_u32 v9, 148480, v9
    v_mfma_f32_16x16x32_bf16 v[128:131], v[60:63], v[44:47], v[128:131]
    ds_read_b64 v[204:205], v9 offset:0
    ds_read_b64 v[206:207], v9 offset:128
    v_mfma_f32_16x16x32_bf16 v[132:135], v[60:63], v[48:51], v[132:135]
    ds_read_b64 v[208:209], v9 offset:256
    ds_read_b64 v[210:211], v9 offset:384
    v_mfma_f32_16x16x32_bf16 v[136:139], v[60:63], v[52:55], v[136:139]
    s_lshl_b32 s42, s36, 7
    v_mfma_f32_16x16x32_bf16 v[140:143], v[60:63], v[56:59], v[140:143]
    v_lshl_add_u32 v11, v3, 4, s42
    v_add_u32 v11, 147456, v11
    v_mfma_f32_16x16x32_bf16 v[144:147], v[64:67], v[44:47], v[144:147]
    ds_read_b128 v[184:187], v11 offset:0
    ds_read_b128 v[188:191], v11 offset:64
    v_mfma_f32_16x16x32_bf16 v[148:151], v[64:67], v[48:51], v[148:151]
    v_mfma_f32_16x16x32_bf16 v[152:155], v[64:67], v[52:55], v[152:155]
    v_mfma_f32_16x16x32_bf16 v[156:159], v[64:67], v[56:59], v[156:159]
    s_waitcnt lgkmcnt(0)
    s_barrier
    v_mfma_f32_16x16x32_bf16 v[128:131], v[88:91], v[72:75], v[128:131]
    v_sub_f32 v192, 0, v204
    ds_read_b128 v[16:19], v4 offset:12288
    v_mfma_f32_16x16x32_bf16 v[132:135], v[88:91], v[76:79], v[132:135]
    v_rsq_f32 v193, v205
    ds_read_b128 v[20:23], v4 offset:32768
    v_mfma_f32_16x16x32_bf16 v[136:139], v[88:91], v[80:83], v[136:139]
    v_sqrt_f32 v194, v205
    ds_read_b128 v[24:27], v4 offset:53248
    v_mfma_f32_16x16x32_bf16 v[140:143], v[88:91], v[84:87], v[140:143]
    v_sub_f32 v195, 0, v206
    ds_read_b128 v[28:31], v6 offset:12288
    v_mfma_f32_16x16x32_bf16 v[144:147], v[92:95], v[72:75], v[144:147]
    v_rsq_f32 v196, v207
    ds_read_b128 v[32:35], v7 offset:32768
    v_mfma_f32_16x16x32_bf16 v[148:151], v[92:95], v[76:79], v[148:151]
    v_sqrt_f32 v197, v207
    ds_read_b128 v[36:39], v7 offset:34816
    v_mfma_f32_16x16x32_bf16 v[152:155], v[92:95], v[80:83], v[152:155]
    v_sub_f32 v198, 0, v208
    v_mfma_f32_16x16x32_bf16 v[156:159], v[92:95], v[84:87], v[156:159]
    v_rsq_f32 v199, v209
    ds_read_b128 v[44:47], v4 offset:13312
    v_mfma_f32_16x16x32_bf16 v[128:131], v[116:119], v[100:103], v[128:131]
    v_sqrt_f32 v200, v209
    ds_read_b128 v[48:51], v4 offset:33792
    v_mfma_f32_16x16x32_bf16 v[132:135], v[116:119], v[104:107], v[132:135]
    v_sub_f32 v201, 0, v210
    ds_read_b128 v[52:55], v4 offset:54272
    v_mfma_f32_16x16x32_bf16 v[136:139], v[116:119], v[108:111], v[136:139]
    v_rsq_f32 v202, v211
    ds_read_b128 v[56:59], v6 offset:13312
    v_mfma_f32_16x16x32_bf16 v[140:143], v[116:119], v[112:115], v[140:143]
    v_sqrt_f32 v203, v211
    ds_read_b128 v[60:63], v7 offset:33792
    v_mfma_f32_16x16x32_bf16 v[144:147], v[120:123], v[100:103], v[144:147]
    s_nop 0
    ds_read_b128 v[64:67], v7 offset:35840
    v_mfma_f32_16x16x32_bf16 v[148:151], v[120:123], v[104:107], v[148:151]
    v_mul_f32 v193, 0xbfb8aa3b, v193
    v_mfma_f32_16x16x32_bf16 v[152:155], v[120:123], v[108:111], v[152:155]
    v_mul_f32 v196, 0xbfb8aa3b, v196
    v_mfma_f32_16x16x32_bf16 v[156:159], v[120:123], v[112:115], v[156:159]
    v_mul_f32 v199, 0xbfb8aa3b, v199
    v_mul_f32 v202, 0xbfb8aa3b, v202
    s_waitcnt lgkmcnt(0)
    s_barrier
    v_mfma_f32_16x16x32_bf16 v[128:131], v[32:35], v[16:19], v[128:131]
    ds_read_b128 v[72:75], v4 offset:14336
    v_mfma_f32_16x16x32_bf16 v[132:135], v[32:35], v[20:23], v[132:135]
    ds_read_b128 v[76:79], v4 offset:34816
    v_mfma_f32_16x16x32_bf16 v[136:139], v[32:35], v[24:27], v[136:139]
    ds_read_b128 v[80:83], v4 offset:55296
    v_mfma_f32_16x16x32_bf16 v[140:143], v[32:35], v[28:31], v[140:143]
    ds_read_b128 v[84:87], v6 offset:14336
    v_mfma_f32_16x16x32_bf16 v[144:147], v[36:39], v[16:19], v[144:147]
    ds_read_b128 v[88:91], v7 offset:49152
    v_mfma_f32_16x16x32_bf16 v[148:151], v[36:39], v[20:23], v[148:151]
    ds_read_b128 v[92:95], v7 offset:51200
    v_mfma_f32_16x16x32_bf16 v[152:155], v[36:39], v[24:27], v[152:155]
    v_mfma_f32_16x16x32_bf16 v[156:159], v[36:39], v[28:31], v[156:159]
    ds_read_b128 v[100:103], v4 offset:15360
    v_mfma_f32_16x16x32_bf16 v[128:131], v[60:63], v[44:47], v[128:131]
    ds_read_b128 v[104:107], v4 offset:35840
    v_mfma_f32_16x16x32_bf16 v[132:135], v[60:63], v[48:51], v[132:135]
    ds_read_b128 v[108:111], v4 offset:56320
    v_mfma_f32_16x16x32_bf16 v[136:139], v[60:63], v[52:55], v[136:139]
    ds_read_b128 v[112:115], v6 offset:15360
    v_mfma_f32_16x16x32_bf16 v[140:143], v[60:63], v[56:59], v[140:143]
    ds_read_b128 v[116:119], v7 offset:50176
    v_mfma_f32_16x16x32_bf16 v[144:147], v[64:67], v[44:47], v[144:147]
    ds_read_b128 v[120:123], v7 offset:52224
    v_mfma_f32_16x16x32_bf16 v[148:151], v[64:67], v[48:51], v[148:151]
    v_mfma_f32_16x16x32_bf16 v[152:155], v[64:67], v[52:55], v[152:155]
    v_mfma_f32_16x16x32_bf16 v[156:159], v[64:67], v[56:59], v[156:159]
    s_waitcnt lgkmcnt(0)
    s_barrier
    v_mfma_f32_16x16x32_bf16 v[128:131], v[88:91], v[72:75], v[128:131]
    ds_read_b128 v[16:19], v4 offset:16384
    v_mfma_f32_16x16x32_bf16 v[132:135], v[88:91], v[76:79], v[132:135]
    ds_read_b128 v[20:23], v4 offset:36864
    v_mfma_f32_16x16x32_bf16 v[136:139], v[88:91], v[80:83], v[136:139]
    ds_read_b128 v[24:27], v4 offset:57344
    v_mfma_f32_16x16x32_bf16 v[140:143], v[88:91], v[84:87], v[140:143]
    ds_read_b128 v[28:31], v6 offset:16384
    v_mfma_f32_16x16x32_bf16 v[144:147], v[92:95], v[72:75], v[144:147]
    ds_read_b128 v[32:35], v7 offset:0
    v_mfma_f32_16x16x32_bf16 v[148:151], v[92:95], v[76:79], v[148:151]
    ds_read_b128 v[36:39], v7 offset:2048
    v_mfma_f32_16x16x32_bf16 v[152:155], v[92:95], v[80:83], v[152:155]
    v_mfma_f32_16x16x32_bf16 v[156:159], v[92:95], v[84:87], v[156:159]
    ds_read_b128 v[44:47], v4 offset:17408
    v_mfma_f32_16x16x32_bf16 v[128:131], v[116:119], v[100:103], v[128:131]
    ds_read_b128 v[48:51], v4 offset:37888
    v_mfma_f32_16x16x32_bf16 v[132:135], v[116:119], v[104:107], v[132:135]
    ds_read_b128 v[52:55], v4 offset:58368
    v_mfma_f32_16x16x32_bf16 v[136:139], v[116:119], v[108:111], v[136:139]
    ds_read_b128 v[56:59], v6 offset:17408
    v_mfma_f32_16x16x32_bf16 v[140:143], v[116:119], v[112:115], v[140:143]
    ds_read_b128 v[60:63], v7 offset:1024
    v_mfma_f32_16x16x32_bf16 v[144:147], v[120:123], v[100:103], v[144:147]
    ds_read_b128 v[64:67], v7 offset:3072
    v_mfma_f32_16x16x32_bf16 v[148:151], v[120:123], v[104:107], v[148:151]
    v_mfma_f32_16x16x32_bf16 v[152:155], v[120:123], v[108:111], v[152:155]
    v_mfma_f32_16x16x32_bf16 v[156:159], v[120:123], v[112:115], v[156:159]
    s_waitcnt lgkmcnt(0)
    s_barrier
    v_mfma_f32_16x16x32_bf16 v[128:131], v[32:35], v[16:19], v[128:131]
    ds_read_b128 v[72:75], v4 offset:18432
    v_mfma_f32_16x16x32_bf16 v[132:135], v[32:35], v[20:23], v[132:135]
    ds_read_b128 v[76:79], v4 offset:38912
    v_mfma_f32_16x16x32_bf16 v[136:139], v[32:35], v[24:27], v[136:139]
    ds_read_b128 v[80:83], v4 offset:59392
    v_mfma_f32_16x16x32_bf16 v[140:143], v[32:35], v[28:31], v[140:143]
    ds_read_b128 v[84:87], v6 offset:18432
    v_mfma_f32_16x16x32_bf16 v[144:147], v[36:39], v[16:19], v[144:147]
    ds_read_b128 v[88:91], v7 offset:16384
    v_mfma_f32_16x16x32_bf16 v[148:151], v[36:39], v[20:23], v[148:151]
    ds_read_b128 v[92:95], v7 offset:18432
    v_mfma_f32_16x16x32_bf16 v[152:155], v[36:39], v[24:27], v[152:155]
    v_mfma_f32_16x16x32_bf16 v[156:159], v[36:39], v[28:31], v[156:159]
    ds_read_b128 v[100:103], v4 offset:19456
    v_mfma_f32_16x16x32_bf16 v[128:131], v[60:63], v[44:47], v[128:131]
    ds_read_b128 v[104:107], v4 offset:39936
    v_mfma_f32_16x16x32_bf16 v[132:135], v[60:63], v[48:51], v[132:135]
    ds_read_b128 v[108:111], v4 offset:60416
    v_mfma_f32_16x16x32_bf16 v[136:139], v[60:63], v[52:55], v[136:139]
    ds_read_b128 v[112:115], v6 offset:19456
    v_mfma_f32_16x16x32_bf16 v[140:143], v[60:63], v[56:59], v[140:143]
    ds_read_b128 v[116:119], v7 offset:17408
    v_mfma_f32_16x16x32_bf16 v[144:147], v[64:67], v[44:47], v[144:147]
    ds_read_b128 v[120:123], v7 offset:19456
    v_mfma_f32_16x16x32_bf16 v[148:151], v[64:67], v[48:51], v[148:151]
    v_mfma_f32_16x16x32_bf16 v[152:155], v[64:67], v[52:55], v[152:155]
    v_mfma_f32_16x16x32_bf16 v[156:159], v[64:67], v[56:59], v[156:159]
    s_waitcnt lgkmcnt(0)
    s_barrier
    ds_read_b128 v[16:19], v8 offset:0
    v_mfma_f32_16x16x32_bf16 v[128:131], v[88:91], v[72:75], v[128:131]
    ds_read_b128 v[20:23], v10 offset:32768
    v_mfma_f32_16x16x32_bf16 v[132:135], v[88:91], v[76:79], v[132:135]
    ds_read_b128 v[24:27], v10 offset:34816
    v_mfma_f32_16x16x32_bf16 v[136:139], v[88:91], v[80:83], v[136:139]
    ds_read_b128 v[28:31], v10 offset:36864
    v_mfma_f32_16x16x32_bf16 v[140:143], v[88:91], v[84:87], v[140:143]
    ds_read_b128 v[32:35], v10 offset:38912
    v_mfma_f32_16x16x32_bf16 v[144:147], v[92:95], v[72:75], v[144:147]
    ds_read_b128 v[36:39], v10 offset:40960
    v_mfma_f32_16x16x32_bf16 v[148:151], v[92:95], v[76:79], v[148:151]
    ds_read_b128 v[40:43], v10 offset:43008
    v_mfma_f32_16x16x32_bf16 v[152:155], v[92:95], v[80:83], v[152:155]
    ds_read_b128 v[44:47], v8 offset:1024
    v_mfma_f32_16x16x32_bf16 v[156:159], v[92:95], v[84:87], v[156:159]
    ds_read_b128 v[48:51], v10 offset:33792
    v_mfma_f32_16x16x32_bf16 v[128:131], v[116:119], v[100:103], v[128:131]
    ds_read_b128 v[52:55], v10 offset:35840
    v_mfma_f32_16x16x32_bf16 v[132:135], v[116:119], v[104:107], v[132:135]
    ds_read_b128 v[56:59], v10 offset:37888
    v_mfma_f32_16x16x32_bf16 v[136:139], v[116:119], v[108:111], v[136:139]
    ds_read_b128 v[60:63], v10 offset:39936
    v_mfma_f32_16x16x32_bf16 v[140:143], v[116:119], v[112:115], v[140:143]
    ds_read_b128 v[64:67], v10 offset:41984
    v_mfma_f32_16x16x32_bf16 v[144:147], v[120:123], v[100:103], v[144:147]
    ds_read_b128 v[68:71], v10 offset:44032
    v_mfma_f32_16x16x32_bf16 v[148:151], v[120:123], v[104:107], v[148:151]
    v_mfma_f32_16x16x32_bf16 v[152:155], v[120:123], v[108:111], v[152:155]
    v_mfma_f32_16x16x32_bf16 v[156:159], v[120:123], v[112:115], v[156:159]
    s_waitcnt lgkmcnt(0)
    s_barrier
    ds_read_b128 v[72:75], v8 offset:2048
    v_mfma_f32_16x16x32_bf16 v[160:163], v[20:23], v[16:19], 0
    s_nop 7
    v_fmac_f32 v128, v192, v184
    v_fmac_f32 v129, v192, v185
    ds_read_b128 v[76:79], v10 offset:49152
    v_mfma_f32_16x16x32_bf16 v[164:167], v[24:27], v[16:19], 0
    v_fmac_f32 v130, v192, v186
    v_fmac_f32 v131, v192, v187
    v_fmac_f32 v144, v192, v188
    ds_read_b128 v[80:83], v10 offset:51200
    ds_read_b128 v[84:87], v10 offset:53248
    v_mfma_f32_16x16x32_bf16 v[168:171], v[28:31], v[16:19], 0
    v_fmac_f32 v145, v192, v189
    v_fmac_f32 v146, v192, v190
    v_fmac_f32 v147, v192, v191
    ds_read_b128 v[88:91], v10 offset:55296
    v_mfma_f32_16x16x32_bf16 v[172:175], v[32:35], v[16:19], 0
    v_mul_f32 v204, v193, v128
    v_mul_f32 v205, v193, v129
    v_mul_f32 v206, v193, v130
    ds_read_b128 v[92:95], v10 offset:57344
    ds_read_b128 v[96:99], v10 offset:59392
    v_mfma_f32_16x16x32_bf16 v[176:179], v[36:39], v[16:19], 0
    v_mul_f32 v207, v193, v131
    v_mul_f32 v208, v193, v144
    v_mul_f32 v209, v193, v145
    ds_read_b128 v[100:103], v8 offset:3072
    v_mfma_f32_16x16x32_bf16 v[180:183], v[40:43], v[16:19], 0
    v_mul_f32 v210, v193, v146
    v_mul_f32 v211, v193, v147
    v_exp_f32 v204, v204
    ds_read_b128 v[104:107], v10 offset:50176
    v_mfma_f32_16x16x32_bf16 v[160:163], v[48:51], v[44:47], v[160:163]
    v_exp_f32 v205, v205
    v_exp_f32 v206, v206
    v_exp_f32 v207, v207
    ds_read_b128 v[108:111], v10 offset:52224
    ds_read_b128 v[112:115], v10 offset:54272
    v_mfma_f32_16x16x32_bf16 v[164:167], v[52:55], v[44:47], v[164:167]
    v_exp_f32 v208, v208
    v_exp_f32 v209, v209
    v_exp_f32 v210, v210
    ds_read_b128 v[116:119], v10 offset:56320
    v_mfma_f32_16x16x32_bf16 v[168:171], v[56:59], v[44:47], v[168:171]
    v_exp_f32 v211, v211
    v_fma_f32 v204, v204, v194, v194
    v_fma_f32 v205, v205, v194, v194
    ds_read_b128 v[120:123], v10 offset:58368
    ds_read_b128 v[124:127], v10 offset:60416
    v_mfma_f32_16x16x32_bf16 v[172:175], v[60:63], v[44:47], v[172:175]
    v_fma_f32 v206, v206, v194, v194
    v_fma_f32 v207, v207, v194, v194
    v_fma_f32 v208, v208, v194, v194
    v_mfma_f32_16x16x32_bf16 v[176:179], v[64:67], v[44:47], v[176:179]
    v_fma_f32 v209, v209, v194, v194
    v_fma_f32 v210, v210, v194, v194
    v_fma_f32 v211, v211, v194, v194
    v_mfma_f32_16x16x32_bf16 v[180:183], v[68:71], v[44:47], v[180:183]
    v_rcp_f32 v204, v204
    v_rcp_f32 v205, v205
    v_rcp_f32 v206, v206
    s_waitcnt lgkmcnt(0)
    s_barrier
    ds_read_b128 v[16:19], v8 offset:4096
    v_mfma_f32_16x16x32_bf16 v[160:163], v[76:79], v[72:75], v[160:163]
    v_rcp_f32 v207, v207
    v_rcp_f32 v208, v208
    ds_read_b128 v[20:23], v10 offset:0
    v_mfma_f32_16x16x32_bf16 v[164:167], v[80:83], v[72:75], v[164:167]
    v_rcp_f32 v209, v209
    v_rcp_f32 v210, v210
    v_rcp_f32 v211, v211
    ds_read_b128 v[24:27], v10 offset:2048
    ds_read_b128 v[28:31], v10 offset:4096
    v_mfma_f32_16x16x32_bf16 v[168:171], v[84:87], v[72:75], v[168:171]
    v_mul_f32 v204, v204, v128
    v_mul_f32 v205, v205, v129
    v_mul_f32 v206, v206, v130
    ds_read_b128 v[32:35], v10 offset:6144
    v_mfma_f32_16x16x32_bf16 v[172:175], v[88:91], v[72:75], v[172:175]
    v_mul_f32 v207, v207, v131
    v_mul_f32 v208, v208, v144
    v_mul_f32 v209, v209, v145
    ds_read_b128 v[36:39], v10 offset:8192
    ds_read_b128 v[40:43], v10 offset:10240
    v_mfma_f32_16x16x32_bf16 v[176:179], v[92:95], v[72:75], v[176:179]
    v_mul_f32 v210, v210, v146
    v_mul_f32 v211, v211, v147
    v_cvt_pk_bf16_f32 v212, v204, v205
    ds_read_b128 v[44:47], v8 offset:5120
    v_mfma_f32_16x16x32_bf16 v[180:183], v[96:99], v[72:75], v[180:183]
    v_cvt_pk_bf16_f32 v213, v206, v207
    v_cvt_pk_bf16_f32 v214, v208, v209
    v_cvt_pk_bf16_f32 v215, v210, v211
    ds_read_b128 v[48:51], v10 offset:1024
    v_mfma_f32_16x16x32_bf16 v[160:163], v[104:107], v[100:103], v[160:163]
    buffer_store_dwordx4 v[212:215], v4, s[16:19], s52 offen sc1
    v_fmac_f32 v132, v195, v184
    v_fmac_f32 v133, v195, v185
    ds_read_b128 v[52:55], v10 offset:3072
    ds_read_b128 v[56:59], v10 offset:5120
    v_mfma_f32_16x16x32_bf16 v[164:167], v[108:111], v[100:103], v[164:167]
    v_fmac_f32 v134, v195, v186
    v_fmac_f32 v135, v195, v187
    v_fmac_f32 v148, v195, v188
    ds_read_b128 v[60:63], v10 offset:7168
    v_mfma_f32_16x16x32_bf16 v[168:171], v[112:115], v[100:103], v[168:171]
    v_fmac_f32 v149, v195, v189
    v_fmac_f32 v150, v195, v190
    v_fmac_f32 v151, v195, v191
    ds_read_b128 v[64:67], v10 offset:9216
    ds_read_b128 v[68:71], v10 offset:11264
    v_mfma_f32_16x16x32_bf16 v[172:175], v[116:119], v[100:103], v[172:175]
    v_mul_f32 v216, v196, v132
    v_mul_f32 v217, v196, v133
    v_mul_f32 v218, v196, v134
    v_mfma_f32_16x16x32_bf16 v[176:179], v[120:123], v[100:103], v[176:179]
    v_mul_f32 v219, v196, v135
    v_mul_f32 v220, v196, v148
    v_mul_f32 v221, v196, v149
    v_mfma_f32_16x16x32_bf16 v[180:183], v[124:127], v[100:103], v[180:183]
    v_mul_f32 v222, v196, v150
    v_mul_f32 v223, v196, v151
    v_exp_f32 v216, v216
    s_waitcnt lgkmcnt(0)
    s_barrier
    ds_read_b128 v[72:75], v8 offset:6144
    v_mfma_f32_16x16x32_bf16 v[160:163], v[20:23], v[16:19], v[160:163]
    v_exp_f32 v217, v217
    v_exp_f32 v218, v218
    v_exp_f32 v219, v219
    ds_read_b128 v[76:79], v10 offset:16384
    v_mfma_f32_16x16x32_bf16 v[164:167], v[24:27], v[16:19], v[164:167]
    v_exp_f32 v220, v220
    v_exp_f32 v221, v221
    v_exp_f32 v222, v222
    ds_read_b128 v[80:83], v10 offset:18432
    ds_read_b128 v[84:87], v10 offset:20480
    v_mfma_f32_16x16x32_bf16 v[168:171], v[28:31], v[16:19], v[168:171]
    v_exp_f32 v223, v223
    v_fma_f32 v216, v216, v197, v197
    v_fma_f32 v217, v217, v197, v197
    ds_read_b128 v[88:91], v10 offset:22528
    v_mfma_f32_16x16x32_bf16 v[172:175], v[32:35], v[16:19], v[172:175]
    v_fma_f32 v218, v218, v197, v197
    v_fma_f32 v219, v219, v197, v197
    v_fma_f32 v220, v220, v197, v197
    ds_read_b128 v[92:95], v10 offset:24576
    ds_read_b128 v[96:99], v10 offset:26624
    v_mfma_f32_16x16x32_bf16 v[176:179], v[36:39], v[16:19], v[176:179]
    v_fma_f32 v221, v221, v197, v197
    v_fma_f32 v222, v222, v197, v197
    v_fma_f32 v223, v223, v197, v197
    ds_read_b128 v[100:103], v8 offset:7168
    v_mfma_f32_16x16x32_bf16 v[180:183], v[40:43], v[16:19], v[180:183]
    v_rcp_f32 v216, v216
    v_rcp_f32 v217, v217
    v_rcp_f32 v218, v218
    ds_read_b128 v[104:107], v10 offset:17408
    v_mfma_f32_16x16x32_bf16 v[160:163], v[48:51], v[44:47], v[160:163]
    v_rcp_f32 v219, v219
    v_rcp_f32 v220, v220
    v_rcp_f32 v221, v221
    ds_read_b128 v[108:111], v10 offset:19456
    ds_read_b128 v[112:115], v10 offset:21504
    v_mfma_f32_16x16x32_bf16 v[164:167], v[52:55], v[44:47], v[164:167]
    v_rcp_f32 v222, v222
    v_rcp_f32 v223, v223
    v_mul_f32 v216, v216, v132
    ds_read_b128 v[116:119], v10 offset:23552
    v_mfma_f32_16x16x32_bf16 v[168:171], v[56:59], v[44:47], v[168:171]
    v_mul_f32 v217, v217, v133
    v_mul_f32 v218, v218, v134
    v_mul_f32 v219, v219, v135
    ds_read_b128 v[120:123], v10 offset:25600
    ds_read_b128 v[124:127], v10 offset:27648
    v_mfma_f32_16x16x32_bf16 v[172:175], v[60:63], v[44:47], v[172:175]
    v_mul_f32 v220, v220, v148
    v_mul_f32 v221, v221, v149
    v_mul_f32 v222, v222, v150
    v_mfma_f32_16x16x32_bf16 v[176:179], v[64:67], v[44:47], v[176:179]
    v_mul_f32 v223, v223, v151
    v_cvt_pk_bf16_f32 v224, v216, v217
    v_cvt_pk_bf16_f32 v225, v218, v219
    v_mfma_f32_16x16x32_bf16 v[180:183], v[68:71], v[44:47], v[180:183]
    v_cvt_pk_bf16_f32 v226, v220, v221
    v_cvt_pk_bf16_f32 v227, v222, v223
    buffer_store_dwordx4 v[224:227], v4, s[16:19], s53 offen sc1
    s_waitcnt lgkmcnt(0)
    s_barrier
    ds_read_b128 v[16:19], v8 offset:8192
    v_mfma_f32_16x16x32_bf16 v[160:163], v[76:79], v[72:75], v[160:163]
    v_fmac_f32 v136, v198, v184
    v_fmac_f32 v137, v198, v185
    ds_read_b128 v[20:23], v10 offset:32768
    v_mfma_f32_16x16x32_bf16 v[164:167], v[80:83], v[72:75], v[164:167]
    v_fmac_f32 v138, v198, v186
    v_fmac_f32 v139, v198, v187
    v_fmac_f32 v152, v198, v188
    ds_read_b128 v[24:27], v10 offset:34816
    ds_read_b128 v[28:31], v10 offset:36864
    v_mfma_f32_16x16x32_bf16 v[168:171], v[84:87], v[72:75], v[168:171]
    v_fmac_f32 v153, v198, v189
    v_fmac_f32 v154, v198, v190
    v_fmac_f32 v155, v198, v191
    ds_read_b128 v[32:35], v10 offset:38912
    v_mfma_f32_16x16x32_bf16 v[172:175], v[88:91], v[72:75], v[172:175]
    v_mul_f32 v204, v199, v136
    v_mul_f32 v205, v199, v137
    v_mul_f32 v206, v199, v138
    ds_read_b128 v[36:39], v10 offset:40960
    ds_read_b128 v[40:43], v10 offset:43008
    v_mfma_f32_16x16x32_bf16 v[176:179], v[92:95], v[72:75], v[176:179]
    v_mul_f32 v207, v199, v139
    v_mul_f32 v208, v199, v152
    v_mul_f32 v209, v199, v153
    ds_read_b128 v[44:47], v8 offset:9216
    v_mfma_f32_16x16x32_bf16 v[180:183], v[96:99], v[72:75], v[180:183]
    v_mul_f32 v210, v199, v154
    v_mul_f32 v211, v199, v155
    v_exp_f32 v204, v204
    ds_read_b128 v[48:51], v10 offset:33792
    v_mfma_f32_16x16x32_bf16 v[160:163], v[104:107], v[100:103], v[160:163]
    v_exp_f32 v205, v205
    v_exp_f32 v206, v206
    v_exp_f32 v207, v207
    ds_read_b128 v[52:55], v10 offset:35840
    ds_read_b128 v[56:59], v10 offset:37888
    v_mfma_f32_16x16x32_bf16 v[164:167], v[108:111], v[100:103], v[164:167]
    v_exp_f32 v208, v208
    v_exp_f32 v209, v209
    v_exp_f32 v210, v210
    ds_read_b128 v[60:63], v10 offset:39936
    v_mfma_f32_16x16x32_bf16 v[168:171], v[112:115], v[100:103], v[168:171]
    v_exp_f32 v211, v211
    v_fma_f32 v204, v204, v200, v200
    v_fma_f32 v205, v205, v200, v200
    ds_read_b128 v[64:67], v10 offset:41984
    ds_read_b128 v[68:71], v10 offset:44032
    v_mfma_f32_16x16x32_bf16 v[172:175], v[116:119], v[100:103], v[172:175]
    v_fma_f32 v206, v206, v200, v200
    v_fma_f32 v207, v207, v200, v200
    v_fma_f32 v208, v208, v200, v200
    v_mfma_f32_16x16x32_bf16 v[176:179], v[120:123], v[100:103], v[176:179]
    v_fma_f32 v209, v209, v200, v200
    v_fma_f32 v210, v210, v200, v200
    v_fma_f32 v211, v211, v200, v200
    v_mfma_f32_16x16x32_bf16 v[180:183], v[124:127], v[100:103], v[180:183]
    v_rcp_f32 v204, v204
    v_rcp_f32 v205, v205
    v_rcp_f32 v206, v206
    s_waitcnt lgkmcnt(0)
    s_barrier
    ds_read_b128 v[72:75], v8 offset:10240
    v_mfma_f32_16x16x32_bf16 v[160:163], v[20:23], v[16:19], v[160:163]
    v_rcp_f32 v207, v207
    v_rcp_f32 v208, v208
    ds_read_b128 v[76:79], v10 offset:49152
    v_mfma_f32_16x16x32_bf16 v[164:167], v[24:27], v[16:19], v[164:167]
    v_rcp_f32 v209, v209
    v_rcp_f32 v210, v210
    v_rcp_f32 v211, v211
    ds_read_b128 v[80:83], v10 offset:51200
    ds_read_b128 v[84:87], v10 offset:53248
    v_mfma_f32_16x16x32_bf16 v[168:171], v[28:31], v[16:19], v[168:171]
    v_mul_f32 v204, v204, v136
    v_mul_f32 v205, v205, v137
    v_mul_f32 v206, v206, v138
    ds_read_b128 v[88:91], v10 offset:55296
    v_mfma_f32_16x16x32_bf16 v[172:175], v[32:35], v[16:19], v[172:175]
    v_mul_f32 v207, v207, v139
    v_mul_f32 v208, v208, v152
    v_mul_f32 v209, v209, v153
    ds_read_b128 v[92:95], v10 offset:57344
    ds_read_b128 v[96:99], v10 offset:59392
    v_mfma_f32_16x16x32_bf16 v[176:179], v[36:39], v[16:19], v[176:179]
    v_mul_f32 v210, v210, v154
    v_mul_f32 v211, v211, v155
    v_cvt_pk_bf16_f32 v212, v204, v205
    ds_read_b128 v[100:103], v8 offset:11264
    v_mfma_f32_16x16x32_bf16 v[180:183], v[40:43], v[16:19], v[180:183]
    v_cvt_pk_bf16_f32 v213, v206, v207
    v_cvt_pk_bf16_f32 v214, v208, v209
    v_cvt_pk_bf16_f32 v215, v210, v211
    ds_read_b128 v[104:107], v10 offset:50176
    v_mfma_f32_16x16x32_bf16 v[160:163], v[48:51], v[44:47], v[160:163]
    buffer_store_dwordx4 v[212:215], v4, s[16:19], s54 offen sc1
    v_fmac_f32 v140, v201, v184
    v_fmac_f32 v141, v201, v185
    ds_read_b128 v[108:111], v10 offset:52224
    ds_read_b128 v[112:115], v10 offset:54272
    v_mfma_f32_16x16x32_bf16 v[164:167], v[52:55], v[44:47], v[164:167]
    v_fmac_f32 v142, v201, v186
    v_fmac_f32 v143, v201, v187
    v_fmac_f32 v156, v201, v188
    ds_read_b128 v[116:119], v10 offset:56320
    v_mfma_f32_16x16x32_bf16 v[168:171], v[56:59], v[44:47], v[168:171]
    v_fmac_f32 v157, v201, v189
    v_fmac_f32 v158, v201, v190
    v_fmac_f32 v159, v201, v191
    ds_read_b128 v[120:123], v10 offset:58368
    ds_read_b128 v[124:127], v10 offset:60416
    v_mfma_f32_16x16x32_bf16 v[172:175], v[60:63], v[44:47], v[172:175]
    v_mul_f32 v216, v202, v140
    v_mul_f32 v217, v202, v141
    v_mul_f32 v218, v202, v142
    v_mfma_f32_16x16x32_bf16 v[176:179], v[64:67], v[44:47], v[176:179]
    v_mul_f32 v219, v202, v143
    v_mul_f32 v220, v202, v156
    v_mul_f32 v221, v202, v157
    v_mfma_f32_16x16x32_bf16 v[180:183], v[68:71], v[44:47], v[180:183]
    v_mul_f32 v222, v202, v158
    v_mul_f32 v223, v202, v159
    v_exp_f32 v216, v216
    s_waitcnt lgkmcnt(0)
    s_barrier
    ds_read_b128 v[16:19], v8 offset:12288
    v_mfma_f32_16x16x32_bf16 v[160:163], v[76:79], v[72:75], v[160:163]
    v_exp_f32 v217, v217
    v_exp_f32 v218, v218
    v_exp_f32 v219, v219
    ds_read_b128 v[20:23], v10 offset:0
    v_mfma_f32_16x16x32_bf16 v[164:167], v[80:83], v[72:75], v[164:167]
    v_exp_f32 v220, v220
    v_exp_f32 v221, v221
    v_exp_f32 v222, v222
    ds_read_b128 v[24:27], v10 offset:2048
    ds_read_b128 v[28:31], v10 offset:4096
    v_mfma_f32_16x16x32_bf16 v[168:171], v[84:87], v[72:75], v[168:171]
    v_exp_f32 v223, v223
    v_fma_f32 v216, v216, v203, v203
    v_fma_f32 v217, v217, v203, v203
    ds_read_b128 v[32:35], v10 offset:6144
    v_mfma_f32_16x16x32_bf16 v[172:175], v[88:91], v[72:75], v[172:175]
    v_fma_f32 v218, v218, v203, v203
    v_fma_f32 v219, v219, v203, v203
    v_fma_f32 v220, v220, v203, v203
    ds_read_b128 v[36:39], v10 offset:8192
    ds_read_b128 v[40:43], v10 offset:10240
    v_mfma_f32_16x16x32_bf16 v[176:179], v[92:95], v[72:75], v[176:179]
    v_fma_f32 v221, v221, v203, v203
    v_fma_f32 v222, v222, v203, v203
    v_fma_f32 v223, v223, v203, v203
    ds_read_b128 v[44:47], v8 offset:13312
    v_mfma_f32_16x16x32_bf16 v[180:183], v[96:99], v[72:75], v[180:183]
    v_rcp_f32 v216, v216
    v_rcp_f32 v217, v217
    v_rcp_f32 v218, v218
    ds_read_b128 v[48:51], v10 offset:1024
    v_mfma_f32_16x16x32_bf16 v[160:163], v[104:107], v[100:103], v[160:163]
    v_rcp_f32 v219, v219
    v_rcp_f32 v220, v220
    v_rcp_f32 v221, v221
    ds_read_b128 v[52:55], v10 offset:3072
    ds_read_b128 v[56:59], v10 offset:5120
    v_mfma_f32_16x16x32_bf16 v[164:167], v[108:111], v[100:103], v[164:167]
    v_rcp_f32 v222, v222
    v_rcp_f32 v223, v223
    v_mul_f32 v216, v216, v140
    ds_read_b128 v[60:63], v10 offset:7168
    v_mfma_f32_16x16x32_bf16 v[168:171], v[112:115], v[100:103], v[168:171]
    v_mul_f32 v217, v217, v141
    v_mul_f32 v218, v218, v142
    v_mul_f32 v219, v219, v143
    ds_read_b128 v[64:67], v10 offset:9216
    ds_read_b128 v[68:71], v10 offset:11264
    v_mfma_f32_16x16x32_bf16 v[172:175], v[116:119], v[100:103], v[172:175]
    v_mul_f32 v220, v220, v156
    v_mul_f32 v221, v221, v157
    v_mul_f32 v222, v222, v158
    v_mfma_f32_16x16x32_bf16 v[176:179], v[120:123], v[100:103], v[176:179]
    v_mul_f32 v223, v223, v159
    v_cvt_pk_bf16_f32 v224, v216, v217
    v_cvt_pk_bf16_f32 v225, v218, v219
    v_mfma_f32_16x16x32_bf16 v[180:183], v[124:127], v[100:103], v[180:183]
    v_cvt_pk_bf16_f32 v226, v220, v221
    v_cvt_pk_bf16_f32 v227, v222, v223
    buffer_store_dwordx4 v[224:227], v4, s[16:19], s55 offen sc1
    s_waitcnt lgkmcnt(0)
    s_barrier
    ds_read_b128 v[72:75], v8 offset:14336
    v_mfma_f32_16x16x32_bf16 v[160:163], v[20:23], v[16:19], v[160:163]
    ds_read_b128 v[76:79], v10 offset:16384
    v_mfma_f32_16x16x32_bf16 v[164:167], v[24:27], v[16:19], v[164:167]
    ds_read_b128 v[80:83], v10 offset:18432
    ds_read_b128 v[84:87], v10 offset:20480
    v_mfma_f32_16x16x32_bf16 v[168:171], v[28:31], v[16:19], v[168:171]
    ds_read_b128 v[88:91], v10 offset:22528
    v_mfma_f32_16x16x32_bf16 v[172:175], v[32:35], v[16:19], v[172:175]
    ds_read_b128 v[92:95], v10 offset:24576
    ds_read_b128 v[96:99], v10 offset:26624
    v_mfma_f32_16x16x32_bf16 v[176:179], v[36:39], v[16:19], v[176:179]
    ds_read_b128 v[100:103], v8 offset:15360
    v_mfma_f32_16x16x32_bf16 v[180:183], v[40:43], v[16:19], v[180:183]
    ds_read_b128 v[104:107], v10 offset:17408
    v_mfma_f32_16x16x32_bf16 v[160:163], v[48:51], v[44:47], v[160:163]
    ds_read_b128 v[108:111], v10 offset:19456
    ds_read_b128 v[112:115], v10 offset:21504
    v_mfma_f32_16x16x32_bf16 v[164:167], v[52:55], v[44:47], v[164:167]
    ds_read_b128 v[116:119], v10 offset:23552
    v_mfma_f32_16x16x32_bf16 v[168:171], v[56:59], v[44:47], v[168:171]
    ds_read_b128 v[120:123], v10 offset:25600
    ds_read_b128 v[124:127], v10 offset:27648
    v_mfma_f32_16x16x32_bf16 v[172:175], v[60:63], v[44:47], v[172:175]
    v_mfma_f32_16x16x32_bf16 v[176:179], v[64:67], v[44:47], v[176:179]
    v_mfma_f32_16x16x32_bf16 v[180:183], v[68:71], v[44:47], v[180:183]
    s_waitcnt lgkmcnt(0)
    s_barrier
    ds_read_b128 v[16:19], v8 offset:16384
    v_mfma_f32_16x16x32_bf16 v[160:163], v[76:79], v[72:75], v[160:163]
    ds_read_b128 v[20:23], v10 offset:32768
    v_mfma_f32_16x16x32_bf16 v[164:167], v[80:83], v[72:75], v[164:167]
    ds_read_b128 v[24:27], v10 offset:34816
    ds_read_b128 v[28:31], v10 offset:36864
    v_mfma_f32_16x16x32_bf16 v[168:171], v[84:87], v[72:75], v[168:171]
    ds_read_b128 v[32:35], v10 offset:38912
    v_mfma_f32_16x16x32_bf16 v[172:175], v[88:91], v[72:75], v[172:175]
    ds_read_b128 v[36:39], v10 offset:40960
    ds_read_b128 v[40:43], v10 offset:43008
    v_mfma_f32_16x16x32_bf16 v[176:179], v[92:95], v[72:75], v[176:179]
    ds_read_b128 v[44:47], v8 offset:17408
    v_mfma_f32_16x16x32_bf16 v[180:183], v[96:99], v[72:75], v[180:183]
    ds_read_b128 v[48:51], v10 offset:33792
    v_mfma_f32_16x16x32_bf16 v[160:163], v[104:107], v[100:103], v[160:163]
    ds_read_b128 v[52:55], v10 offset:35840
    ds_read_b128 v[56:59], v10 offset:37888
    v_mfma_f32_16x16x32_bf16 v[164:167], v[108:111], v[100:103], v[164:167]
    ds_read_b128 v[60:63], v10 offset:39936
    v_mfma_f32_16x16x32_bf16 v[168:171], v[112:115], v[100:103], v[168:171]
    ds_read_b128 v[64:67], v10 offset:41984
    ds_read_b128 v[68:71], v10 offset:44032
    v_mfma_f32_16x16x32_bf16 v[172:175], v[116:119], v[100:103], v[172:175]
    v_mfma_f32_16x16x32_bf16 v[176:179], v[120:123], v[100:103], v[176:179]
    v_mfma_f32_16x16x32_bf16 v[180:183], v[124:127], v[100:103], v[180:183]
    s_waitcnt lgkmcnt(0)
    s_barrier
    s_lshl_b32 s42, s36, 7
    v_mfma_f32_16x16x32_bf16 v[160:163], v[20:23], v[16:19], v[160:163]
    v_lshl_add_u32 v12, v2, 3, s42
    v_add_u32 v12, 148480, v12
    v_mfma_f32_16x16x32_bf16 v[164:167], v[24:27], v[16:19], v[164:167]
    v_lshlrev_b32 v13, 4, v3
    v_add_u32 v13, 147456, v13
    v_mfma_f32_16x16x32_bf16 v[168:171], v[28:31], v[16:19], v[168:171]
    ds_read_b128 v[72:75], v8 offset:18432
    ds_read_b128 v[76:79], v10 offset:49152
    v_mfma_f32_16x16x32_bf16 v[172:175], v[32:35], v[16:19], v[172:175]
    ds_read_b128 v[80:83], v10 offset:51200
    ds_read_b128 v[84:87], v10 offset:53248
    v_mfma_f32_16x16x32_bf16 v[176:179], v[36:39], v[16:19], v[176:179]
    ds_read_b128 v[88:91], v10 offset:55296
    ds_read_b128 v[92:95], v10 offset:57344
    v_mfma_f32_16x16x32_bf16 v[180:183], v[40:43], v[16:19], v[180:183]
    ds_read_b128 v[96:99], v10 offset:59392
    ds_read_b128 v[100:103], v8 offset:19456
    v_mfma_f32_16x16x32_bf16 v[160:163], v[48:51], v[44:47], v[160:163]
    ds_read_b128 v[104:107], v10 offset:50176
    ds_read_b128 v[108:111], v10 offset:52224
    v_mfma_f32_16x16x32_bf16 v[164:167], v[52:55], v[44:47], v[164:167]
    ds_read_b128 v[112:115], v10 offset:54272
    ds_read_b128 v[116:119], v10 offset:56320
    v_mfma_f32_16x16x32_bf16 v[168:171], v[56:59], v[44:47], v[168:171]
    ds_read_b128 v[120:123], v10 offset:58368
    ds_read_b128 v[124:127], v10 offset:60416
    v_mfma_f32_16x16x32_bf16 v[172:175], v[60:63], v[44:47], v[172:175]
    v_mfma_f32_16x16x32_bf16 v[176:179], v[64:67], v[44:47], v[176:179]
    v_mfma_f32_16x16x32_bf16 v[180:183], v[68:71], v[44:47], v[180:183]
    s_add_u32 s42, s14, 16384
    v_mov_b32 v250, 163836
    v_mov_b32 v251, 1
    s_waitcnt vmcnt(0)
    s_mov_b64 exec, 1
    ds_add_rtn_u32 v252, v250, v251
    v_mov_b32 v250, 0
    s_waitcnt lgkmcnt(0)
    v_readfirstlane_b32 s72, v252
    s_cmp_eq_u32 s72, 3
    s_cbranch_scc0 sequential_preLN__grouped_kv_mqa__dense_activation_silu__prompt_kernel_pub14
    buffer_atomic_add v251, v250, s[16:19], s42 offen sc1

sequential_preLN__grouped_kv_mqa__dense_activation_silu__prompt_kernel_pub14:
    s_mov_b64 exec, -1
    s_waitcnt lgkmcnt(0)
    v_mfma_f32_16x16x32_bf16 v[160:163], v[76:79], v[72:75], v[160:163]
    ds_read_b64 v[192:193], v12
    v_mfma_f32_16x16x32_bf16 v[164:167], v[80:83], v[72:75], v[164:167]
    ds_read_b128 v[16:19], v13 offset:512
    v_mfma_f32_16x16x32_bf16 v[168:171], v[84:87], v[72:75], v[168:171]
    v_mfma_f32_16x16x32_bf16 v[172:175], v[88:91], v[72:75], v[172:175]
    ds_read_b128 v[20:23], v13 offset:576
    v_mfma_f32_16x16x32_bf16 v[176:179], v[92:95], v[72:75], v[176:179]
    ds_read_b128 v[24:27], v13 offset:640
    v_mfma_f32_16x16x32_bf16 v[180:183], v[96:99], v[72:75], v[180:183]
    v_mfma_f32_16x16x32_bf16 v[160:163], v[104:107], v[100:103], v[160:163]
    ds_read_b128 v[28:31], v13 offset:704
    v_mfma_f32_16x16x32_bf16 v[164:167], v[108:111], v[100:103], v[164:167]
    ds_read_b128 v[32:35], v13 offset:768
    v_mfma_f32_16x16x32_bf16 v[168:171], v[112:115], v[100:103], v[168:171]
    ds_read_b128 v[36:39], v13 offset:832
    v_mfma_f32_16x16x32_bf16 v[172:175], v[116:119], v[100:103], v[172:175]
    v_mfma_f32_16x16x32_bf16 v[176:179], v[120:123], v[100:103], v[176:179]
    v_mfma_f32_16x16x32_bf16 v[180:183], v[124:127], v[100:103], v[180:183]
    s_waitcnt lgkmcnt(0)
    s_barrier
    v_sqrt_f32 v194, v193
    v_rsq_f32 v193, v193
    v_sub_f32 v192, 0, v192
    v_mul_f32 v193, 0xbfb8aa3b, v193

    v_fmac_f32 v160, v192, v16
    v_fmac_f32 v161, v192, v17
    v_fmac_f32 v162, v192, v18
    v_fmac_f32 v163, v192, v19
    v_fmac_f32 v164, v192, v20
    v_fmac_f32 v165, v192, v21
    v_fmac_f32 v166, v192, v22
    v_fmac_f32 v167, v192, v23
    v_mul_f32 v204, v193, v160
    v_mul_f32 v205, v193, v161
    v_mul_f32 v206, v193, v162
    v_mul_f32 v207, v193, v163
    v_mul_f32 v208, v193, v164
    v_mul_f32 v209, v193, v165
    v_mul_f32 v210, v193, v166
    v_mul_f32 v211, v193, v167
    v_exp_f32 v204, v204
    v_exp_f32 v205, v205
    v_exp_f32 v206, v206
    v_exp_f32 v207, v207
    v_exp_f32 v208, v208
    v_exp_f32 v209, v209
    v_exp_f32 v210, v210
    v_exp_f32 v211, v211
    v_fma_f32 v204, v204, v194, v194
    v_fma_f32 v205, v205, v194, v194
    v_fma_f32 v206, v206, v194, v194
    v_fma_f32 v207, v207, v194, v194
    v_fma_f32 v208, v208, v194, v194
    v_fma_f32 v209, v209, v194, v194
    v_fma_f32 v210, v210, v194, v194
    v_fma_f32 v211, v211, v194, v194
    v_rcp_f32 v204, v204
    v_rcp_f32 v205, v205
    v_rcp_f32 v206, v206
    v_rcp_f32 v207, v207
    v_rcp_f32 v208, v208
    v_rcp_f32 v209, v209
    v_rcp_f32 v210, v210
    v_rcp_f32 v211, v211
    v_mul_f32 v204, v204, v160
    v_mul_f32 v205, v205, v161
    v_mul_f32 v206, v206, v162
    v_mul_f32 v207, v207, v163
    v_mul_f32 v208, v208, v164
    v_mul_f32 v209, v209, v165
    v_mul_f32 v210, v210, v166
    v_mul_f32 v211, v211, v167
    v_cvt_pk_bf16_f32 v212, v204, v205
    v_cvt_pk_bf16_f32 v213, v206, v207
    v_cvt_pk_bf16_f32 v214, v208, v209
    v_cvt_pk_bf16_f32 v215, v210, v211
    buffer_store_dwordx4 v[212:215], v4, s[16:19], s56 offen sc1
    v_fmac_f32 v168, v192, v24
    v_fmac_f32 v169, v192, v25
    v_fmac_f32 v170, v192, v26
    v_fmac_f32 v171, v192, v27
    v_fmac_f32 v172, v192, v28
    v_fmac_f32 v173, v192, v29
    v_fmac_f32 v174, v192, v30
    v_fmac_f32 v175, v192, v31
    v_mul_f32 v216, v193, v168
    v_mul_f32 v217, v193, v169
    v_mul_f32 v218, v193, v170
    v_mul_f32 v219, v193, v171
    v_mul_f32 v220, v193, v172
    v_mul_f32 v221, v193, v173
    v_mul_f32 v222, v193, v174
    v_mul_f32 v223, v193, v175
    v_exp_f32 v216, v216
    v_exp_f32 v217, v217
    v_exp_f32 v218, v218
    v_exp_f32 v219, v219
    v_exp_f32 v220, v220
    v_exp_f32 v221, v221
    v_exp_f32 v222, v222
    v_exp_f32 v223, v223
    v_fma_f32 v216, v216, v194, v194
    v_fma_f32 v217, v217, v194, v194
    v_fma_f32 v218, v218, v194, v194
    v_fma_f32 v219, v219, v194, v194
    v_fma_f32 v220, v220, v194, v194
    v_fma_f32 v221, v221, v194, v194
    v_fma_f32 v222, v222, v194, v194
    v_fma_f32 v223, v223, v194, v194
    v_rcp_f32 v216, v216
    v_rcp_f32 v217, v217
    v_rcp_f32 v218, v218
    v_rcp_f32 v219, v219
    v_rcp_f32 v220, v220
    v_rcp_f32 v221, v221
    v_rcp_f32 v222, v222
    v_rcp_f32 v223, v223
    v_mul_f32 v216, v216, v168
    v_mul_f32 v217, v217, v169
    v_mul_f32 v218, v218, v170
    v_mul_f32 v219, v219, v171
    v_mul_f32 v220, v220, v172
    v_mul_f32 v221, v221, v173
    v_mul_f32 v222, v222, v174
    v_mul_f32 v223, v223, v175
    v_cvt_pk_bf16_f32 v224, v216, v217
    v_cvt_pk_bf16_f32 v225, v218, v219
    v_cvt_pk_bf16_f32 v226, v220, v221
    v_cvt_pk_bf16_f32 v227, v222, v223
    buffer_store_dwordx4 v[224:227], v4, s[16:19], s57 offen sc1
    v_fmac_f32 v176, v192, v32
    v_fmac_f32 v177, v192, v33
    v_fmac_f32 v178, v192, v34
    v_fmac_f32 v179, v192, v35
    v_fmac_f32 v180, v192, v36
    v_fmac_f32 v181, v192, v37
    v_fmac_f32 v182, v192, v38
    v_fmac_f32 v183, v192, v39
    v_mul_f32 v204, v193, v176
    v_mul_f32 v205, v193, v177
    v_mul_f32 v206, v193, v178
    v_mul_f32 v207, v193, v179
    v_mul_f32 v208, v193, v180
    v_mul_f32 v209, v193, v181
    v_mul_f32 v210, v193, v182
    v_mul_f32 v211, v193, v183
    v_exp_f32 v204, v204
    v_exp_f32 v205, v205
    v_exp_f32 v206, v206
    v_exp_f32 v207, v207
    v_exp_f32 v208, v208
    v_exp_f32 v209, v209
    v_exp_f32 v210, v210
    v_exp_f32 v211, v211
    v_fma_f32 v204, v204, v194, v194
    v_fma_f32 v205, v205, v194, v194
    v_fma_f32 v206, v206, v194, v194
    v_fma_f32 v207, v207, v194, v194
    v_fma_f32 v208, v208, v194, v194
    v_fma_f32 v209, v209, v194, v194
    v_fma_f32 v210, v210, v194, v194
    v_fma_f32 v211, v211, v194, v194
    v_rcp_f32 v204, v204
    v_rcp_f32 v205, v205
    v_rcp_f32 v206, v206
    v_rcp_f32 v207, v207
    v_rcp_f32 v208, v208
    v_rcp_f32 v209, v209
    v_rcp_f32 v210, v210
    v_rcp_f32 v211, v211
    v_mul_f32 v204, v204, v176
    v_mul_f32 v205, v205, v177
    v_mul_f32 v206, v206, v178
    v_mul_f32 v207, v207, v179
    v_mul_f32 v208, v208, v180
    v_mul_f32 v209, v209, v181
    v_mul_f32 v210, v210, v182
    v_mul_f32 v211, v211, v183
    v_cvt_pk_bf16_f32 v212, v204, v205
    v_cvt_pk_bf16_f32 v213, v206, v207
    v_cvt_pk_bf16_f32 v214, v208, v209
    v_cvt_pk_bf16_f32 v215, v210, v211
    buffer_store_dwordx4 v[212:215], v4, s[16:19], s58 offen sc1
    s_mov_b32 s24, s32
    s_and_b32 s25, s33, 0xffff
    s_mov_b32 s26, 0x280000
    s_mov_b32 s27, 0x00020000
    v_and_b32 v2, 15, v1
    v_lshrrev_b32 v3, 4, v1
    s_and_b32 s44, s36, 1
    s_lshl_b32 s45, s37, 2
    s_lshl_b32 s42, s44, 1
    s_add_u32 s45, s45, s42
    v_mul_u32_u24 v5, 1280, v2
    v_lshl_add_u32 v5, v3, 3, v5
    s_mul_i32 s46, s45, 20480
    s_mul_i32 s42, s38, 160
    s_add_u32 s46, s46, s42
    s_add_u32 s47, s46, 20480
    s_mul_i32 s43, s38, 5
    s_lshl_b32 s42, s44, 12
    v_lshrrev_b32 v6, 1, v3
    v_lshl_add_u32 v6, v6, 4, v2
    v_lshlrev_b32 v6, 4, v6
    v_and_b32 v7, 1, v3

    v_mul_u32_u24 v7, 8, v7
    v_add_u32 v8, v6, v7
    v_add_u32 v48, s42, v4
    v_add_u32 v49, 57344, v4
    v_add_u32 v50, 118784, v4
    s_cmp_ge_u32 s36, 2
    s_cbranch_scc1 sequential_preLN__grouped_kv_mqa__dense_activation_silu__prompt_kernel_c5b
    s_add_u32 s40, s43, 0
    s_lshl_b32 s40, s40, 9
    s_mul_i32 s41, s45, 20480
    s_add_u32 s40, s40, s41
    s_add_u32 s52, s40, 6291456
    s_add_u32 s55, s52, 20480

    s_add_u32 s40, s43, 1
    s_lshl_b32 s40, s40, 9
    s_mul_i32 s41, s45, 20480
    s_add_u32 s40, s40, s41
    s_add_u32 s53, s40, 6291456
    s_add_u32 s56, s53, 20480

    s_add_u32 s40, s43, 2
    s_lshl_b32 s40, s40, 9
    s_mul_i32 s41, s45, 20480
    s_add_u32 s40, s40, s41
    s_add_u32 s54, s40, 6291456
    s_add_u32 s57, s54, 20480

    buffer_load_dwordx2 v[36:37], v8, s[16:19], s52 offen sc1
    buffer_load_dwordx2 v[40:41], v8, s[16:19], s53 offen sc1
    buffer_load_dwordx2 v[44:45], v8, s[16:19], s54 offen sc1
    buffer_load_dwordx2 v[38:39], v8, s[16:19], s55 offen sc1
    buffer_load_dwordx2 v[42:43], v8, s[16:19], s56 offen sc1
    buffer_load_dwordx2 v[46:47], v8, s[16:19], s57 offen sc1
    s_barrier
    ds_read_b128 v[64:67], v48 offset:0
    ds_read_b128 v[68:71], v48 offset:2048
    ds_read_b128 v[72:75], v49 offset:0
    ds_read_b128 v[76:79], v49 offset:2048
    ds_read_b128 v[80:83], v49 offset:4096
    ds_read_b128 v[84:87], v48 offset:1024
    ds_read_b128 v[88:91], v48 offset:3072
    ds_read_b128 v[92:95], v49 offset:1024
    ds_read_b128 v[96:99], v49 offset:3072
    ds_read_b128 v[100:103], v49 offset:5120
    s_waitcnt lgkmcnt(0)
    s_barrier
    ds_read_b128 v[104:107], v48 offset:8192
    v_mfma_f32_16x16x32_bf16 v[12:15], v[72:75], v[64:67], 0
    ds_read_b128 v[108:111], v48 offset:10240
    v_mfma_f32_16x16x32_bf16 v[16:19], v[72:75], v[68:71], 0
    ds_read_b128 v[112:115], v49 offset:10240
    v_mfma_f32_16x16x32_bf16 v[20:23], v[76:79], v[64:67], 0
    ds_read_b128 v[116:119], v49 offset:12288
    v_mfma_f32_16x16x32_bf16 v[24:27], v[76:79], v[68:71], 0
    ds_read_b128 v[120:123], v49 offset:14336
    v_mfma_f32_16x16x32_bf16 v[28:31], v[80:83], v[64:67], 0
    ds_read_b128 v[124:127], v48 offset:9216
    v_mfma_f32_16x16x32_bf16 v[32:35], v[80:83], v[68:71], 0
    ds_read_b128 v[128:131], v48 offset:11264
    v_mfma_f32_16x16x32_bf16 v[12:15], v[92:95], v[84:87], v[12:15]
    ds_read_b128 v[132:135], v49 offset:11264
    v_mfma_f32_16x16x32_bf16 v[16:19], v[92:95], v[88:91], v[16:19]
    ds_read_b128 v[136:139], v49 offset:13312
    v_mfma_f32_16x16x32_bf16 v[20:23], v[96:99], v[84:87], v[20:23]
    ds_read_b128 v[140:143], v49 offset:15360
    v_mfma_f32_16x16x32_bf16 v[24:27], v[96:99], v[88:91], v[24:27]
    v_mfma_f32_16x16x32_bf16 v[28:31], v[100:103], v[84:87], v[28:31]
    v_mfma_f32_16x16x32_bf16 v[32:35], v[100:103], v[88:91], v[32:35]
    s_waitcnt lgkmcnt(0)
    s_barrier
    ds_read_b128 v[64:67], v48 offset:16384
    v_mfma_f32_16x16x32_bf16 v[12:15], v[112:115], v[104:107], v[12:15]
    ds_read_b128 v[68:71], v48 offset:18432
    v_mfma_f32_16x16x32_bf16 v[16:19], v[112:115], v[108:111], v[16:19]
    ds_read_b128 v[72:75], v49 offset:20480
    v_mfma_f32_16x16x32_bf16 v[20:23], v[116:119], v[104:107], v[20:23]
    ds_read_b128 v[76:79], v49 offset:22528
    v_mfma_f32_16x16x32_bf16 v[24:27], v[116:119], v[108:111], v[24:27]
    ds_read_b128 v[80:83], v49 offset:24576
    v_mfma_f32_16x16x32_bf16 v[28:31], v[120:123], v[104:107], v[28:31]
    ds_read_b128 v[84:87], v48 offset:17408
    v_mfma_f32_16x16x32_bf16 v[32:35], v[120:123], v[108:111], v[32:35]
    ds_read_b128 v[88:91], v48 offset:19456
    v_mfma_f32_16x16x32_bf16 v[12:15], v[132:135], v[124:127], v[12:15]
    ds_read_b128 v[92:95], v49 offset:21504
    v_mfma_f32_16x16x32_bf16 v[16:19], v[132:135], v[128:131], v[16:19]
    ds_read_b128 v[96:99], v49 offset:23552
    v_mfma_f32_16x16x32_bf16 v[20:23], v[136:139], v[124:127], v[20:23]
    ds_read_b128 v[100:103], v49 offset:25600
    v_mfma_f32_16x16x32_bf16 v[24:27], v[136:139], v[128:131], v[24:27]
    v_mfma_f32_16x16x32_bf16 v[28:31], v[140:143], v[124:127], v[28:31]
    v_mfma_f32_16x16x32_bf16 v[32:35], v[140:143], v[128:131], v[32:35]
    s_waitcnt lgkmcnt(0)
    s_barrier
    ds_read_b128 v[104:107], v48 offset:24576
    v_mfma_f32_16x16x32_bf16 v[12:15], v[72:75], v[64:67], v[12:15]
    ds_read_b128 v[108:111], v48 offset:26624
    v_mfma_f32_16x16x32_bf16 v[16:19], v[72:75], v[68:71], v[16:19]
    ds_read_b128 v[112:115], v49 offset:30720
    v_mfma_f32_16x16x32_bf16 v[20:23], v[76:79], v[64:67], v[20:23]
    ds_read_b128 v[116:119], v49 offset:32768
    v_mfma_f32_16x16x32_bf16 v[24:27], v[76:79], v[68:71], v[24:27]
    ds_read_b128 v[120:123], v49 offset:34816
    v_mfma_f32_16x16x32_bf16 v[28:31], v[80:83], v[64:67], v[28:31]
    ds_read_b128 v[124:127], v48 offset:25600
    v_mfma_f32_16x16x32_bf16 v[32:35], v[80:83], v[68:71], v[32:35]
    ds_read_b128 v[128:131], v48 offset:27648
    v_mfma_f32_16x16x32_bf16 v[12:15], v[92:95], v[84:87], v[12:15]
    ds_read_b128 v[132:135], v49 offset:31744
    v_mfma_f32_16x16x32_bf16 v[16:19], v[92:95], v[88:91], v[16:19]
    ds_read_b128 v[136:139], v49 offset:33792
    v_mfma_f32_16x16x32_bf16 v[20:23], v[96:99], v[84:87], v[20:23]
    ds_read_b128 v[140:143], v49 offset:35840
    v_mfma_f32_16x16x32_bf16 v[24:27], v[96:99], v[88:91], v[24:27]
    v_mfma_f32_16x16x32_bf16 v[28:31], v[100:103], v[84:87], v[28:31]
    v_mfma_f32_16x16x32_bf16 v[32:35], v[100:103], v[88:91], v[32:35]
    s_add_u32 s42, s14, 8192
    v_mov_b32 v250, 163832
    v_mov_b32 v251, 1
    s_waitcnt vmcnt(0)
    s_mov_b64 exec, 1
    ds_add_rtn_u32 v252, v250, v251
    v_mov_b32 v250, 0
    s_waitcnt lgkmcnt(0)
    v_readfirstlane_b32 s72, v252
    s_cmp_eq_u32 s72, 3
    s_cbranch_scc0 sequential_preLN__grouped_kv_mqa__dense_activation_silu__prompt_kernel_pub15
    buffer_atomic_add v251, v250, s[16:19], s42 offen sc1

sequential_preLN__grouped_kv_mqa__dense_activation_silu__prompt_kernel_pub15:
    s_mov_b64 exec, -1
    s_waitcnt lgkmcnt(0)
    s_barrier
    ds_read_b128 v[64:67], v48 offset:32768
    v_mfma_f32_16x16x32_bf16 v[12:15], v[112:115], v[104:107], v[12:15]
    ds_read_b128 v[68:71], v48 offset:34816
    v_mfma_f32_16x16x32_bf16 v[16:19], v[112:115], v[108:111], v[16:19]
    ds_read_b128 v[72:75], v49 offset:40960
    v_mfma_f32_16x16x32_bf16 v[20:23], v[116:119], v[104:107], v[20:23]
    ds_read_b128 v[76:79], v49 offset:43008
    v_mfma_f32_16x16x32_bf16 v[24:27], v[116:119], v[108:111], v[24:27]
    ds_read_b128 v[80:83], v49 offset:45056
    v_mfma_f32_16x16x32_bf16 v[28:31], v[120:123], v[104:107], v[28:31]
    ds_read_b128 v[84:87], v48 offset:33792
    v_mfma_f32_16x16x32_bf16 v[32:35], v[120:123], v[108:111], v[32:35]
    ds_read_b128 v[88:91], v48 offset:35840
    v_mfma_f32_16x16x32_bf16 v[12:15], v[132:135], v[124:127], v[12:15]
    ds_read_b128 v[92:95], v49 offset:41984
    v_mfma_f32_16x16x32_bf16 v[16:19], v[132:135], v[128:131], v[16:19]
    ds_read_b128 v[96:99], v49 offset:44032
    v_mfma_f32_16x16x32_bf16 v[20:23], v[136:139], v[124:127], v[20:23]
    ds_read_b128 v[100:103], v49 offset:46080
    v_mfma_f32_16x16x32_bf16 v[24:27], v[136:139], v[128:131], v[24:27]
    v_mfma_f32_16x16x32_bf16 v[28:31], v[140:143], v[124:127], v[28:31]
    v_mfma_f32_16x16x32_bf16 v[32:35], v[140:143], v[128:131], v[32:35]
    s_waitcnt lgkmcnt(0)
    s_barrier
    ds_read_b128 v[104:107], v48 offset:40960
    v_mfma_f32_16x16x32_bf16 v[12:15], v[72:75], v[64:67], v[12:15]
    ds_read_b128 v[108:111], v48 offset:43008
    v_mfma_f32_16x16x32_bf16 v[16:19], v[72:75], v[68:71], v[16:19]
    ds_read_b128 v[112:115], v49 offset:51200
    v_mfma_f32_16x16x32_bf16 v[20:23], v[76:79], v[64:67], v[20:23]
    ds_read_b128 v[116:119], v49 offset:53248
    v_mfma_f32_16x16x32_bf16 v[24:27], v[76:79], v[68:71], v[24:27]
    ds_read_b128 v[120:123], v49 offset:55296
    v_mfma_f32_16x16x32_bf16 v[28:31], v[80:83], v[64:67], v[28:31]
    ds_read_b128 v[124:127], v48 offset:41984
    v_mfma_f32_16x16x32_bf16 v[32:35], v[80:83], v[68:71], v[32:35]
    ds_read_b128 v[128:131], v48 offset:44032
    v_mfma_f32_16x16x32_bf16 v[12:15], v[92:95], v[84:87], v[12:15]
    ds_read_b128 v[132:135], v49 offset:52224
    v_mfma_f32_16x16x32_bf16 v[16:19], v[92:95], v[88:91], v[16:19]
    ds_read_b128 v[136:139], v49 offset:54272
    v_mfma_f32_16x16x32_bf16 v[20:23], v[96:99], v[84:87], v[20:23]
    ds_read_b128 v[140:143], v49 offset:56320
    v_mfma_f32_16x16x32_bf16 v[24:27], v[96:99], v[88:91], v[24:27]
    v_mfma_f32_16x16x32_bf16 v[28:31], v[100:103], v[84:87], v[28:31]
    v_mfma_f32_16x16x32_bf16 v[32:35], v[100:103], v[88:91], v[32:35]
    s_waitcnt lgkmcnt(0)
    s_barrier
    ds_read_b128 v[64:67], v48 offset:49152
    v_mfma_f32_16x16x32_bf16 v[12:15], v[112:115], v[104:107], v[12:15]
    ds_read_b128 v[68:71], v48 offset:51200
    v_mfma_f32_16x16x32_bf16 v[16:19], v[112:115], v[108:111], v[16:19]
    ds_read_b128 v[72:75], v50 offset:0
    v_mfma_f32_16x16x32_bf16 v[20:23], v[116:119], v[104:107], v[20:23]
    ds_read_b128 v[76:79], v50 offset:2048
    v_mfma_f32_16x16x32_bf16 v[24:27], v[116:119], v[108:111], v[24:27]
    ds_read_b128 v[80:83], v50 offset:4096
    v_mfma_f32_16x16x32_bf16 v[28:31], v[120:123], v[104:107], v[28:31]
    ds_read_b128 v[84:87], v48 offset:50176
    v_mfma_f32_16x16x32_bf16 v[32:35], v[120:123], v[108:111], v[32:35]
    ds_read_b128 v[88:91], v48 offset:52224
    v_mfma_f32_16x16x32_bf16 v[12:15], v[132:135], v[124:127], v[12:15]
    ds_read_b128 v[92:95], v50 offset:1024
    v_mfma_f32_16x16x32_bf16 v[16:19], v[132:135], v[128:131], v[16:19]
    ds_read_b128 v[96:99], v50 offset:3072
    v_mfma_f32_16x16x32_bf16 v[20:23], v[136:139], v[124:127], v[20:23]
    ds_read_b128 v[100:103], v50 offset:5120
    v_mfma_f32_16x16x32_bf16 v[24:27], v[136:139], v[128:131], v[24:27]
    v_mfma_f32_16x16x32_bf16 v[28:31], v[140:143], v[124:127], v[28:31]
    v_mfma_f32_16x16x32_bf16 v[32:35], v[140:143], v[128:131], v[32:35]
    s_waitcnt lgkmcnt(0)
    s_barrier
    ds_read_b128 v[104:107], v48 offset:0
    v_mfma_f32_16x16x32_bf16 v[12:15], v[72:75], v[64:67], v[12:15]
    ds_read_b128 v[108:111], v48 offset:2048
    v_mfma_f32_16x16x32_bf16 v[16:19], v[72:75], v[68:71], v[16:19]
    ds_read_b128 v[112:115], v49 offset:0
    v_mfma_f32_16x16x32_bf16 v[20:23], v[76:79], v[64:67], v[20:23]
    ds_read_b128 v[116:119], v49 offset:2048
    v_mfma_f32_16x16x32_bf16 v[24:27], v[76:79], v[68:71], v[24:27]
    ds_read_b128 v[120:123], v49 offset:4096
    v_mfma_f32_16x16x32_bf16 v[28:31], v[80:83], v[64:67], v[28:31]
    ds_read_b128 v[124:127], v48 offset:1024
    v_mfma_f32_16x16x32_bf16 v[32:35], v[80:83], v[68:71], v[32:35]
    ds_read_b128 v[128:131], v48 offset:3072
    v_mfma_f32_16x16x32_bf16 v[12:15], v[92:95], v[84:87], v[12:15]
    ds_read_b128 v[132:135], v49 offset:1024
    v_mfma_f32_16x16x32_bf16 v[16:19], v[92:95], v[88:91], v[16:19]
    ds_read_b128 v[136:139], v49 offset:3072
    v_mfma_f32_16x16x32_bf16 v[20:23], v[96:99], v[84:87], v[20:23]
    ds_read_b128 v[140:143], v49 offset:5120
    v_mfma_f32_16x16x32_bf16 v[24:27], v[96:99], v[88:91], v[24:27]
    v_mfma_f32_16x16x32_bf16 v[28:31], v[100:103], v[84:87], v[28:31]
    v_mfma_f32_16x16x32_bf16 v[32:35], v[100:103], v[88:91], v[32:35]
    s_waitcnt lgkmcnt(0)
    s_barrier
    ds_read_b128 v[64:67], v48 offset:8192
    v_mfma_f32_16x16x32_bf16 v[12:15], v[112:115], v[104:107], v[12:15]
    ds_read_b128 v[68:71], v48 offset:10240
    v_mfma_f32_16x16x32_bf16 v[16:19], v[112:115], v[108:111], v[16:19]
    ds_read_b128 v[72:75], v49 offset:10240
    v_mfma_f32_16x16x32_bf16 v[20:23], v[116:119], v[104:107], v[20:23]
    ds_read_b128 v[76:79], v49 offset:12288
    v_mfma_f32_16x16x32_bf16 v[24:27], v[116:119], v[108:111], v[24:27]
    ds_read_b128 v[80:83], v49 offset:14336
    v_mfma_f32_16x16x32_bf16 v[28:31], v[120:123], v[104:107], v[28:31]
    ds_read_b128 v[84:87], v48 offset:9216
    v_mfma_f32_16x16x32_bf16 v[32:35], v[120:123], v[108:111], v[32:35]
    ds_read_b128 v[88:91], v48 offset:11264
    v_mfma_f32_16x16x32_bf16 v[12:15], v[132:135], v[124:127], v[12:15]
    ds_read_b128 v[92:95], v49 offset:11264
    v_mfma_f32_16x16x32_bf16 v[16:19], v[132:135], v[128:131], v[16:19]
    ds_read_b128 v[96:99], v49 offset:13312
    v_mfma_f32_16x16x32_bf16 v[20:23], v[136:139], v[124:127], v[20:23]
    ds_read_b128 v[100:103], v49 offset:15360
    v_mfma_f32_16x16x32_bf16 v[24:27], v[136:139], v[128:131], v[24:27]
    v_mfma_f32_16x16x32_bf16 v[28:31], v[140:143], v[124:127], v[28:31]
    v_mfma_f32_16x16x32_bf16 v[32:35], v[140:143], v[128:131], v[32:35]
    s_waitcnt lgkmcnt(0)
    s_barrier
    ds_read_b128 v[104:107], v48 offset:16384
    v_mfma_f32_16x16x32_bf16 v[12:15], v[72:75], v[64:67], v[12:15]
    ds_read_b128 v[108:111], v48 offset:18432
    v_mfma_f32_16x16x32_bf16 v[16:19], v[72:75], v[68:71], v[16:19]
    ds_read_b128 v[112:115], v49 offset:20480
    v_mfma_f32_16x16x32_bf16 v[20:23], v[76:79], v[64:67], v[20:23]
    ds_read_b128 v[116:119], v49 offset:22528
    v_mfma_f32_16x16x32_bf16 v[24:27], v[76:79], v[68:71], v[24:27]
    ds_read_b128 v[120:123], v49 offset:24576
    v_mfma_f32_16x16x32_bf16 v[28:31], v[80:83], v[64:67], v[28:31]
    ds_read_b128 v[124:127], v48 offset:17408
    v_mfma_f32_16x16x32_bf16 v[32:35], v[80:83], v[68:71], v[32:35]
    ds_read_b128 v[128:131], v48 offset:19456
    v_mfma_f32_16x16x32_bf16 v[12:15], v[92:95], v[84:87], v[12:15]
    ds_read_b128 v[132:135], v49 offset:21504
    v_mfma_f32_16x16x32_bf16 v[16:19], v[92:95], v[88:91], v[16:19]
    ds_read_b128 v[136:139], v49 offset:23552
    v_mfma_f32_16x16x32_bf16 v[20:23], v[96:99], v[84:87], v[20:23]
    ds_read_b128 v[140:143], v49 offset:25600
    v_mfma_f32_16x16x32_bf16 v[24:27], v[96:99], v[88:91], v[24:27]
    v_mfma_f32_16x16x32_bf16 v[28:31], v[100:103], v[84:87], v[28:31]
    v_mfma_f32_16x16x32_bf16 v[32:35], v[100:103], v[88:91], v[32:35]
    s_waitcnt lgkmcnt(0)
    s_barrier
    ds_read_b128 v[64:67], v48 offset:24576
    v_mfma_f32_16x16x32_bf16 v[12:15], v[112:115], v[104:107], v[12:15]
    ds_read_b128 v[68:71], v48 offset:26624
    v_mfma_f32_16x16x32_bf16 v[16:19], v[112:115], v[108:111], v[16:19]
    ds_read_b128 v[72:75], v49 offset:30720
    v_mfma_f32_16x16x32_bf16 v[20:23], v[116:119], v[104:107], v[20:23]
    ds_read_b128 v[76:79], v49 offset:32768
    v_mfma_f32_16x16x32_bf16 v[24:27], v[116:119], v[108:111], v[24:27]
    ds_read_b128 v[80:83], v49 offset:34816
    v_mfma_f32_16x16x32_bf16 v[28:31], v[120:123], v[104:107], v[28:31]
    ds_read_b128 v[84:87], v48 offset:25600
    v_mfma_f32_16x16x32_bf16 v[32:35], v[120:123], v[108:111], v[32:35]
    ds_read_b128 v[88:91], v48 offset:27648
    v_mfma_f32_16x16x32_bf16 v[12:15], v[132:135], v[124:127], v[12:15]
    ds_read_b128 v[92:95], v49 offset:31744
    v_mfma_f32_16x16x32_bf16 v[16:19], v[132:135], v[128:131], v[16:19]
    ds_read_b128 v[96:99], v49 offset:33792
    v_mfma_f32_16x16x32_bf16 v[20:23], v[136:139], v[124:127], v[20:23]
    ds_read_b128 v[100:103], v49 offset:35840
    v_mfma_f32_16x16x32_bf16 v[24:27], v[136:139], v[128:131], v[24:27]
    v_mfma_f32_16x16x32_bf16 v[28:31], v[140:143], v[124:127], v[28:31]
    v_mfma_f32_16x16x32_bf16 v[32:35], v[140:143], v[128:131], v[32:35]
    s_waitcnt lgkmcnt(0)
    s_barrier
    ds_read_b128 v[104:107], v48 offset:32768
    v_mfma_f32_16x16x32_bf16 v[12:15], v[72:75], v[64:67], v[12:15]
    ds_read_b128 v[108:111], v48 offset:34816
    v_mfma_f32_16x16x32_bf16 v[16:19], v[72:75], v[68:71], v[16:19]
    ds_read_b128 v[112:115], v49 offset:40960
    v_mfma_f32_16x16x32_bf16 v[20:23], v[76:79], v[64:67], v[20:23]
    ds_read_b128 v[116:119], v49 offset:43008
    v_mfma_f32_16x16x32_bf16 v[24:27], v[76:79], v[68:71], v[24:27]
    ds_read_b128 v[120:123], v49 offset:45056
    v_mfma_f32_16x16x32_bf16 v[28:31], v[80:83], v[64:67], v[28:31]
    ds_read_b128 v[124:127], v48 offset:33792
    v_mfma_f32_16x16x32_bf16 v[32:35], v[80:83], v[68:71], v[32:35]
    ds_read_b128 v[128:131], v48 offset:35840
    v_mfma_f32_16x16x32_bf16 v[12:15], v[92:95], v[84:87], v[12:15]
    ds_read_b128 v[132:135], v49 offset:41984
    v_mfma_f32_16x16x32_bf16 v[16:19], v[92:95], v[88:91], v[16:19]
    ds_read_b128 v[136:139], v49 offset:44032
    v_mfma_f32_16x16x32_bf16 v[20:23], v[96:99], v[84:87], v[20:23]
    ds_read_b128 v[140:143], v49 offset:46080
    v_mfma_f32_16x16x32_bf16 v[24:27], v[96:99], v[88:91], v[24:27]
    v_mfma_f32_16x16x32_bf16 v[28:31], v[100:103], v[84:87], v[28:31]
    v_mfma_f32_16x16x32_bf16 v[32:35], v[100:103], v[88:91], v[32:35]
    s_waitcnt lgkmcnt(0)
    s_barrier
    ds_read_b128 v[64:67], v48 offset:40960
    v_mfma_f32_16x16x32_bf16 v[12:15], v[112:115], v[104:107], v[12:15]
    ds_read_b128 v[68:71], v48 offset:43008
    v_mfma_f32_16x16x32_bf16 v[16:19], v[112:115], v[108:111], v[16:19]
    ds_read_b128 v[72:75], v49 offset:51200
    v_mfma_f32_16x16x32_bf16 v[20:23], v[116:119], v[104:107], v[20:23]
    ds_read_b128 v[76:79], v49 offset:53248
    v_mfma_f32_16x16x32_bf16 v[24:27], v[116:119], v[108:111], v[24:27]
    ds_read_b128 v[80:83], v49 offset:55296
    v_mfma_f32_16x16x32_bf16 v[28:31], v[120:123], v[104:107], v[28:31]
    ds_read_b128 v[84:87], v48 offset:41984
    v_mfma_f32_16x16x32_bf16 v[32:35], v[120:123], v[108:111], v[32:35]
    ds_read_b128 v[88:91], v48 offset:44032
    v_mfma_f32_16x16x32_bf16 v[12:15], v[132:135], v[124:127], v[12:15]
    ds_read_b128 v[92:95], v49 offset:52224
    v_mfma_f32_16x16x32_bf16 v[16:19], v[132:135], v[128:131], v[16:19]
    ds_read_b128 v[96:99], v49 offset:54272
    v_mfma_f32_16x16x32_bf16 v[20:23], v[136:139], v[124:127], v[20:23]
    ds_read_b128 v[100:103], v49 offset:56320
    v_mfma_f32_16x16x32_bf16 v[24:27], v[136:139], v[128:131], v[24:27]
    v_mfma_f32_16x16x32_bf16 v[28:31], v[140:143], v[124:127], v[28:31]
    v_mfma_f32_16x16x32_bf16 v[32:35], v[140:143], v[128:131], v[32:35]
    s_waitcnt lgkmcnt(0)
    s_barrier
    ds_read_b128 v[104:107], v48 offset:49152
    v_mfma_f32_16x16x32_bf16 v[12:15], v[72:75], v[64:67], v[12:15]
    ds_read_b128 v[108:111], v48 offset:51200
    v_mfma_f32_16x16x32_bf16 v[16:19], v[72:75], v[68:71], v[16:19]
    ds_read_b128 v[112:115], v50 offset:0
    v_mfma_f32_16x16x32_bf16 v[20:23], v[76:79], v[64:67], v[20:23]
    ds_read_b128 v[116:119], v50 offset:2048
    v_mfma_f32_16x16x32_bf16 v[24:27], v[76:79], v[68:71], v[24:27]
    ds_read_b128 v[120:123], v50 offset:4096
    v_mfma_f32_16x16x32_bf16 v[28:31], v[80:83], v[64:67], v[28:31]
    ds_read_b128 v[124:127], v48 offset:50176
    v_mfma_f32_16x16x32_bf16 v[32:35], v[80:83], v[68:71], v[32:35]
    ds_read_b128 v[128:131], v48 offset:52224
    v_mfma_f32_16x16x32_bf16 v[12:15], v[92:95], v[84:87], v[12:15]
    ds_read_b128 v[132:135], v50 offset:1024
    v_mfma_f32_16x16x32_bf16 v[16:19], v[92:95], v[88:91], v[16:19]
    ds_read_b128 v[136:139], v50 offset:3072
    v_mfma_f32_16x16x32_bf16 v[20:23], v[96:99], v[84:87], v[20:23]
    ds_read_b128 v[140:143], v50 offset:5120
    v_mfma_f32_16x16x32_bf16 v[24:27], v[96:99], v[88:91], v[24:27]
    v_mfma_f32_16x16x32_bf16 v[28:31], v[100:103], v[84:87], v[28:31]
    v_mfma_f32_16x16x32_bf16 v[32:35], v[100:103], v[88:91], v[32:35]
    s_waitcnt lgkmcnt(0)
    s_barrier
    ds_read_b128 v[64:67], v48 offset:0
    v_mfma_f32_16x16x32_bf16 v[12:15], v[112:115], v[104:107], v[12:15]
    ds_read_b128 v[68:71], v48 offset:2048
    v_mfma_f32_16x16x32_bf16 v[16:19], v[112:115], v[108:111], v[16:19]
    ds_read_b128 v[72:75], v49 offset:0
    v_mfma_f32_16x16x32_bf16 v[20:23], v[116:119], v[104:107], v[20:23]
    ds_read_b128 v[76:79], v49 offset:2048
    v_mfma_f32_16x16x32_bf16 v[24:27], v[116:119], v[108:111], v[24:27]
    ds_read_b128 v[80:83], v49 offset:4096
    v_mfma_f32_16x16x32_bf16 v[28:31], v[120:123], v[104:107], v[28:31]
    ds_read_b128 v[84:87], v48 offset:1024
    v_mfma_f32_16x16x32_bf16 v[32:35], v[120:123], v[108:111], v[32:35]
    ds_read_b128 v[88:91], v48 offset:3072
    v_mfma_f32_16x16x32_bf16 v[12:15], v[132:135], v[124:127], v[12:15]
    ds_read_b128 v[92:95], v49 offset:1024
    v_mfma_f32_16x16x32_bf16 v[16:19], v[132:135], v[128:131], v[16:19]
    ds_read_b128 v[96:99], v49 offset:3072
    v_mfma_f32_16x16x32_bf16 v[20:23], v[136:139], v[124:127], v[20:23]
    ds_read_b128 v[100:103], v49 offset:5120
    v_mfma_f32_16x16x32_bf16 v[24:27], v[136:139], v[128:131], v[24:27]
    v_mfma_f32_16x16x32_bf16 v[28:31], v[140:143], v[124:127], v[28:31]
    v_mfma_f32_16x16x32_bf16 v[32:35], v[140:143], v[128:131], v[32:35]
    s_waitcnt lgkmcnt(0)
    s_barrier
    ds_read_b128 v[104:107], v48 offset:8192
    v_mfma_f32_16x16x32_bf16 v[12:15], v[72:75], v[64:67], v[12:15]
    ds_read_b128 v[108:111], v48 offset:10240
    v_mfma_f32_16x16x32_bf16 v[16:19], v[72:75], v[68:71], v[16:19]
    ds_read_b128 v[112:115], v49 offset:10240
    v_mfma_f32_16x16x32_bf16 v[20:23], v[76:79], v[64:67], v[20:23]
    ds_read_b128 v[116:119], v49 offset:12288
    v_mfma_f32_16x16x32_bf16 v[24:27], v[76:79], v[68:71], v[24:27]
    ds_read_b128 v[120:123], v49 offset:14336
    v_mfma_f32_16x16x32_bf16 v[28:31], v[80:83], v[64:67], v[28:31]
    ds_read_b128 v[124:127], v48 offset:9216
    v_mfma_f32_16x16x32_bf16 v[32:35], v[80:83], v[68:71], v[32:35]
    ds_read_b128 v[128:131], v48 offset:11264
    v_mfma_f32_16x16x32_bf16 v[12:15], v[92:95], v[84:87], v[12:15]
    ds_read_b128 v[132:135], v49 offset:11264
    v_mfma_f32_16x16x32_bf16 v[16:19], v[92:95], v[88:91], v[16:19]
    ds_read_b128 v[136:139], v49 offset:13312
    v_mfma_f32_16x16x32_bf16 v[20:23], v[96:99], v[84:87], v[20:23]
    ds_read_b128 v[140:143], v49 offset:15360
    v_mfma_f32_16x16x32_bf16 v[24:27], v[96:99], v[88:91], v[24:27]
    v_mfma_f32_16x16x32_bf16 v[28:31], v[100:103], v[84:87], v[28:31]
    v_mfma_f32_16x16x32_bf16 v[32:35], v[100:103], v[88:91], v[32:35]
    s_waitcnt lgkmcnt(0)
    s_barrier
    ds_read_b128 v[64:67], v48 offset:16384
    v_mfma_f32_16x16x32_bf16 v[12:15], v[112:115], v[104:107], v[12:15]
    ds_read_b128 v[68:71], v48 offset:18432
    v_mfma_f32_16x16x32_bf16 v[16:19], v[112:115], v[108:111], v[16:19]
    ds_read_b128 v[72:75], v49 offset:20480
    v_mfma_f32_16x16x32_bf16 v[20:23], v[116:119], v[104:107], v[20:23]
    ds_read_b128 v[76:79], v49 offset:22528
    v_mfma_f32_16x16x32_bf16 v[24:27], v[116:119], v[108:111], v[24:27]
    ds_read_b128 v[80:83], v49 offset:24576
    v_mfma_f32_16x16x32_bf16 v[28:31], v[120:123], v[104:107], v[28:31]
    ds_read_b128 v[84:87], v48 offset:17408
    v_mfma_f32_16x16x32_bf16 v[32:35], v[120:123], v[108:111], v[32:35]
    ds_read_b128 v[88:91], v48 offset:19456
    v_mfma_f32_16x16x32_bf16 v[12:15], v[132:135], v[124:127], v[12:15]
    ds_read_b128 v[92:95], v49 offset:21504
    v_mfma_f32_16x16x32_bf16 v[16:19], v[132:135], v[128:131], v[16:19]
    ds_read_b128 v[96:99], v49 offset:23552
    v_mfma_f32_16x16x32_bf16 v[20:23], v[136:139], v[124:127], v[20:23]
    ds_read_b128 v[100:103], v49 offset:25600
    v_mfma_f32_16x16x32_bf16 v[24:27], v[136:139], v[128:131], v[24:27]
    v_mfma_f32_16x16x32_bf16 v[28:31], v[140:143], v[124:127], v[28:31]
    v_mfma_f32_16x16x32_bf16 v[32:35], v[140:143], v[128:131], v[32:35]
    s_waitcnt lgkmcnt(0)
    s_barrier
    ds_read_b128 v[104:107], v48 offset:24576
    v_mfma_f32_16x16x32_bf16 v[12:15], v[72:75], v[64:67], v[12:15]
    ds_read_b128 v[108:111], v48 offset:26624
    v_mfma_f32_16x16x32_bf16 v[16:19], v[72:75], v[68:71], v[16:19]
    ds_read_b128 v[112:115], v49 offset:30720
    v_mfma_f32_16x16x32_bf16 v[20:23], v[76:79], v[64:67], v[20:23]
    ds_read_b128 v[116:119], v49 offset:32768
    v_mfma_f32_16x16x32_bf16 v[24:27], v[76:79], v[68:71], v[24:27]
    ds_read_b128 v[120:123], v49 offset:34816
    v_mfma_f32_16x16x32_bf16 v[28:31], v[80:83], v[64:67], v[28:31]
    ds_read_b128 v[124:127], v48 offset:25600
    v_mfma_f32_16x16x32_bf16 v[32:35], v[80:83], v[68:71], v[32:35]
    ds_read_b128 v[128:131], v48 offset:27648
    v_mfma_f32_16x16x32_bf16 v[12:15], v[92:95], v[84:87], v[12:15]
    ds_read_b128 v[132:135], v49 offset:31744
    v_mfma_f32_16x16x32_bf16 v[16:19], v[92:95], v[88:91], v[16:19]
    ds_read_b128 v[136:139], v49 offset:33792
    v_mfma_f32_16x16x32_bf16 v[20:23], v[96:99], v[84:87], v[20:23]
    ds_read_b128 v[140:143], v49 offset:35840
    v_mfma_f32_16x16x32_bf16 v[24:27], v[96:99], v[88:91], v[24:27]
    v_mfma_f32_16x16x32_bf16 v[28:31], v[100:103], v[84:87], v[28:31]
    v_mfma_f32_16x16x32_bf16 v[32:35], v[100:103], v[88:91], v[32:35]
    s_waitcnt lgkmcnt(0)
    s_barrier
    ds_read_b128 v[64:67], v48 offset:32768
    v_mfma_f32_16x16x32_bf16 v[12:15], v[112:115], v[104:107], v[12:15]
    ds_read_b128 v[68:71], v48 offset:34816
    v_mfma_f32_16x16x32_bf16 v[16:19], v[112:115], v[108:111], v[16:19]
    ds_read_b128 v[72:75], v49 offset:40960
    v_mfma_f32_16x16x32_bf16 v[20:23], v[116:119], v[104:107], v[20:23]
    ds_read_b128 v[76:79], v49 offset:43008
    v_mfma_f32_16x16x32_bf16 v[24:27], v[116:119], v[108:111], v[24:27]
    ds_read_b128 v[80:83], v49 offset:45056
    v_mfma_f32_16x16x32_bf16 v[28:31], v[120:123], v[104:107], v[28:31]
    ds_read_b128 v[84:87], v48 offset:33792
    v_mfma_f32_16x16x32_bf16 v[32:35], v[120:123], v[108:111], v[32:35]
    ds_read_b128 v[88:91], v48 offset:35840
    v_mfma_f32_16x16x32_bf16 v[12:15], v[132:135], v[124:127], v[12:15]
    ds_read_b128 v[92:95], v49 offset:41984
    v_mfma_f32_16x16x32_bf16 v[16:19], v[132:135], v[128:131], v[16:19]
    ds_read_b128 v[96:99], v49 offset:44032
    v_mfma_f32_16x16x32_bf16 v[20:23], v[136:139], v[124:127], v[20:23]
    ds_read_b128 v[100:103], v49 offset:46080
    v_mfma_f32_16x16x32_bf16 v[24:27], v[136:139], v[128:131], v[24:27]
    v_mfma_f32_16x16x32_bf16 v[28:31], v[140:143], v[124:127], v[28:31]
    v_mfma_f32_16x16x32_bf16 v[32:35], v[140:143], v[128:131], v[32:35]
    s_waitcnt lgkmcnt(0)
    s_barrier
    ds_read_b128 v[104:107], v48 offset:40960
    v_mfma_f32_16x16x32_bf16 v[12:15], v[72:75], v[64:67], v[12:15]
    ds_read_b128 v[108:111], v48 offset:43008
    v_mfma_f32_16x16x32_bf16 v[16:19], v[72:75], v[68:71], v[16:19]
    ds_read_b128 v[112:115], v49 offset:51200
    v_mfma_f32_16x16x32_bf16 v[20:23], v[76:79], v[64:67], v[20:23]
    ds_read_b128 v[116:119], v49 offset:53248
    v_mfma_f32_16x16x32_bf16 v[24:27], v[76:79], v[68:71], v[24:27]
    ds_read_b128 v[120:123], v49 offset:55296
    v_mfma_f32_16x16x32_bf16 v[28:31], v[80:83], v[64:67], v[28:31]
    ds_read_b128 v[124:127], v48 offset:41984
    v_mfma_f32_16x16x32_bf16 v[32:35], v[80:83], v[68:71], v[32:35]
    ds_read_b128 v[128:131], v48 offset:44032
    v_mfma_f32_16x16x32_bf16 v[12:15], v[92:95], v[84:87], v[12:15]
    ds_read_b128 v[132:135], v49 offset:52224
    v_mfma_f32_16x16x32_bf16 v[16:19], v[92:95], v[88:91], v[16:19]
    ds_read_b128 v[136:139], v49 offset:54272
    v_mfma_f32_16x16x32_bf16 v[20:23], v[96:99], v[84:87], v[20:23]
    ds_read_b128 v[140:143], v49 offset:56320
    v_mfma_f32_16x16x32_bf16 v[24:27], v[96:99], v[88:91], v[24:27]
    v_mfma_f32_16x16x32_bf16 v[28:31], v[100:103], v[84:87], v[28:31]
    v_mfma_f32_16x16x32_bf16 v[32:35], v[100:103], v[88:91], v[32:35]
    s_waitcnt lgkmcnt(0)
    s_barrier
    ds_read_b128 v[64:67], v48 offset:49152
    v_mfma_f32_16x16x32_bf16 v[12:15], v[112:115], v[104:107], v[12:15]
    ds_read_b128 v[68:71], v48 offset:51200
    v_mfma_f32_16x16x32_bf16 v[16:19], v[112:115], v[108:111], v[16:19]
    ds_read_b128 v[72:75], v50 offset:0
    v_mfma_f32_16x16x32_bf16 v[20:23], v[116:119], v[104:107], v[20:23]
    ds_read_b128 v[76:79], v50 offset:2048
    v_mfma_f32_16x16x32_bf16 v[24:27], v[116:119], v[108:111], v[24:27]
    ds_read_b128 v[80:83], v50 offset:4096
    v_mfma_f32_16x16x32_bf16 v[28:31], v[120:123], v[104:107], v[28:31]
    ds_read_b128 v[84:87], v48 offset:50176
    v_mfma_f32_16x16x32_bf16 v[32:35], v[120:123], v[108:111], v[32:35]
    ds_read_b128 v[88:91], v48 offset:52224
    v_mfma_f32_16x16x32_bf16 v[12:15], v[132:135], v[124:127], v[12:15]
    ds_read_b128 v[92:95], v50 offset:1024
    v_mfma_f32_16x16x32_bf16 v[16:19], v[132:135], v[128:131], v[16:19]
    ds_read_b128 v[96:99], v50 offset:3072
    v_mfma_f32_16x16x32_bf16 v[20:23], v[136:139], v[124:127], v[20:23]
    ds_read_b128 v[100:103], v50 offset:5120
    v_mfma_f32_16x16x32_bf16 v[24:27], v[136:139], v[128:131], v[24:27]
    v_mfma_f32_16x16x32_bf16 v[28:31], v[140:143], v[124:127], v[28:31]
    v_mfma_f32_16x16x32_bf16 v[32:35], v[140:143], v[128:131], v[32:35]
    s_waitcnt lgkmcnt(0)
    s_barrier
    ds_read_b128 v[104:107], v48 offset:0
    v_mfma_f32_16x16x32_bf16 v[12:15], v[72:75], v[64:67], v[12:15]
    ds_read_b128 v[108:111], v48 offset:2048
    v_mfma_f32_16x16x32_bf16 v[16:19], v[72:75], v[68:71], v[16:19]
    ds_read_b128 v[112:115], v49 offset:0
    v_mfma_f32_16x16x32_bf16 v[20:23], v[76:79], v[64:67], v[20:23]
    ds_read_b128 v[116:119], v49 offset:2048
    v_mfma_f32_16x16x32_bf16 v[24:27], v[76:79], v[68:71], v[24:27]
    ds_read_b128 v[120:123], v49 offset:4096
    v_mfma_f32_16x16x32_bf16 v[28:31], v[80:83], v[64:67], v[28:31]
    ds_read_b128 v[124:127], v48 offset:1024
    v_mfma_f32_16x16x32_bf16 v[32:35], v[80:83], v[68:71], v[32:35]
    ds_read_b128 v[128:131], v48 offset:3072
    v_mfma_f32_16x16x32_bf16 v[12:15], v[92:95], v[84:87], v[12:15]
    ds_read_b128 v[132:135], v49 offset:1024
    v_mfma_f32_16x16x32_bf16 v[16:19], v[92:95], v[88:91], v[16:19]
    ds_read_b128 v[136:139], v49 offset:3072
    v_mfma_f32_16x16x32_bf16 v[20:23], v[96:99], v[84:87], v[20:23]
    ds_read_b128 v[140:143], v49 offset:5120
    v_mfma_f32_16x16x32_bf16 v[24:27], v[96:99], v[88:91], v[24:27]
    v_mfma_f32_16x16x32_bf16 v[28:31], v[100:103], v[84:87], v[28:31]
    v_mfma_f32_16x16x32_bf16 v[32:35], v[100:103], v[88:91], v[32:35]
    s_waitcnt lgkmcnt(0)
    s_barrier
    ds_read_b128 v[64:67], v48 offset:8192
    v_mfma_f32_16x16x32_bf16 v[12:15], v[112:115], v[104:107], v[12:15]
    ds_read_b128 v[68:71], v48 offset:10240
    v_mfma_f32_16x16x32_bf16 v[16:19], v[112:115], v[108:111], v[16:19]
    ds_read_b128 v[72:75], v49 offset:10240
    v_mfma_f32_16x16x32_bf16 v[20:23], v[116:119], v[104:107], v[20:23]
    ds_read_b128 v[76:79], v49 offset:12288
    v_mfma_f32_16x16x32_bf16 v[24:27], v[116:119], v[108:111], v[24:27]
    ds_read_b128 v[80:83], v49 offset:14336
    v_mfma_f32_16x16x32_bf16 v[28:31], v[120:123], v[104:107], v[28:31]
    ds_read_b128 v[84:87], v48 offset:9216
    v_mfma_f32_16x16x32_bf16 v[32:35], v[120:123], v[108:111], v[32:35]
    ds_read_b128 v[88:91], v48 offset:11264
    v_mfma_f32_16x16x32_bf16 v[12:15], v[132:135], v[124:127], v[12:15]
    ds_read_b128 v[92:95], v49 offset:11264
    v_mfma_f32_16x16x32_bf16 v[16:19], v[132:135], v[128:131], v[16:19]
    ds_read_b128 v[96:99], v49 offset:13312
    v_mfma_f32_16x16x32_bf16 v[20:23], v[136:139], v[124:127], v[20:23]
    ds_read_b128 v[100:103], v49 offset:15360
    v_mfma_f32_16x16x32_bf16 v[24:27], v[136:139], v[128:131], v[24:27]
    v_mfma_f32_16x16x32_bf16 v[28:31], v[140:143], v[124:127], v[28:31]
    v_mfma_f32_16x16x32_bf16 v[32:35], v[140:143], v[128:131], v[32:35]
    s_waitcnt lgkmcnt(0)
    s_barrier
    ds_read_b128 v[104:107], v48 offset:16384
    v_mfma_f32_16x16x32_bf16 v[12:15], v[72:75], v[64:67], v[12:15]
    ds_read_b128 v[108:111], v48 offset:18432
    v_mfma_f32_16x16x32_bf16 v[16:19], v[72:75], v[68:71], v[16:19]
    ds_read_b128 v[112:115], v49 offset:20480
    v_mfma_f32_16x16x32_bf16 v[20:23], v[76:79], v[64:67], v[20:23]
    ds_read_b128 v[116:119], v49 offset:22528
    v_mfma_f32_16x16x32_bf16 v[24:27], v[76:79], v[68:71], v[24:27]
    ds_read_b128 v[120:123], v49 offset:24576
    v_mfma_f32_16x16x32_bf16 v[28:31], v[80:83], v[64:67], v[28:31]
    ds_read_b128 v[124:127], v48 offset:17408
    v_mfma_f32_16x16x32_bf16 v[32:35], v[80:83], v[68:71], v[32:35]
    ds_read_b128 v[128:131], v48 offset:19456
    v_mfma_f32_16x16x32_bf16 v[12:15], v[92:95], v[84:87], v[12:15]
    ds_read_b128 v[132:135], v49 offset:21504
    v_mfma_f32_16x16x32_bf16 v[16:19], v[92:95], v[88:91], v[16:19]
    ds_read_b128 v[136:139], v49 offset:23552
    v_mfma_f32_16x16x32_bf16 v[20:23], v[96:99], v[84:87], v[20:23]
    ds_read_b128 v[140:143], v49 offset:25600
    v_mfma_f32_16x16x32_bf16 v[24:27], v[96:99], v[88:91], v[24:27]
    v_mfma_f32_16x16x32_bf16 v[28:31], v[100:103], v[84:87], v[28:31]
    v_mfma_f32_16x16x32_bf16 v[32:35], v[100:103], v[88:91], v[32:35]
    s_waitcnt lgkmcnt(0)
    s_barrier
    ds_read_b128 v[64:67], v48 offset:24576
    v_mfma_f32_16x16x32_bf16 v[12:15], v[112:115], v[104:107], v[12:15]
    ds_read_b128 v[68:71], v48 offset:26624
    v_mfma_f32_16x16x32_bf16 v[16:19], v[112:115], v[108:111], v[16:19]
    ds_read_b128 v[72:75], v49 offset:30720
    v_mfma_f32_16x16x32_bf16 v[20:23], v[116:119], v[104:107], v[20:23]
    ds_read_b128 v[76:79], v49 offset:32768
    v_mfma_f32_16x16x32_bf16 v[24:27], v[116:119], v[108:111], v[24:27]
    ds_read_b128 v[80:83], v49 offset:34816
    v_mfma_f32_16x16x32_bf16 v[28:31], v[120:123], v[104:107], v[28:31]
    ds_read_b128 v[84:87], v48 offset:25600
    v_mfma_f32_16x16x32_bf16 v[32:35], v[120:123], v[108:111], v[32:35]
    ds_read_b128 v[88:91], v48 offset:27648
    v_mfma_f32_16x16x32_bf16 v[12:15], v[132:135], v[124:127], v[12:15]
    ds_read_b128 v[92:95], v49 offset:31744
    v_mfma_f32_16x16x32_bf16 v[16:19], v[132:135], v[128:131], v[16:19]
    ds_read_b128 v[96:99], v49 offset:33792
    v_mfma_f32_16x16x32_bf16 v[20:23], v[136:139], v[124:127], v[20:23]
    ds_read_b128 v[100:103], v49 offset:35840
    v_mfma_f32_16x16x32_bf16 v[24:27], v[136:139], v[128:131], v[24:27]
    v_mfma_f32_16x16x32_bf16 v[28:31], v[140:143], v[124:127], v[28:31]
    v_mfma_f32_16x16x32_bf16 v[32:35], v[140:143], v[128:131], v[32:35]
    s_waitcnt lgkmcnt(0)
    s_barrier
    ds_read_b128 v[104:107], v48 offset:32768
    v_mfma_f32_16x16x32_bf16 v[12:15], v[72:75], v[64:67], v[12:15]
    ds_read_b128 v[108:111], v48 offset:34816
    v_mfma_f32_16x16x32_bf16 v[16:19], v[72:75], v[68:71], v[16:19]
    ds_read_b128 v[112:115], v49 offset:40960
    v_mfma_f32_16x16x32_bf16 v[20:23], v[76:79], v[64:67], v[20:23]
    ds_read_b128 v[116:119], v49 offset:43008
    v_mfma_f32_16x16x32_bf16 v[24:27], v[76:79], v[68:71], v[24:27]
    ds_read_b128 v[120:123], v49 offset:45056
    v_mfma_f32_16x16x32_bf16 v[28:31], v[80:83], v[64:67], v[28:31]
    ds_read_b128 v[124:127], v48 offset:33792
    v_mfma_f32_16x16x32_bf16 v[32:35], v[80:83], v[68:71], v[32:35]
    ds_read_b128 v[128:131], v48 offset:35840
    v_mfma_f32_16x16x32_bf16 v[12:15], v[92:95], v[84:87], v[12:15]
    ds_read_b128 v[132:135], v49 offset:41984
    v_mfma_f32_16x16x32_bf16 v[16:19], v[92:95], v[88:91], v[16:19]
    ds_read_b128 v[136:139], v49 offset:44032
    v_mfma_f32_16x16x32_bf16 v[20:23], v[96:99], v[84:87], v[20:23]
    ds_read_b128 v[140:143], v49 offset:46080
    v_mfma_f32_16x16x32_bf16 v[24:27], v[96:99], v[88:91], v[24:27]
    v_mfma_f32_16x16x32_bf16 v[28:31], v[100:103], v[84:87], v[28:31]
    v_mfma_f32_16x16x32_bf16 v[32:35], v[100:103], v[88:91], v[32:35]
    s_waitcnt lgkmcnt(0)
    s_barrier
    ds_read_b128 v[64:67], v48 offset:40960
    v_mfma_f32_16x16x32_bf16 v[12:15], v[112:115], v[104:107], v[12:15]
    ds_read_b128 v[68:71], v48 offset:43008
    v_mfma_f32_16x16x32_bf16 v[16:19], v[112:115], v[108:111], v[16:19]
    ds_read_b128 v[72:75], v49 offset:51200
    v_mfma_f32_16x16x32_bf16 v[20:23], v[116:119], v[104:107], v[20:23]
    ds_read_b128 v[76:79], v49 offset:53248
    v_mfma_f32_16x16x32_bf16 v[24:27], v[116:119], v[108:111], v[24:27]
    ds_read_b128 v[80:83], v49 offset:55296
    v_mfma_f32_16x16x32_bf16 v[28:31], v[120:123], v[104:107], v[28:31]
    ds_read_b128 v[84:87], v48 offset:41984
    v_mfma_f32_16x16x32_bf16 v[32:35], v[120:123], v[108:111], v[32:35]
    ds_read_b128 v[88:91], v48 offset:44032
    v_mfma_f32_16x16x32_bf16 v[12:15], v[132:135], v[124:127], v[12:15]
    ds_read_b128 v[92:95], v49 offset:52224
    v_mfma_f32_16x16x32_bf16 v[16:19], v[132:135], v[128:131], v[16:19]
    ds_read_b128 v[96:99], v49 offset:54272
    v_mfma_f32_16x16x32_bf16 v[20:23], v[136:139], v[124:127], v[20:23]
    ds_read_b128 v[100:103], v49 offset:56320
    v_mfma_f32_16x16x32_bf16 v[24:27], v[136:139], v[128:131], v[24:27]
    v_mfma_f32_16x16x32_bf16 v[28:31], v[140:143], v[124:127], v[28:31]
    v_mfma_f32_16x16x32_bf16 v[32:35], v[140:143], v[128:131], v[32:35]
    s_waitcnt lgkmcnt(0)
    v_mfma_f32_16x16x32_bf16 v[12:15], v[72:75], v[64:67], v[12:15]
    v_mfma_f32_16x16x32_bf16 v[16:19], v[72:75], v[68:71], v[16:19]
    v_mfma_f32_16x16x32_bf16 v[20:23], v[76:79], v[64:67], v[20:23]
    v_mfma_f32_16x16x32_bf16 v[24:27], v[76:79], v[68:71], v[24:27]
    v_mfma_f32_16x16x32_bf16 v[28:31], v[80:83], v[64:67], v[28:31]
    v_mfma_f32_16x16x32_bf16 v[32:35], v[80:83], v[68:71], v[32:35]
    v_mfma_f32_16x16x32_bf16 v[12:15], v[92:95], v[84:87], v[12:15]
    v_mfma_f32_16x16x32_bf16 v[16:19], v[92:95], v[88:91], v[16:19]
    v_mfma_f32_16x16x32_bf16 v[20:23], v[96:99], v[84:87], v[20:23]
    v_mfma_f32_16x16x32_bf16 v[24:27], v[96:99], v[88:91], v[24:27]
    v_mfma_f32_16x16x32_bf16 v[28:31], v[100:103], v[84:87], v[28:31]
    v_mfma_f32_16x16x32_bf16 v[32:35], v[100:103], v[88:91], v[32:35]
    s_waitcnt vmcnt(0)
    v_lshlrev_b32 v64, 16, v36
    v_and_b32 v65, 0xffff0000, v36
    v_lshlrev_b32 v66, 16, v37
    v_and_b32 v67, 0xffff0000, v37
    v_lshlrev_b32 v68, 16, v38
    v_and_b32 v69, 0xffff0000, v38
    v_lshlrev_b32 v70, 16, v39
    v_and_b32 v71, 0xffff0000, v39
    v_lshlrev_b32 v72, 16, v40
    v_and_b32 v73, 0xffff0000, v40
    v_lshlrev_b32 v74, 16, v41
    v_and_b32 v75, 0xffff0000, v41
    v_lshlrev_b32 v76, 16, v42
    v_and_b32 v77, 0xffff0000, v42
    v_lshlrev_b32 v78, 16, v43
    v_and_b32 v79, 0xffff0000, v43
    v_lshlrev_b32 v80, 16, v44
    v_and_b32 v81, 0xffff0000, v44
    v_lshlrev_b32 v82, 16, v45
    v_and_b32 v83, 0xffff0000, v45
    v_lshlrev_b32 v84, 16, v46
    v_and_b32 v85, 0xffff0000, v46
    v_lshlrev_b32 v86, 16, v47
    v_and_b32 v87, 0xffff0000, v47
    v_add_f32 v12, v12, v64
    v_add_f32 v13, v13, v65
    v_add_f32 v14, v14, v66
    v_add_f32 v15, v15, v67
    v_cvt_pk_bf16_f32 v36, v12, v13
    v_cvt_pk_bf16_f32 v37, v14, v15
    buffer_store_dwordx2 v[36:37], v5, s[24:27], s46 offen offset:0
    v_add_f32 v16, v16, v68
    v_add_f32 v17, v17, v69
    v_add_f32 v18, v18, v70
    v_add_f32 v19, v19, v71
    v_cvt_pk_bf16_f32 v38, v16, v17
    v_cvt_pk_bf16_f32 v39, v18, v19
    buffer_store_dwordx2 v[38:39], v5, s[24:27], s47 offen offset:0
    v_add_f32 v20, v20, v72
    v_add_f32 v21, v21, v73
    v_add_f32 v22, v22, v74
    v_add_f32 v23, v23, v75
    v_cvt_pk_bf16_f32 v40, v20, v21
    v_cvt_pk_bf16_f32 v41, v22, v23
    buffer_store_dwordx2 v[40:41], v5, s[24:27], s46 offen offset:32
    v_add_f32 v24, v24, v76
    v_add_f32 v25, v25, v77
    v_add_f32 v26, v26, v78
    v_add_f32 v27, v27, v79
    v_cvt_pk_bf16_f32 v42, v24, v25
    v_cvt_pk_bf16_f32 v43, v26, v27
    buffer_store_dwordx2 v[42:43], v5, s[24:27], s47 offen offset:32
    v_add_f32 v28, v28, v80
    v_add_f32 v29, v29, v81
    v_add_f32 v30, v30, v82
    v_add_f32 v31, v31, v83
    v_cvt_pk_bf16_f32 v44, v28, v29
    v_cvt_pk_bf16_f32 v45, v30, v31
    buffer_store_dwordx2 v[44:45], v5, s[24:27], s46 offen offset:64
    v_add_f32 v32, v32, v84
    v_add_f32 v33, v33, v85
    v_add_f32 v34, v34, v86
    v_add_f32 v35, v35, v87
    v_cvt_pk_bf16_f32 v46, v32, v33
    v_cvt_pk_bf16_f32 v47, v34, v35
    buffer_store_dwordx2 v[46:47], v5, s[24:27], s47 offen offset:64
    s_endpgm
sequential_preLN__grouped_kv_mqa__dense_activation_silu__prompt_kernel_c5b:
    s_add_u32 s40, s43, 3
    s_lshl_b32 s40, s40, 9
    s_mul_i32 s41, s45, 20480
    s_add_u32 s40, s40, s41
    s_add_u32 s52, s40, 6291456
    s_add_u32 s55, s52, 20480

    s_add_u32 s40, s43, 4
    s_lshl_b32 s40, s40, 9
    s_mul_i32 s41, s45, 20480
    s_add_u32 s40, s40, s41
    s_add_u32 s53, s40, 6291456
    s_add_u32 s56, s53, 20480

    buffer_load_dwordx2 v[36:37], v8, s[16:19], s52 offen sc1
    buffer_load_dwordx2 v[40:41], v8, s[16:19], s53 offen sc1
    buffer_load_dwordx2 v[38:39], v8, s[16:19], s55 offen sc1
    buffer_load_dwordx2 v[42:43], v8, s[16:19], s56 offen sc1
    s_barrier
    ds_read_b128 v[64:67], v48 offset:0
    ds_read_b128 v[68:71], v48 offset:2048
    ds_read_b128 v[72:75], v49 offset:6144
    ds_read_b128 v[76:79], v49 offset:8192
    ds_read_b128 v[84:87], v48 offset:1024
    ds_read_b128 v[88:91], v48 offset:3072
    ds_read_b128 v[92:95], v49 offset:7168
    ds_read_b128 v[96:99], v49 offset:9216
    s_waitcnt lgkmcnt(0)
    s_barrier
    ds_read_b128 v[104:107], v48 offset:8192
    v_mfma_f32_16x16x32_bf16 v[12:15], v[72:75], v[64:67], 0
    ds_read_b128 v[108:111], v48 offset:10240
    v_mfma_f32_16x16x32_bf16 v[16:19], v[72:75], v[68:71], 0
    ds_read_b128 v[112:115], v49 offset:16384
    v_mfma_f32_16x16x32_bf16 v[20:23], v[76:79], v[64:67], 0
    ds_read_b128 v[116:119], v49 offset:18432
    v_mfma_f32_16x16x32_bf16 v[24:27], v[76:79], v[68:71], 0
    ds_read_b128 v[124:127], v48 offset:9216
    v_mfma_f32_16x16x32_bf16 v[12:15], v[92:95], v[84:87], v[12:15]
    ds_read_b128 v[128:131], v48 offset:11264
    v_mfma_f32_16x16x32_bf16 v[16:19], v[92:95], v[88:91], v[16:19]
    ds_read_b128 v[132:135], v49 offset:17408
    v_mfma_f32_16x16x32_bf16 v[20:23], v[96:99], v[84:87], v[20:23]
    ds_read_b128 v[136:139], v49 offset:19456
    v_mfma_f32_16x16x32_bf16 v[24:27], v[96:99], v[88:91], v[24:27]
    s_waitcnt lgkmcnt(0)
    s_barrier
    ds_read_b128 v[64:67], v48 offset:16384
    v_mfma_f32_16x16x32_bf16 v[12:15], v[112:115], v[104:107], v[12:15]
    ds_read_b128 v[68:71], v48 offset:18432
    v_mfma_f32_16x16x32_bf16 v[16:19], v[112:115], v[108:111], v[16:19]
    ds_read_b128 v[72:75], v49 offset:26624
    v_mfma_f32_16x16x32_bf16 v[20:23], v[116:119], v[104:107], v[20:23]
    ds_read_b128 v[76:79], v49 offset:28672
    v_mfma_f32_16x16x32_bf16 v[24:27], v[116:119], v[108:111], v[24:27]
    ds_read_b128 v[84:87], v48 offset:17408
    v_mfma_f32_16x16x32_bf16 v[12:15], v[132:135], v[124:127], v[12:15]
    ds_read_b128 v[88:91], v48 offset:19456
    v_mfma_f32_16x16x32_bf16 v[16:19], v[132:135], v[128:131], v[16:19]
    ds_read_b128 v[92:95], v49 offset:27648
    v_mfma_f32_16x16x32_bf16 v[20:23], v[136:139], v[124:127], v[20:23]
    ds_read_b128 v[96:99], v49 offset:29696
    v_mfma_f32_16x16x32_bf16 v[24:27], v[136:139], v[128:131], v[24:27]
    s_waitcnt lgkmcnt(0)
    s_barrier
    ds_read_b128 v[104:107], v48 offset:24576
    v_mfma_f32_16x16x32_bf16 v[12:15], v[72:75], v[64:67], v[12:15]
    ds_read_b128 v[108:111], v48 offset:26624
    v_mfma_f32_16x16x32_bf16 v[16:19], v[72:75], v[68:71], v[16:19]
    ds_read_b128 v[112:115], v49 offset:36864
    v_mfma_f32_16x16x32_bf16 v[20:23], v[76:79], v[64:67], v[20:23]
    ds_read_b128 v[116:119], v49 offset:38912
    v_mfma_f32_16x16x32_bf16 v[24:27], v[76:79], v[68:71], v[24:27]
    ds_read_b128 v[124:127], v48 offset:25600
    v_mfma_f32_16x16x32_bf16 v[12:15], v[92:95], v[84:87], v[12:15]
    ds_read_b128 v[128:131], v48 offset:27648
    v_mfma_f32_16x16x32_bf16 v[16:19], v[92:95], v[88:91], v[16:19]
    ds_read_b128 v[132:135], v49 offset:37888
    v_mfma_f32_16x16x32_bf16 v[20:23], v[96:99], v[84:87], v[20:23]
    ds_read_b128 v[136:139], v49 offset:39936
    v_mfma_f32_16x16x32_bf16 v[24:27], v[96:99], v[88:91], v[24:27]
    s_add_u32 s42, s14, 8192
    v_mov_b32 v250, 163832
    v_mov_b32 v251, 1
    s_waitcnt vmcnt(0)
    s_mov_b64 exec, 1
    ds_add_rtn_u32 v252, v250, v251
    v_mov_b32 v250, 0
    s_waitcnt lgkmcnt(0)
    v_readfirstlane_b32 s72, v252
    s_cmp_eq_u32 s72, 3
    s_cbranch_scc0 sequential_preLN__grouped_kv_mqa__dense_activation_silu__prompt_kernel_pub16
    buffer_atomic_add v251, v250, s[16:19], s42 offen sc1

sequential_preLN__grouped_kv_mqa__dense_activation_silu__prompt_kernel_pub16:
    s_mov_b64 exec, -1
    s_waitcnt lgkmcnt(0)
    s_barrier
    ds_read_b128 v[64:67], v48 offset:32768
    v_mfma_f32_16x16x32_bf16 v[12:15], v[112:115], v[104:107], v[12:15]
    ds_read_b128 v[68:71], v48 offset:34816
    v_mfma_f32_16x16x32_bf16 v[16:19], v[112:115], v[108:111], v[16:19]
    ds_read_b128 v[72:75], v49 offset:47104
    v_mfma_f32_16x16x32_bf16 v[20:23], v[116:119], v[104:107], v[20:23]
    ds_read_b128 v[76:79], v49 offset:49152
    v_mfma_f32_16x16x32_bf16 v[24:27], v[116:119], v[108:111], v[24:27]
    ds_read_b128 v[84:87], v48 offset:33792
    v_mfma_f32_16x16x32_bf16 v[12:15], v[132:135], v[124:127], v[12:15]
    ds_read_b128 v[88:91], v48 offset:35840
    v_mfma_f32_16x16x32_bf16 v[16:19], v[132:135], v[128:131], v[16:19]
    ds_read_b128 v[92:95], v49 offset:48128
    v_mfma_f32_16x16x32_bf16 v[20:23], v[136:139], v[124:127], v[20:23]
    ds_read_b128 v[96:99], v49 offset:50176
    v_mfma_f32_16x16x32_bf16 v[24:27], v[136:139], v[128:131], v[24:27]
    s_waitcnt lgkmcnt(0)
    s_barrier
    ds_read_b128 v[104:107], v48 offset:40960
    v_mfma_f32_16x16x32_bf16 v[12:15], v[72:75], v[64:67], v[12:15]
    ds_read_b128 v[108:111], v48 offset:43008
    v_mfma_f32_16x16x32_bf16 v[16:19], v[72:75], v[68:71], v[16:19]
    ds_read_b128 v[112:115], v49 offset:57344
    v_mfma_f32_16x16x32_bf16 v[20:23], v[76:79], v[64:67], v[20:23]
    ds_read_b128 v[116:119], v49 offset:59392
    v_mfma_f32_16x16x32_bf16 v[24:27], v[76:79], v[68:71], v[24:27]
    ds_read_b128 v[124:127], v48 offset:41984
    v_mfma_f32_16x16x32_bf16 v[12:15], v[92:95], v[84:87], v[12:15]
    ds_read_b128 v[128:131], v48 offset:44032
    v_mfma_f32_16x16x32_bf16 v[16:19], v[92:95], v[88:91], v[16:19]
    ds_read_b128 v[132:135], v49 offset:58368
    v_mfma_f32_16x16x32_bf16 v[20:23], v[96:99], v[84:87], v[20:23]
    ds_read_b128 v[136:139], v49 offset:60416
    v_mfma_f32_16x16x32_bf16 v[24:27], v[96:99], v[88:91], v[24:27]
    s_waitcnt lgkmcnt(0)
    s_barrier
    ds_read_b128 v[64:67], v48 offset:49152
    v_mfma_f32_16x16x32_bf16 v[12:15], v[112:115], v[104:107], v[12:15]
    ds_read_b128 v[68:71], v48 offset:51200
    v_mfma_f32_16x16x32_bf16 v[16:19], v[112:115], v[108:111], v[16:19]
    ds_read_b128 v[72:75], v50 offset:6144
    v_mfma_f32_16x16x32_bf16 v[20:23], v[116:119], v[104:107], v[20:23]
    ds_read_b128 v[76:79], v50 offset:8192
    v_mfma_f32_16x16x32_bf16 v[24:27], v[116:119], v[108:111], v[24:27]
    ds_read_b128 v[84:87], v48 offset:50176
    v_mfma_f32_16x16x32_bf16 v[12:15], v[132:135], v[124:127], v[12:15]
    ds_read_b128 v[88:91], v48 offset:52224
    v_mfma_f32_16x16x32_bf16 v[16:19], v[132:135], v[128:131], v[16:19]
    ds_read_b128 v[92:95], v50 offset:7168
    v_mfma_f32_16x16x32_bf16 v[20:23], v[136:139], v[124:127], v[20:23]
    ds_read_b128 v[96:99], v50 offset:9216
    v_mfma_f32_16x16x32_bf16 v[24:27], v[136:139], v[128:131], v[24:27]
    s_waitcnt lgkmcnt(0)
    s_barrier
    ds_read_b128 v[104:107], v48 offset:0
    v_mfma_f32_16x16x32_bf16 v[12:15], v[72:75], v[64:67], v[12:15]
    ds_read_b128 v[108:111], v48 offset:2048
    v_mfma_f32_16x16x32_bf16 v[16:19], v[72:75], v[68:71], v[16:19]
    ds_read_b128 v[112:115], v49 offset:6144
    v_mfma_f32_16x16x32_bf16 v[20:23], v[76:79], v[64:67], v[20:23]
    ds_read_b128 v[116:119], v49 offset:8192
    v_mfma_f32_16x16x32_bf16 v[24:27], v[76:79], v[68:71], v[24:27]
    ds_read_b128 v[124:127], v48 offset:1024
    v_mfma_f32_16x16x32_bf16 v[12:15], v[92:95], v[84:87], v[12:15]
    ds_read_b128 v[128:131], v48 offset:3072
    v_mfma_f32_16x16x32_bf16 v[16:19], v[92:95], v[88:91], v[16:19]
    ds_read_b128 v[132:135], v49 offset:7168
    v_mfma_f32_16x16x32_bf16 v[20:23], v[96:99], v[84:87], v[20:23]
    ds_read_b128 v[136:139], v49 offset:9216
    v_mfma_f32_16x16x32_bf16 v[24:27], v[96:99], v[88:91], v[24:27]
    s_waitcnt lgkmcnt(0)
    s_barrier
    ds_read_b128 v[64:67], v48 offset:8192
    v_mfma_f32_16x16x32_bf16 v[12:15], v[112:115], v[104:107], v[12:15]
    ds_read_b128 v[68:71], v48 offset:10240
    v_mfma_f32_16x16x32_bf16 v[16:19], v[112:115], v[108:111], v[16:19]
    ds_read_b128 v[72:75], v49 offset:16384
    v_mfma_f32_16x16x32_bf16 v[20:23], v[116:119], v[104:107], v[20:23]
    ds_read_b128 v[76:79], v49 offset:18432
    v_mfma_f32_16x16x32_bf16 v[24:27], v[116:119], v[108:111], v[24:27]
    ds_read_b128 v[84:87], v48 offset:9216
    v_mfma_f32_16x16x32_bf16 v[12:15], v[132:135], v[124:127], v[12:15]
    ds_read_b128 v[88:91], v48 offset:11264
    v_mfma_f32_16x16x32_bf16 v[16:19], v[132:135], v[128:131], v[16:19]
    ds_read_b128 v[92:95], v49 offset:17408
    v_mfma_f32_16x16x32_bf16 v[20:23], v[136:139], v[124:127], v[20:23]
    ds_read_b128 v[96:99], v49 offset:19456
    v_mfma_f32_16x16x32_bf16 v[24:27], v[136:139], v[128:131], v[24:27]
    s_waitcnt lgkmcnt(0)
    s_barrier
    ds_read_b128 v[104:107], v48 offset:16384
    v_mfma_f32_16x16x32_bf16 v[12:15], v[72:75], v[64:67], v[12:15]
    ds_read_b128 v[108:111], v48 offset:18432
    v_mfma_f32_16x16x32_bf16 v[16:19], v[72:75], v[68:71], v[16:19]
    ds_read_b128 v[112:115], v49 offset:26624
    v_mfma_f32_16x16x32_bf16 v[20:23], v[76:79], v[64:67], v[20:23]
    ds_read_b128 v[116:119], v49 offset:28672
    v_mfma_f32_16x16x32_bf16 v[24:27], v[76:79], v[68:71], v[24:27]
    ds_read_b128 v[124:127], v48 offset:17408
    v_mfma_f32_16x16x32_bf16 v[12:15], v[92:95], v[84:87], v[12:15]
    ds_read_b128 v[128:131], v48 offset:19456
    v_mfma_f32_16x16x32_bf16 v[16:19], v[92:95], v[88:91], v[16:19]
    ds_read_b128 v[132:135], v49 offset:27648
    v_mfma_f32_16x16x32_bf16 v[20:23], v[96:99], v[84:87], v[20:23]
    ds_read_b128 v[136:139], v49 offset:29696
    v_mfma_f32_16x16x32_bf16 v[24:27], v[96:99], v[88:91], v[24:27]
    s_waitcnt lgkmcnt(0)
    s_barrier
    ds_read_b128 v[64:67], v48 offset:24576
    v_mfma_f32_16x16x32_bf16 v[12:15], v[112:115], v[104:107], v[12:15]
    ds_read_b128 v[68:71], v48 offset:26624
    v_mfma_f32_16x16x32_bf16 v[16:19], v[112:115], v[108:111], v[16:19]
    ds_read_b128 v[72:75], v49 offset:36864
    v_mfma_f32_16x16x32_bf16 v[20:23], v[116:119], v[104:107], v[20:23]
    ds_read_b128 v[76:79], v49 offset:38912
    v_mfma_f32_16x16x32_bf16 v[24:27], v[116:119], v[108:111], v[24:27]
    ds_read_b128 v[84:87], v48 offset:25600
    v_mfma_f32_16x16x32_bf16 v[12:15], v[132:135], v[124:127], v[12:15]
    ds_read_b128 v[88:91], v48 offset:27648
    v_mfma_f32_16x16x32_bf16 v[16:19], v[132:135], v[128:131], v[16:19]
    ds_read_b128 v[92:95], v49 offset:37888
    v_mfma_f32_16x16x32_bf16 v[20:23], v[136:139], v[124:127], v[20:23]
    ds_read_b128 v[96:99], v49 offset:39936
    v_mfma_f32_16x16x32_bf16 v[24:27], v[136:139], v[128:131], v[24:27]
    s_waitcnt lgkmcnt(0)
    s_barrier
    ds_read_b128 v[104:107], v48 offset:32768
    v_mfma_f32_16x16x32_bf16 v[12:15], v[72:75], v[64:67], v[12:15]
    ds_read_b128 v[108:111], v48 offset:34816
    v_mfma_f32_16x16x32_bf16 v[16:19], v[72:75], v[68:71], v[16:19]
    ds_read_b128 v[112:115], v49 offset:47104
    v_mfma_f32_16x16x32_bf16 v[20:23], v[76:79], v[64:67], v[20:23]
    ds_read_b128 v[116:119], v49 offset:49152
    v_mfma_f32_16x16x32_bf16 v[24:27], v[76:79], v[68:71], v[24:27]
    ds_read_b128 v[124:127], v48 offset:33792
    v_mfma_f32_16x16x32_bf16 v[12:15], v[92:95], v[84:87], v[12:15]
    ds_read_b128 v[128:131], v48 offset:35840
    v_mfma_f32_16x16x32_bf16 v[16:19], v[92:95], v[88:91], v[16:19]
    ds_read_b128 v[132:135], v49 offset:48128
    v_mfma_f32_16x16x32_bf16 v[20:23], v[96:99], v[84:87], v[20:23]
    ds_read_b128 v[136:139], v49 offset:50176
    v_mfma_f32_16x16x32_bf16 v[24:27], v[96:99], v[88:91], v[24:27]
    s_waitcnt lgkmcnt(0)
    s_barrier
    ds_read_b128 v[64:67], v48 offset:40960
    v_mfma_f32_16x16x32_bf16 v[12:15], v[112:115], v[104:107], v[12:15]
    ds_read_b128 v[68:71], v48 offset:43008
    v_mfma_f32_16x16x32_bf16 v[16:19], v[112:115], v[108:111], v[16:19]
    ds_read_b128 v[72:75], v49 offset:57344
    v_mfma_f32_16x16x32_bf16 v[20:23], v[116:119], v[104:107], v[20:23]
    ds_read_b128 v[76:79], v49 offset:59392
    v_mfma_f32_16x16x32_bf16 v[24:27], v[116:119], v[108:111], v[24:27]
    ds_read_b128 v[84:87], v48 offset:41984
    v_mfma_f32_16x16x32_bf16 v[12:15], v[132:135], v[124:127], v[12:15]
    ds_read_b128 v[88:91], v48 offset:44032
    v_mfma_f32_16x16x32_bf16 v[16:19], v[132:135], v[128:131], v[16:19]
    ds_read_b128 v[92:95], v49 offset:58368
    v_mfma_f32_16x16x32_bf16 v[20:23], v[136:139], v[124:127], v[20:23]
    ds_read_b128 v[96:99], v49 offset:60416
    v_mfma_f32_16x16x32_bf16 v[24:27], v[136:139], v[128:131], v[24:27]
    s_waitcnt lgkmcnt(0)
    s_barrier
    ds_read_b128 v[104:107], v48 offset:49152
    v_mfma_f32_16x16x32_bf16 v[12:15], v[72:75], v[64:67], v[12:15]
    ds_read_b128 v[108:111], v48 offset:51200
    v_mfma_f32_16x16x32_bf16 v[16:19], v[72:75], v[68:71], v[16:19]
    ds_read_b128 v[112:115], v50 offset:6144
    v_mfma_f32_16x16x32_bf16 v[20:23], v[76:79], v[64:67], v[20:23]
    ds_read_b128 v[116:119], v50 offset:8192
    v_mfma_f32_16x16x32_bf16 v[24:27], v[76:79], v[68:71], v[24:27]
    ds_read_b128 v[124:127], v48 offset:50176
    v_mfma_f32_16x16x32_bf16 v[12:15], v[92:95], v[84:87], v[12:15]
    ds_read_b128 v[128:131], v48 offset:52224
    v_mfma_f32_16x16x32_bf16 v[16:19], v[92:95], v[88:91], v[16:19]
    ds_read_b128 v[132:135], v50 offset:7168
    v_mfma_f32_16x16x32_bf16 v[20:23], v[96:99], v[84:87], v[20:23]
    ds_read_b128 v[136:139], v50 offset:9216
    v_mfma_f32_16x16x32_bf16 v[24:27], v[96:99], v[88:91], v[24:27]
    s_waitcnt lgkmcnt(0)
    s_barrier
    ds_read_b128 v[64:67], v48 offset:0
    v_mfma_f32_16x16x32_bf16 v[12:15], v[112:115], v[104:107], v[12:15]
    ds_read_b128 v[68:71], v48 offset:2048
    v_mfma_f32_16x16x32_bf16 v[16:19], v[112:115], v[108:111], v[16:19]
    ds_read_b128 v[72:75], v49 offset:6144
    v_mfma_f32_16x16x32_bf16 v[20:23], v[116:119], v[104:107], v[20:23]
    ds_read_b128 v[76:79], v49 offset:8192
    v_mfma_f32_16x16x32_bf16 v[24:27], v[116:119], v[108:111], v[24:27]
    ds_read_b128 v[84:87], v48 offset:1024
    v_mfma_f32_16x16x32_bf16 v[12:15], v[132:135], v[124:127], v[12:15]
    ds_read_b128 v[88:91], v48 offset:3072
    v_mfma_f32_16x16x32_bf16 v[16:19], v[132:135], v[128:131], v[16:19]
    ds_read_b128 v[92:95], v49 offset:7168
    v_mfma_f32_16x16x32_bf16 v[20:23], v[136:139], v[124:127], v[20:23]
    ds_read_b128 v[96:99], v49 offset:9216
    v_mfma_f32_16x16x32_bf16 v[24:27], v[136:139], v[128:131], v[24:27]
    s_waitcnt lgkmcnt(0)
    s_barrier
    ds_read_b128 v[104:107], v48 offset:8192
    v_mfma_f32_16x16x32_bf16 v[12:15], v[72:75], v[64:67], v[12:15]
    ds_read_b128 v[108:111], v48 offset:10240
    v_mfma_f32_16x16x32_bf16 v[16:19], v[72:75], v[68:71], v[16:19]
    ds_read_b128 v[112:115], v49 offset:16384
    v_mfma_f32_16x16x32_bf16 v[20:23], v[76:79], v[64:67], v[20:23]
    ds_read_b128 v[116:119], v49 offset:18432
    v_mfma_f32_16x16x32_bf16 v[24:27], v[76:79], v[68:71], v[24:27]
    ds_read_b128 v[124:127], v48 offset:9216
    v_mfma_f32_16x16x32_bf16 v[12:15], v[92:95], v[84:87], v[12:15]
    ds_read_b128 v[128:131], v48 offset:11264
    v_mfma_f32_16x16x32_bf16 v[16:19], v[92:95], v[88:91], v[16:19]
    ds_read_b128 v[132:135], v49 offset:17408
    v_mfma_f32_16x16x32_bf16 v[20:23], v[96:99], v[84:87], v[20:23]
    ds_read_b128 v[136:139], v49 offset:19456
    v_mfma_f32_16x16x32_bf16 v[24:27], v[96:99], v[88:91], v[24:27]
    s_waitcnt lgkmcnt(0)
    s_barrier
    ds_read_b128 v[64:67], v48 offset:16384
    v_mfma_f32_16x16x32_bf16 v[12:15], v[112:115], v[104:107], v[12:15]
    ds_read_b128 v[68:71], v48 offset:18432
    v_mfma_f32_16x16x32_bf16 v[16:19], v[112:115], v[108:111], v[16:19]
    ds_read_b128 v[72:75], v49 offset:26624
    v_mfma_f32_16x16x32_bf16 v[20:23], v[116:119], v[104:107], v[20:23]
    ds_read_b128 v[76:79], v49 offset:28672
    v_mfma_f32_16x16x32_bf16 v[24:27], v[116:119], v[108:111], v[24:27]
    ds_read_b128 v[84:87], v48 offset:17408
    v_mfma_f32_16x16x32_bf16 v[12:15], v[132:135], v[124:127], v[12:15]
    ds_read_b128 v[88:91], v48 offset:19456
    v_mfma_f32_16x16x32_bf16 v[16:19], v[132:135], v[128:131], v[16:19]
    ds_read_b128 v[92:95], v49 offset:27648
    v_mfma_f32_16x16x32_bf16 v[20:23], v[136:139], v[124:127], v[20:23]
    ds_read_b128 v[96:99], v49 offset:29696
    v_mfma_f32_16x16x32_bf16 v[24:27], v[136:139], v[128:131], v[24:27]
    s_waitcnt lgkmcnt(0)
    s_barrier
    ds_read_b128 v[104:107], v48 offset:24576
    v_mfma_f32_16x16x32_bf16 v[12:15], v[72:75], v[64:67], v[12:15]
    ds_read_b128 v[108:111], v48 offset:26624
    v_mfma_f32_16x16x32_bf16 v[16:19], v[72:75], v[68:71], v[16:19]
    ds_read_b128 v[112:115], v49 offset:36864
    v_mfma_f32_16x16x32_bf16 v[20:23], v[76:79], v[64:67], v[20:23]
    ds_read_b128 v[116:119], v49 offset:38912
    v_mfma_f32_16x16x32_bf16 v[24:27], v[76:79], v[68:71], v[24:27]
    ds_read_b128 v[124:127], v48 offset:25600
    v_mfma_f32_16x16x32_bf16 v[12:15], v[92:95], v[84:87], v[12:15]
    ds_read_b128 v[128:131], v48 offset:27648
    v_mfma_f32_16x16x32_bf16 v[16:19], v[92:95], v[88:91], v[16:19]
    ds_read_b128 v[132:135], v49 offset:37888
    v_mfma_f32_16x16x32_bf16 v[20:23], v[96:99], v[84:87], v[20:23]
    ds_read_b128 v[136:139], v49 offset:39936
    v_mfma_f32_16x16x32_bf16 v[24:27], v[96:99], v[88:91], v[24:27]
    s_waitcnt lgkmcnt(0)
    s_barrier
    ds_read_b128 v[64:67], v48 offset:32768
    v_mfma_f32_16x16x32_bf16 v[12:15], v[112:115], v[104:107], v[12:15]
    ds_read_b128 v[68:71], v48 offset:34816
    v_mfma_f32_16x16x32_bf16 v[16:19], v[112:115], v[108:111], v[16:19]
    ds_read_b128 v[72:75], v49 offset:47104
    v_mfma_f32_16x16x32_bf16 v[20:23], v[116:119], v[104:107], v[20:23]
    ds_read_b128 v[76:79], v49 offset:49152
    v_mfma_f32_16x16x32_bf16 v[24:27], v[116:119], v[108:111], v[24:27]
    ds_read_b128 v[84:87], v48 offset:33792
    v_mfma_f32_16x16x32_bf16 v[12:15], v[132:135], v[124:127], v[12:15]
    ds_read_b128 v[88:91], v48 offset:35840
    v_mfma_f32_16x16x32_bf16 v[16:19], v[132:135], v[128:131], v[16:19]
    ds_read_b128 v[92:95], v49 offset:48128
    v_mfma_f32_16x16x32_bf16 v[20:23], v[136:139], v[124:127], v[20:23]
    ds_read_b128 v[96:99], v49 offset:50176
    v_mfma_f32_16x16x32_bf16 v[24:27], v[136:139], v[128:131], v[24:27]
    s_waitcnt lgkmcnt(0)
    s_barrier
    ds_read_b128 v[104:107], v48 offset:40960
    v_mfma_f32_16x16x32_bf16 v[12:15], v[72:75], v[64:67], v[12:15]
    ds_read_b128 v[108:111], v48 offset:43008
    v_mfma_f32_16x16x32_bf16 v[16:19], v[72:75], v[68:71], v[16:19]
    ds_read_b128 v[112:115], v49 offset:57344
    v_mfma_f32_16x16x32_bf16 v[20:23], v[76:79], v[64:67], v[20:23]
    ds_read_b128 v[116:119], v49 offset:59392
    v_mfma_f32_16x16x32_bf16 v[24:27], v[76:79], v[68:71], v[24:27]
    ds_read_b128 v[124:127], v48 offset:41984
    v_mfma_f32_16x16x32_bf16 v[12:15], v[92:95], v[84:87], v[12:15]
    ds_read_b128 v[128:131], v48 offset:44032
    v_mfma_f32_16x16x32_bf16 v[16:19], v[92:95], v[88:91], v[16:19]
    ds_read_b128 v[132:135], v49 offset:58368
    v_mfma_f32_16x16x32_bf16 v[20:23], v[96:99], v[84:87], v[20:23]
    ds_read_b128 v[136:139], v49 offset:60416
    v_mfma_f32_16x16x32_bf16 v[24:27], v[96:99], v[88:91], v[24:27]
    s_waitcnt lgkmcnt(0)
    s_barrier
    ds_read_b128 v[64:67], v48 offset:49152
    v_mfma_f32_16x16x32_bf16 v[12:15], v[112:115], v[104:107], v[12:15]
    ds_read_b128 v[68:71], v48 offset:51200
    v_mfma_f32_16x16x32_bf16 v[16:19], v[112:115], v[108:111], v[16:19]
    ds_read_b128 v[72:75], v50 offset:6144
    v_mfma_f32_16x16x32_bf16 v[20:23], v[116:119], v[104:107], v[20:23]
    ds_read_b128 v[76:79], v50 offset:8192
    v_mfma_f32_16x16x32_bf16 v[24:27], v[116:119], v[108:111], v[24:27]
    ds_read_b128 v[84:87], v48 offset:50176
    v_mfma_f32_16x16x32_bf16 v[12:15], v[132:135], v[124:127], v[12:15]
    ds_read_b128 v[88:91], v48 offset:52224
    v_mfma_f32_16x16x32_bf16 v[16:19], v[132:135], v[128:131], v[16:19]
    ds_read_b128 v[92:95], v50 offset:7168
    v_mfma_f32_16x16x32_bf16 v[20:23], v[136:139], v[124:127], v[20:23]
    ds_read_b128 v[96:99], v50 offset:9216
    v_mfma_f32_16x16x32_bf16 v[24:27], v[136:139], v[128:131], v[24:27]
    s_waitcnt lgkmcnt(0)
    s_barrier
    ds_read_b128 v[104:107], v48 offset:0
    v_mfma_f32_16x16x32_bf16 v[12:15], v[72:75], v[64:67], v[12:15]
    ds_read_b128 v[108:111], v48 offset:2048
    v_mfma_f32_16x16x32_bf16 v[16:19], v[72:75], v[68:71], v[16:19]
    ds_read_b128 v[112:115], v49 offset:6144
    v_mfma_f32_16x16x32_bf16 v[20:23], v[76:79], v[64:67], v[20:23]
    ds_read_b128 v[116:119], v49 offset:8192
    v_mfma_f32_16x16x32_bf16 v[24:27], v[76:79], v[68:71], v[24:27]
    ds_read_b128 v[124:127], v48 offset:1024
    v_mfma_f32_16x16x32_bf16 v[12:15], v[92:95], v[84:87], v[12:15]
    ds_read_b128 v[128:131], v48 offset:3072
    v_mfma_f32_16x16x32_bf16 v[16:19], v[92:95], v[88:91], v[16:19]
    ds_read_b128 v[132:135], v49 offset:7168
    v_mfma_f32_16x16x32_bf16 v[20:23], v[96:99], v[84:87], v[20:23]
    ds_read_b128 v[136:139], v49 offset:9216
    v_mfma_f32_16x16x32_bf16 v[24:27], v[96:99], v[88:91], v[24:27]
    s_waitcnt lgkmcnt(0)
    s_barrier
    ds_read_b128 v[64:67], v48 offset:8192
    v_mfma_f32_16x16x32_bf16 v[12:15], v[112:115], v[104:107], v[12:15]
    ds_read_b128 v[68:71], v48 offset:10240
    v_mfma_f32_16x16x32_bf16 v[16:19], v[112:115], v[108:111], v[16:19]
    ds_read_b128 v[72:75], v49 offset:16384
    v_mfma_f32_16x16x32_bf16 v[20:23], v[116:119], v[104:107], v[20:23]
    ds_read_b128 v[76:79], v49 offset:18432
    v_mfma_f32_16x16x32_bf16 v[24:27], v[116:119], v[108:111], v[24:27]
    ds_read_b128 v[84:87], v48 offset:9216
    v_mfma_f32_16x16x32_bf16 v[12:15], v[132:135], v[124:127], v[12:15]
    ds_read_b128 v[88:91], v48 offset:11264
    v_mfma_f32_16x16x32_bf16 v[16:19], v[132:135], v[128:131], v[16:19]
    ds_read_b128 v[92:95], v49 offset:17408
    v_mfma_f32_16x16x32_bf16 v[20:23], v[136:139], v[124:127], v[20:23]
    ds_read_b128 v[96:99], v49 offset:19456
    v_mfma_f32_16x16x32_bf16 v[24:27], v[136:139], v[128:131], v[24:27]
    s_waitcnt lgkmcnt(0)
    s_barrier
    ds_read_b128 v[104:107], v48 offset:16384
    v_mfma_f32_16x16x32_bf16 v[12:15], v[72:75], v[64:67], v[12:15]
    ds_read_b128 v[108:111], v48 offset:18432
    v_mfma_f32_16x16x32_bf16 v[16:19], v[72:75], v[68:71], v[16:19]
    ds_read_b128 v[112:115], v49 offset:26624
    v_mfma_f32_16x16x32_bf16 v[20:23], v[76:79], v[64:67], v[20:23]
    ds_read_b128 v[116:119], v49 offset:28672
    v_mfma_f32_16x16x32_bf16 v[24:27], v[76:79], v[68:71], v[24:27]
    ds_read_b128 v[124:127], v48 offset:17408
    v_mfma_f32_16x16x32_bf16 v[12:15], v[92:95], v[84:87], v[12:15]
    ds_read_b128 v[128:131], v48 offset:19456
    v_mfma_f32_16x16x32_bf16 v[16:19], v[92:95], v[88:91], v[16:19]
    ds_read_b128 v[132:135], v49 offset:27648
    v_mfma_f32_16x16x32_bf16 v[20:23], v[96:99], v[84:87], v[20:23]
    ds_read_b128 v[136:139], v49 offset:29696
    v_mfma_f32_16x16x32_bf16 v[24:27], v[96:99], v[88:91], v[24:27]
    s_waitcnt lgkmcnt(0)
    s_barrier
    ds_read_b128 v[64:67], v48 offset:24576
    v_mfma_f32_16x16x32_bf16 v[12:15], v[112:115], v[104:107], v[12:15]
    ds_read_b128 v[68:71], v48 offset:26624
    v_mfma_f32_16x16x32_bf16 v[16:19], v[112:115], v[108:111], v[16:19]
    ds_read_b128 v[72:75], v49 offset:36864
    v_mfma_f32_16x16x32_bf16 v[20:23], v[116:119], v[104:107], v[20:23]
    ds_read_b128 v[76:79], v49 offset:38912
    v_mfma_f32_16x16x32_bf16 v[24:27], v[116:119], v[108:111], v[24:27]
    ds_read_b128 v[84:87], v48 offset:25600
    v_mfma_f32_16x16x32_bf16 v[12:15], v[132:135], v[124:127], v[12:15]
    ds_read_b128 v[88:91], v48 offset:27648
    v_mfma_f32_16x16x32_bf16 v[16:19], v[132:135], v[128:131], v[16:19]
    ds_read_b128 v[92:95], v49 offset:37888
    v_mfma_f32_16x16x32_bf16 v[20:23], v[136:139], v[124:127], v[20:23]
    ds_read_b128 v[96:99], v49 offset:39936
    v_mfma_f32_16x16x32_bf16 v[24:27], v[136:139], v[128:131], v[24:27]
    s_waitcnt lgkmcnt(0)
    s_barrier
    ds_read_b128 v[104:107], v48 offset:32768
    v_mfma_f32_16x16x32_bf16 v[12:15], v[72:75], v[64:67], v[12:15]
    ds_read_b128 v[108:111], v48 offset:34816
    v_mfma_f32_16x16x32_bf16 v[16:19], v[72:75], v[68:71], v[16:19]
    ds_read_b128 v[112:115], v49 offset:47104
    v_mfma_f32_16x16x32_bf16 v[20:23], v[76:79], v[64:67], v[20:23]
    ds_read_b128 v[116:119], v49 offset:49152
    v_mfma_f32_16x16x32_bf16 v[24:27], v[76:79], v[68:71], v[24:27]
    ds_read_b128 v[124:127], v48 offset:33792
    v_mfma_f32_16x16x32_bf16 v[12:15], v[92:95], v[84:87], v[12:15]
    ds_read_b128 v[128:131], v48 offset:35840
    v_mfma_f32_16x16x32_bf16 v[16:19], v[92:95], v[88:91], v[16:19]
    ds_read_b128 v[132:135], v49 offset:48128
    v_mfma_f32_16x16x32_bf16 v[20:23], v[96:99], v[84:87], v[20:23]
    ds_read_b128 v[136:139], v49 offset:50176
    v_mfma_f32_16x16x32_bf16 v[24:27], v[96:99], v[88:91], v[24:27]
    s_waitcnt lgkmcnt(0)
    s_barrier
    ds_read_b128 v[64:67], v48 offset:40960
    v_mfma_f32_16x16x32_bf16 v[12:15], v[112:115], v[104:107], v[12:15]
    ds_read_b128 v[68:71], v48 offset:43008
    v_mfma_f32_16x16x32_bf16 v[16:19], v[112:115], v[108:111], v[16:19]
    ds_read_b128 v[72:75], v49 offset:57344
    v_mfma_f32_16x16x32_bf16 v[20:23], v[116:119], v[104:107], v[20:23]
    ds_read_b128 v[76:79], v49 offset:59392
    v_mfma_f32_16x16x32_bf16 v[24:27], v[116:119], v[108:111], v[24:27]
    ds_read_b128 v[84:87], v48 offset:41984
    v_mfma_f32_16x16x32_bf16 v[12:15], v[132:135], v[124:127], v[12:15]
    ds_read_b128 v[88:91], v48 offset:44032
    v_mfma_f32_16x16x32_bf16 v[16:19], v[132:135], v[128:131], v[16:19]
    ds_read_b128 v[92:95], v49 offset:58368
    v_mfma_f32_16x16x32_bf16 v[20:23], v[136:139], v[124:127], v[20:23]
    ds_read_b128 v[96:99], v49 offset:60416
    v_mfma_f32_16x16x32_bf16 v[24:27], v[136:139], v[128:131], v[24:27]
    s_waitcnt lgkmcnt(0)
    v_mfma_f32_16x16x32_bf16 v[12:15], v[72:75], v[64:67], v[12:15]
    v_mfma_f32_16x16x32_bf16 v[16:19], v[72:75], v[68:71], v[16:19]
    v_mfma_f32_16x16x32_bf16 v[20:23], v[76:79], v[64:67], v[20:23]
    v_mfma_f32_16x16x32_bf16 v[24:27], v[76:79], v[68:71], v[24:27]
    v_mfma_f32_16x16x32_bf16 v[12:15], v[92:95], v[84:87], v[12:15]
    v_mfma_f32_16x16x32_bf16 v[16:19], v[92:95], v[88:91], v[16:19]
    v_mfma_f32_16x16x32_bf16 v[20:23], v[96:99], v[84:87], v[20:23]
    v_mfma_f32_16x16x32_bf16 v[24:27], v[96:99], v[88:91], v[24:27]
    s_waitcnt vmcnt(0)
    v_lshlrev_b32 v64, 16, v36
    v_and_b32 v65, 0xffff0000, v36
    v_lshlrev_b32 v66, 16, v37
    v_and_b32 v67, 0xffff0000, v37
    v_lshlrev_b32 v68, 16, v38
    v_and_b32 v69, 0xffff0000, v38
    v_lshlrev_b32 v70, 16, v39
    v_and_b32 v71, 0xffff0000, v39
    v_lshlrev_b32 v72, 16, v40
    v_and_b32 v73, 0xffff0000, v40
    v_lshlrev_b32 v74, 16, v41
    v_and_b32 v75, 0xffff0000, v41
    v_lshlrev_b32 v76, 16, v42
    v_and_b32 v77, 0xffff0000, v42
    v_lshlrev_b32 v78, 16, v43
    v_and_b32 v79, 0xffff0000, v43
    v_add_f32 v12, v12, v64
    v_add_f32 v13, v13, v65
    v_add_f32 v14, v14, v66
    v_add_f32 v15, v15, v67
    v_cvt_pk_bf16_f32 v36, v12, v13
    v_cvt_pk_bf16_f32 v37, v14, v15
    buffer_store_dwordx2 v[36:37], v5, s[24:27], s46 offen offset:96
    v_add_f32 v16, v16, v68
    v_add_f32 v17, v17, v69
    v_add_f32 v18, v18, v70
    v_add_f32 v19, v19, v71
    v_cvt_pk_bf16_f32 v38, v16, v17
    v_cvt_pk_bf16_f32 v39, v18, v19
    buffer_store_dwordx2 v[38:39], v5, s[24:27], s47 offen offset:96
    v_add_f32 v20, v20, v72
    v_add_f32 v21, v21, v73
    v_add_f32 v22, v22, v74
    v_add_f32 v23, v23, v75
    v_cvt_pk_bf16_f32 v40, v20, v21
    v_cvt_pk_bf16_f32 v41, v22, v23
    buffer_store_dwordx2 v[40:41], v5, s[24:27], s46 offen offset:128
    v_add_f32 v24, v24, v76
    v_add_f32 v25, v25, v77
    v_add_f32 v26, v26, v78
    v_add_f32 v27, v27, v79
    v_cvt_pk_bf16_f32 v42, v24, v25
    v_cvt_pk_bf16_f32 v43, v26, v27
    buffer_store_dwordx2 v[42:43], v5, s[24:27], s47 offen offset:128
    s_endpgm
sequential_preLN__grouped_kv_mqa__dense_activation_silu__prompt_kernel_slow:
    v_mov_b32 v113, 0xff800000
    v_mov_b32 v110, v112
    v_mul_u32_u24 v111, 20, v3
    v_add_u32 v111, v111, v2
    v_lshlrev_b32 v111, 4, v111
    v_add_u32 v111, 10240, v111

    s_mov_b32 s64, 8
sequential_preLN__grouped_kv_mqa__dense_activation_silu__prompt_kernel_s0:
    ds_read_b128 v[22:25], v110 offset:0
    ds_read_b128 v[30:33], v110 offset:8192
    s_waitcnt lgkmcnt(0)
    v_mfma_f32_32x32x16_bf16 v[54:69], v[22:25], v[8:11], 0
    s_nop 7
    s_nop 3
    v_mfma_f32_32x32x8_bf16 v[54:69], v[30:31], v[12:13], v[54:69]
    s_nop 7
    s_nop 3
    v_max3_f32 v113, v54, v55, v113
    v_max3_f32 v113, v56, v57, v113
    v_max3_f32 v113, v58, v59, v113
    v_max3_f32 v113, v60, v61, v113
    v_max3_f32 v113, v62, v63, v113
    v_max3_f32 v113, v64, v65, v113
    v_max3_f32 v113, v66, v67, v113
    v_max3_f32 v113, v68, v69, v113
    ds_read_b128 v[22:25], v110 offset:1024
    s_waitcnt lgkmcnt(0)
    v_mfma_f32_32x32x16_bf16 v[54:69], v[22:25], v[8:11], 0
    s_nop 7
    s_nop 3
    v_mfma_f32_32x32x8_bf16 v[54:69], v[32:33], v[12:13], v[54:69]
    s_nop 7
    s_nop 3
    v_max3_f32 v113, v54, v55, v113
    v_max3_f32 v113, v56, v57, v113
    v_max3_f32 v113, v58, v59, v113
    v_max3_f32 v113, v60, v61, v113
    v_max3_f32 v113, v62, v63, v113
    v_max3_f32 v113, v64, v65, v113
    v_max3_f32 v113, v66, v67, v113
    v_max3_f32 v113, v68, v69, v113
    ds_read_b128 v[22:25], v110 offset:2048
    s_waitcnt lgkmcnt(0)
    v_mfma_f32_32x32x16_bf16 v[54:69], v[22:25], v[8:11], 0
    s_nop 7
    s_nop 3
    v_mfma_f32_32x32x8_bf16 v[54:69], v[30:31], v[14:15], v[54:69]
    s_nop 7
    s_nop 3
    v_max3_f32 v113, v54, v55, v113
    v_max3_f32 v113, v56, v57, v113
    v_max3_f32 v113, v58, v59, v113
    v_max3_f32 v113, v60, v61, v113
    v_max3_f32 v113, v62, v63, v113
    v_max3_f32 v113, v64, v65, v113
    v_max3_f32 v113, v66, v67, v113
    v_max3_f32 v113, v68, v69, v113
    ds_read_b128 v[22:25], v110 offset:3072
    s_waitcnt lgkmcnt(0)
    v_mfma_f32_32x32x16_bf16 v[54:69], v[22:25], v[8:11], 0
    s_nop 7
    s_nop 3
    v_mfma_f32_32x32x8_bf16 v[54:69], v[32:33], v[14:15], v[54:69]
    s_nop 7
    s_nop 3
    v_max3_f32 v113, v54, v55, v113
    v_max3_f32 v113, v56, v57, v113
    v_max3_f32 v113, v58, v59, v113
    v_max3_f32 v113, v60, v61, v113
    v_max3_f32 v113, v62, v63, v113
    v_max3_f32 v113, v64, v65, v113
    v_max3_f32 v113, v66, v67, v113
    v_max3_f32 v113, v68, v69, v113
    ds_read_b128 v[22:25], v110 offset:4096
    ds_read_b128 v[34:37], v110 offset:9216
    s_waitcnt lgkmcnt(0)
    v_mfma_f32_32x32x16_bf16 v[54:69], v[22:25], v[8:11], 0
    s_nop 7
    s_nop 3
    v_mfma_f32_32x32x8_bf16 v[54:69], v[34:35], v[12:13], v[54:69]
    s_nop 7
    s_nop 3
    v_max3_f32 v113, v54, v55, v113
    v_max3_f32 v113, v56, v57, v113
    v_max3_f32 v113, v58, v59, v113
    v_max3_f32 v113, v60, v61, v113
    v_max3_f32 v113, v62, v63, v113
    v_max3_f32 v113, v64, v65, v113
    v_max3_f32 v113, v66, v67, v113
    v_max3_f32 v113, v68, v69, v113
    ds_read_b128 v[22:25], v110 offset:5120
    s_waitcnt lgkmcnt(0)
    v_mfma_f32_32x32x16_bf16 v[54:69], v[22:25], v[8:11], 0
    s_nop 7
    s_nop 3
    v_mfma_f32_32x32x8_bf16 v[54:69], v[36:37], v[12:13], v[54:69]
    s_nop 7
    s_nop 3
    v_max3_f32 v113, v54, v55, v113
    v_max3_f32 v113, v56, v57, v113
    v_max3_f32 v113, v58, v59, v113
    v_max3_f32 v113, v60, v61, v113
    v_max3_f32 v113, v62, v63, v113
    v_max3_f32 v113, v64, v65, v113
    v_max3_f32 v113, v66, v67, v113
    v_max3_f32 v113, v68, v69, v113
    ds_read_b128 v[22:25], v110 offset:6144
    s_waitcnt lgkmcnt(0)
    v_mfma_f32_32x32x16_bf16 v[54:69], v[22:25], v[8:11], 0
    s_nop 7
    s_nop 3
    v_mfma_f32_32x32x8_bf16 v[54:69], v[34:35], v[14:15], v[54:69]
    s_nop 7
    s_nop 3
    v_max3_f32 v113, v54, v55, v113
    v_max3_f32 v113, v56, v57, v113
    v_max3_f32 v113, v58, v59, v113
    v_max3_f32 v113, v60, v61, v113
    v_max3_f32 v113, v62, v63, v113
    v_max3_f32 v113, v64, v65, v113
    v_max3_f32 v113, v66, v67, v113
    v_max3_f32 v113, v68, v69, v113
    ds_read_b128 v[22:25], v110 offset:7168
    s_waitcnt lgkmcnt(0)
    v_mfma_f32_32x32x16_bf16 v[54:69], v[22:25], v[8:11], 0
    s_nop 7
    s_nop 3
    v_mfma_f32_32x32x8_bf16 v[54:69], v[36:37], v[14:15], v[54:69]
    s_nop 7
    s_nop 3
    v_max3_f32 v113, v54, v55, v113
    v_max3_f32 v113, v56, v57, v113
    v_max3_f32 v113, v58, v59, v113
    v_max3_f32 v113, v60, v61, v113
    v_max3_f32 v113, v62, v63, v113
    v_max3_f32 v113, v64, v65, v113
    v_max3_f32 v113, v66, v67, v113
    v_max3_f32 v113, v68, v69, v113
    v_add_u32 v110, 20480, v110
    v_add_u32 v111, 20480, v111
    s_sub_u32 s64, s64, 1
    s_cmp_lg_u32 s64, 0
    s_cbranch_scc1 sequential_preLN__grouped_kv_mqa__dense_activation_silu__prompt_kernel_s0
    v_mov_b32 v4, v113
    s_nop 1
    v_permlane32_swap_b32 v113, v4
    s_nop 1
    v_max_f32 v113, v113, v4

    v_mov_b32 v110, v112
    v_mul_u32_u24 v111, 20, v3
    v_add_u32 v111, v111, v2
    v_lshlrev_b32 v111, 4, v111
    v_add_u32 v111, 10240, v111

    s_mov_b32 s64, 8
    v_mov_b32 v94, 0
    v_mov_b32 v95, 0
    v_mov_b32 v96, 0
    v_mov_b32 v97, 0
    v_mov_b32 v98, 0
    v_mov_b32 v99, 0
    v_mov_b32 v100, 0
    v_mov_b32 v101, 0
    v_mov_b32 v102, 0
    v_mov_b32 v103, 0
    v_mov_b32 v104, 0
    v_mov_b32 v105, 0
    v_mov_b32 v106, 0
    v_mov_b32 v107, 0
    v_mov_b32 v108, 0
    v_mov_b32 v109, 0
sequential_preLN__grouped_kv_mqa__dense_activation_silu__prompt_kernel_s1:
    ds_read_b128 v[22:25], v110 offset:0
    ds_read_b128 v[30:33], v110 offset:8192
    s_mov_b64 exec, s[60:61]
    ds_read_b128 v[38:41], v111 offset:0
    ds_read_b128 v[46:49], v111 offset:640
    s_mov_b64 exec, -1
    s_waitcnt lgkmcnt(0)
    v_mfma_f32_32x32x16_bf16 v[54:69], v[22:25], v[8:11], 0
    s_nop 7
    s_nop 3
    v_mfma_f32_32x32x8_bf16 v[54:69], v[30:31], v[12:13], v[54:69]
    s_nop 7
    s_nop 3
    v_sub_f32 v54, v54, v113
    v_sub_f32 v55, v55, v113
    v_sub_f32 v56, v56, v113
    v_sub_f32 v57, v57, v113
    v_sub_f32 v58, v58, v113
    v_sub_f32 v59, v59, v113
    v_sub_f32 v60, v60, v113
    v_sub_f32 v61, v61, v113
    v_sub_f32 v62, v62, v113
    v_sub_f32 v63, v63, v113
    v_sub_f32 v64, v64, v113
    v_sub_f32 v65, v65, v113
    v_sub_f32 v66, v66, v113
    v_sub_f32 v67, v67, v113
    v_sub_f32 v68, v68, v113
    v_sub_f32 v69, v69, v113
    v_exp_f32 v54, v54
    v_exp_f32 v55, v55
    v_exp_f32 v56, v56
    v_exp_f32 v57, v57
    v_exp_f32 v58, v58
    v_exp_f32 v59, v59
    v_exp_f32 v60, v60
    v_exp_f32 v61, v61
    v_exp_f32 v62, v62
    v_exp_f32 v63, v63
    v_exp_f32 v64, v64
    v_exp_f32 v65, v65
    v_exp_f32 v66, v66
    v_exp_f32 v67, v67
    v_exp_f32 v68, v68
    v_exp_f32 v69, v69
    s_nop 0
    v_cvt_pk_bf16_f32 v86, v54, v55
    v_cvt_pk_bf16_f32 v87, v56, v57
    v_cvt_pk_bf16_f32 v88, v58, v59
    v_cvt_pk_bf16_f32 v89, v60, v61
    v_cvt_pk_bf16_f32 v90, v62, v63
    v_cvt_pk_bf16_f32 v91, v64, v65
    v_cvt_pk_bf16_f32 v92, v66, v67
    v_cvt_pk_bf16_f32 v93, v68, v69
    s_nop 1
    v_mfma_f32_32x32x16_bf16 v[94:109], v[38:41], v[86:89], v[94:109]
    v_mfma_f32_32x32x16_bf16 v[94:109], v[46:49], v[90:93], v[94:109]
    ds_read_b128 v[22:25], v110 offset:1024
    s_mov_b64 exec, s[60:61]
    ds_read_b128 v[38:41], v111 offset:1280
    ds_read_b128 v[46:49], v111 offset:1920
    s_mov_b64 exec, -1
    s_waitcnt lgkmcnt(0)
    v_mfma_f32_32x32x16_bf16 v[54:69], v[22:25], v[8:11], 0
    s_nop 7
    s_nop 3
    v_mfma_f32_32x32x8_bf16 v[54:69], v[32:33], v[12:13], v[54:69]
    s_nop 7
    s_nop 3
    v_sub_f32 v54, v54, v113
    v_sub_f32 v55, v55, v113
    v_sub_f32 v56, v56, v113
    v_sub_f32 v57, v57, v113
    v_sub_f32 v58, v58, v113
    v_sub_f32 v59, v59, v113
    v_sub_f32 v60, v60, v113
    v_sub_f32 v61, v61, v113
    v_sub_f32 v62, v62, v113
    v_sub_f32 v63, v63, v113
    v_sub_f32 v64, v64, v113
    v_sub_f32 v65, v65, v113
    v_sub_f32 v66, v66, v113
    v_sub_f32 v67, v67, v113
    v_sub_f32 v68, v68, v113
    v_sub_f32 v69, v69, v113
    v_exp_f32 v54, v54
    v_exp_f32 v55, v55
    v_exp_f32 v56, v56
    v_exp_f32 v57, v57
    v_exp_f32 v58, v58
    v_exp_f32 v59, v59
    v_exp_f32 v60, v60
    v_exp_f32 v61, v61
    v_exp_f32 v62, v62
    v_exp_f32 v63, v63
    v_exp_f32 v64, v64
    v_exp_f32 v65, v65
    v_exp_f32 v66, v66
    v_exp_f32 v67, v67
    v_exp_f32 v68, v68
    v_exp_f32 v69, v69
    s_nop 0
    v_cvt_pk_bf16_f32 v86, v54, v55
    v_cvt_pk_bf16_f32 v87, v56, v57
    v_cvt_pk_bf16_f32 v88, v58, v59
    v_cvt_pk_bf16_f32 v89, v60, v61
    v_cvt_pk_bf16_f32 v90, v62, v63
    v_cvt_pk_bf16_f32 v91, v64, v65
    v_cvt_pk_bf16_f32 v92, v66, v67
    v_cvt_pk_bf16_f32 v93, v68, v69
    s_nop 1
    v_mfma_f32_32x32x16_bf16 v[94:109], v[38:41], v[86:89], v[94:109]
    v_mfma_f32_32x32x16_bf16 v[94:109], v[46:49], v[90:93], v[94:109]
    ds_read_b128 v[22:25], v110 offset:2048
    s_mov_b64 exec, s[60:61]
    ds_read_b128 v[38:41], v111 offset:2560
    ds_read_b128 v[46:49], v111 offset:3200
    s_mov_b64 exec, -1
    s_waitcnt lgkmcnt(0)
    v_mfma_f32_32x32x16_bf16 v[54:69], v[22:25], v[8:11], 0
    s_nop 7
    s_nop 3
    v_mfma_f32_32x32x8_bf16 v[54:69], v[30:31], v[14:15], v[54:69]
    s_nop 7
    s_nop 3
    v_sub_f32 v54, v54, v113
    v_sub_f32 v55, v55, v113
    v_sub_f32 v56, v56, v113
    v_sub_f32 v57, v57, v113
    v_sub_f32 v58, v58, v113
    v_sub_f32 v59, v59, v113
    v_sub_f32 v60, v60, v113
    v_sub_f32 v61, v61, v113
    v_sub_f32 v62, v62, v113
    v_sub_f32 v63, v63, v113
    v_sub_f32 v64, v64, v113
    v_sub_f32 v65, v65, v113
    v_sub_f32 v66, v66, v113
    v_sub_f32 v67, v67, v113
    v_sub_f32 v68, v68, v113
    v_sub_f32 v69, v69, v113
    v_exp_f32 v54, v54
    v_exp_f32 v55, v55
    v_exp_f32 v56, v56
    v_exp_f32 v57, v57
    v_exp_f32 v58, v58
    v_exp_f32 v59, v59
    v_exp_f32 v60, v60
    v_exp_f32 v61, v61
    v_exp_f32 v62, v62
    v_exp_f32 v63, v63
    v_exp_f32 v64, v64
    v_exp_f32 v65, v65
    v_exp_f32 v66, v66
    v_exp_f32 v67, v67
    v_exp_f32 v68, v68
    v_exp_f32 v69, v69
    s_nop 0
    v_cvt_pk_bf16_f32 v86, v54, v55
    v_cvt_pk_bf16_f32 v87, v56, v57
    v_cvt_pk_bf16_f32 v88, v58, v59
    v_cvt_pk_bf16_f32 v89, v60, v61
    v_cvt_pk_bf16_f32 v90, v62, v63
    v_cvt_pk_bf16_f32 v91, v64, v65
    v_cvt_pk_bf16_f32 v92, v66, v67
    v_cvt_pk_bf16_f32 v93, v68, v69
    s_nop 1
    v_mfma_f32_32x32x16_bf16 v[94:109], v[38:41], v[86:89], v[94:109]
    v_mfma_f32_32x32x16_bf16 v[94:109], v[46:49], v[90:93], v[94:109]
    ds_read_b128 v[22:25], v110 offset:3072
    s_mov_b64 exec, s[60:61]
    ds_read_b128 v[38:41], v111 offset:3840
    ds_read_b128 v[46:49], v111 offset:4480
    s_mov_b64 exec, -1
    s_waitcnt lgkmcnt(0)
    v_mfma_f32_32x32x16_bf16 v[54:69], v[22:25], v[8:11], 0
    s_nop 7
    s_nop 3
    v_mfma_f32_32x32x8_bf16 v[54:69], v[32:33], v[14:15], v[54:69]
    s_nop 7
    s_nop 3
    v_sub_f32 v54, v54, v113
    v_sub_f32 v55, v55, v113
    v_sub_f32 v56, v56, v113
    v_sub_f32 v57, v57, v113
    v_sub_f32 v58, v58, v113
    v_sub_f32 v59, v59, v113
    v_sub_f32 v60, v60, v113
    v_sub_f32 v61, v61, v113
    v_sub_f32 v62, v62, v113
    v_sub_f32 v63, v63, v113
    v_sub_f32 v64, v64, v113
    v_sub_f32 v65, v65, v113
    v_sub_f32 v66, v66, v113
    v_sub_f32 v67, v67, v113
    v_sub_f32 v68, v68, v113
    v_sub_f32 v69, v69, v113
    v_exp_f32 v54, v54
    v_exp_f32 v55, v55
    v_exp_f32 v56, v56
    v_exp_f32 v57, v57
    v_exp_f32 v58, v58
    v_exp_f32 v59, v59
    v_exp_f32 v60, v60
    v_exp_f32 v61, v61
    v_exp_f32 v62, v62
    v_exp_f32 v63, v63
    v_exp_f32 v64, v64
    v_exp_f32 v65, v65
    v_exp_f32 v66, v66
    v_exp_f32 v67, v67
    v_exp_f32 v68, v68
    v_exp_f32 v69, v69
    s_nop 0
    v_cvt_pk_bf16_f32 v86, v54, v55
    v_cvt_pk_bf16_f32 v87, v56, v57
    v_cvt_pk_bf16_f32 v88, v58, v59
    v_cvt_pk_bf16_f32 v89, v60, v61
    v_cvt_pk_bf16_f32 v90, v62, v63
    v_cvt_pk_bf16_f32 v91, v64, v65
    v_cvt_pk_bf16_f32 v92, v66, v67
    v_cvt_pk_bf16_f32 v93, v68, v69
    s_nop 1
    v_mfma_f32_32x32x16_bf16 v[94:109], v[38:41], v[86:89], v[94:109]
    v_mfma_f32_32x32x16_bf16 v[94:109], v[46:49], v[90:93], v[94:109]
    ds_read_b128 v[22:25], v110 offset:4096
    ds_read_b128 v[34:37], v110 offset:9216
    s_mov_b64 exec, s[60:61]
    ds_read_b128 v[38:41], v111 offset:5120
    ds_read_b128 v[46:49], v111 offset:5760
    s_mov_b64 exec, -1
    s_waitcnt lgkmcnt(0)
    v_mfma_f32_32x32x16_bf16 v[54:69], v[22:25], v[8:11], 0
    s_nop 7
    s_nop 3
    v_mfma_f32_32x32x8_bf16 v[54:69], v[34:35], v[12:13], v[54:69]
    s_nop 7
    s_nop 3
    v_sub_f32 v54, v54, v113
    v_sub_f32 v55, v55, v113
    v_sub_f32 v56, v56, v113
    v_sub_f32 v57, v57, v113
    v_sub_f32 v58, v58, v113
    v_sub_f32 v59, v59, v113
    v_sub_f32 v60, v60, v113
    v_sub_f32 v61, v61, v113
    v_sub_f32 v62, v62, v113
    v_sub_f32 v63, v63, v113
    v_sub_f32 v64, v64, v113
    v_sub_f32 v65, v65, v113
    v_sub_f32 v66, v66, v113
    v_sub_f32 v67, v67, v113
    v_sub_f32 v68, v68, v113
    v_sub_f32 v69, v69, v113
    v_exp_f32 v54, v54
    v_exp_f32 v55, v55
    v_exp_f32 v56, v56
    v_exp_f32 v57, v57
    v_exp_f32 v58, v58
    v_exp_f32 v59, v59
    v_exp_f32 v60, v60
    v_exp_f32 v61, v61
    v_exp_f32 v62, v62
    v_exp_f32 v63, v63
    v_exp_f32 v64, v64
    v_exp_f32 v65, v65
    v_exp_f32 v66, v66
    v_exp_f32 v67, v67
    v_exp_f32 v68, v68
    v_exp_f32 v69, v69
    s_nop 0
    v_cvt_pk_bf16_f32 v86, v54, v55
    v_cvt_pk_bf16_f32 v87, v56, v57
    v_cvt_pk_bf16_f32 v88, v58, v59
    v_cvt_pk_bf16_f32 v89, v60, v61
    v_cvt_pk_bf16_f32 v90, v62, v63
    v_cvt_pk_bf16_f32 v91, v64, v65
    v_cvt_pk_bf16_f32 v92, v66, v67
    v_cvt_pk_bf16_f32 v93, v68, v69
    s_nop 1
    v_mfma_f32_32x32x16_bf16 v[94:109], v[38:41], v[86:89], v[94:109]
    v_mfma_f32_32x32x16_bf16 v[94:109], v[46:49], v[90:93], v[94:109]
    ds_read_b128 v[22:25], v110 offset:5120
    s_mov_b64 exec, s[60:61]
    ds_read_b128 v[38:41], v111 offset:6400
    ds_read_b128 v[46:49], v111 offset:7040
    s_mov_b64 exec, -1
    s_waitcnt lgkmcnt(0)
    v_mfma_f32_32x32x16_bf16 v[54:69], v[22:25], v[8:11], 0
    s_nop 7
    s_nop 3
    v_mfma_f32_32x32x8_bf16 v[54:69], v[36:37], v[12:13], v[54:69]
    s_nop 7
    s_nop 3
    v_sub_f32 v54, v54, v113
    v_sub_f32 v55, v55, v113
    v_sub_f32 v56, v56, v113
    v_sub_f32 v57, v57, v113
    v_sub_f32 v58, v58, v113
    v_sub_f32 v59, v59, v113
    v_sub_f32 v60, v60, v113
    v_sub_f32 v61, v61, v113
    v_sub_f32 v62, v62, v113
    v_sub_f32 v63, v63, v113
    v_sub_f32 v64, v64, v113
    v_sub_f32 v65, v65, v113
    v_sub_f32 v66, v66, v113
    v_sub_f32 v67, v67, v113
    v_sub_f32 v68, v68, v113
    v_sub_f32 v69, v69, v113
    v_exp_f32 v54, v54
    v_exp_f32 v55, v55
    v_exp_f32 v56, v56
    v_exp_f32 v57, v57
    v_exp_f32 v58, v58
    v_exp_f32 v59, v59
    v_exp_f32 v60, v60
    v_exp_f32 v61, v61
    v_exp_f32 v62, v62
    v_exp_f32 v63, v63
    v_exp_f32 v64, v64
    v_exp_f32 v65, v65
    v_exp_f32 v66, v66
    v_exp_f32 v67, v67
    v_exp_f32 v68, v68
    v_exp_f32 v69, v69
    s_nop 0
    v_cvt_pk_bf16_f32 v86, v54, v55
    v_cvt_pk_bf16_f32 v87, v56, v57
    v_cvt_pk_bf16_f32 v88, v58, v59
    v_cvt_pk_bf16_f32 v89, v60, v61
    v_cvt_pk_bf16_f32 v90, v62, v63
    v_cvt_pk_bf16_f32 v91, v64, v65
    v_cvt_pk_bf16_f32 v92, v66, v67
    v_cvt_pk_bf16_f32 v93, v68, v69
    s_nop 1
    v_mfma_f32_32x32x16_bf16 v[94:109], v[38:41], v[86:89], v[94:109]
    v_mfma_f32_32x32x16_bf16 v[94:109], v[46:49], v[90:93], v[94:109]
    ds_read_b128 v[22:25], v110 offset:6144
    s_mov_b64 exec, s[60:61]
    ds_read_b128 v[38:41], v111 offset:7680
    ds_read_b128 v[46:49], v111 offset:8320
    s_mov_b64 exec, -1
    s_waitcnt lgkmcnt(0)
    v_mfma_f32_32x32x16_bf16 v[54:69], v[22:25], v[8:11], 0
    s_nop 7
    s_nop 3
    v_mfma_f32_32x32x8_bf16 v[54:69], v[34:35], v[14:15], v[54:69]
    s_nop 7
    s_nop 3
    v_sub_f32 v54, v54, v113
    v_sub_f32 v55, v55, v113
    v_sub_f32 v56, v56, v113
    v_sub_f32 v57, v57, v113
    v_sub_f32 v58, v58, v113
    v_sub_f32 v59, v59, v113
    v_sub_f32 v60, v60, v113
    v_sub_f32 v61, v61, v113
    v_sub_f32 v62, v62, v113
    v_sub_f32 v63, v63, v113
    v_sub_f32 v64, v64, v113
    v_sub_f32 v65, v65, v113
    v_sub_f32 v66, v66, v113
    v_sub_f32 v67, v67, v113
    v_sub_f32 v68, v68, v113
    v_sub_f32 v69, v69, v113
    v_exp_f32 v54, v54
    v_exp_f32 v55, v55
    v_exp_f32 v56, v56
    v_exp_f32 v57, v57
    v_exp_f32 v58, v58
    v_exp_f32 v59, v59
    v_exp_f32 v60, v60
    v_exp_f32 v61, v61
    v_exp_f32 v62, v62
    v_exp_f32 v63, v63
    v_exp_f32 v64, v64
    v_exp_f32 v65, v65
    v_exp_f32 v66, v66
    v_exp_f32 v67, v67
    v_exp_f32 v68, v68
    v_exp_f32 v69, v69
    s_nop 0
    v_cvt_pk_bf16_f32 v86, v54, v55
    v_cvt_pk_bf16_f32 v87, v56, v57
    v_cvt_pk_bf16_f32 v88, v58, v59
    v_cvt_pk_bf16_f32 v89, v60, v61
    v_cvt_pk_bf16_f32 v90, v62, v63
    v_cvt_pk_bf16_f32 v91, v64, v65
    v_cvt_pk_bf16_f32 v92, v66, v67
    v_cvt_pk_bf16_f32 v93, v68, v69
    s_nop 1
    v_mfma_f32_32x32x16_bf16 v[94:109], v[38:41], v[86:89], v[94:109]
    v_mfma_f32_32x32x16_bf16 v[94:109], v[46:49], v[90:93], v[94:109]
    ds_read_b128 v[22:25], v110 offset:7168
    s_mov_b64 exec, s[60:61]
    ds_read_b128 v[38:41], v111 offset:8960
    ds_read_b128 v[46:49], v111 offset:9600
    s_mov_b64 exec, -1
    s_waitcnt lgkmcnt(0)
    v_mfma_f32_32x32x16_bf16 v[54:69], v[22:25], v[8:11], 0
    s_nop 7
    s_nop 3
    v_mfma_f32_32x32x8_bf16 v[54:69], v[36:37], v[14:15], v[54:69]
    s_nop 7
    s_nop 3
    v_sub_f32 v54, v54, v113
    v_sub_f32 v55, v55, v113
    v_sub_f32 v56, v56, v113
    v_sub_f32 v57, v57, v113
    v_sub_f32 v58, v58, v113
    v_sub_f32 v59, v59, v113
    v_sub_f32 v60, v60, v113
    v_sub_f32 v61, v61, v113
    v_sub_f32 v62, v62, v113
    v_sub_f32 v63, v63, v113
    v_sub_f32 v64, v64, v113
    v_sub_f32 v65, v65, v113
    v_sub_f32 v66, v66, v113
    v_sub_f32 v67, v67, v113
    v_sub_f32 v68, v68, v113
    v_sub_f32 v69, v69, v113
    v_exp_f32 v54, v54
    v_exp_f32 v55, v55
    v_exp_f32 v56, v56
    v_exp_f32 v57, v57
    v_exp_f32 v58, v58
    v_exp_f32 v59, v59
    v_exp_f32 v60, v60
    v_exp_f32 v61, v61
    v_exp_f32 v62, v62
    v_exp_f32 v63, v63
    v_exp_f32 v64, v64
    v_exp_f32 v65, v65
    v_exp_f32 v66, v66
    v_exp_f32 v67, v67
    v_exp_f32 v68, v68
    v_exp_f32 v69, v69
    s_nop 0
    v_cvt_pk_bf16_f32 v86, v54, v55
    v_cvt_pk_bf16_f32 v87, v56, v57
    v_cvt_pk_bf16_f32 v88, v58, v59
    v_cvt_pk_bf16_f32 v89, v60, v61
    v_cvt_pk_bf16_f32 v90, v62, v63
    v_cvt_pk_bf16_f32 v91, v64, v65
    v_cvt_pk_bf16_f32 v92, v66, v67
    v_cvt_pk_bf16_f32 v93, v68, v69
    s_nop 1
    v_mfma_f32_32x32x16_bf16 v[94:109], v[38:41], v[86:89], v[94:109]
    v_mfma_f32_32x32x16_bf16 v[94:109], v[46:49], v[90:93], v[94:109]
    v_add_u32 v110, 20480, v110
    v_add_u32 v111, 20480, v111
    s_sub_u32 s64, s64, 1
    s_cmp_lg_u32 s64, 0
    s_cbranch_scc1 sequential_preLN__grouped_kv_mqa__dense_activation_silu__prompt_kernel_s1
    s_nop 7
    s_nop 7
    s_branch sequential_preLN__grouped_kv_mqa__dense_activation_silu__prompt_kernel_store
sequential_preLN__grouped_kv_mqa__dense_activation_silu__prompt_kernel_end:
    s_endpgm
.p2align 8
.fill 768, 4, 0xbf800000
code_end:
.section .rodata,"a"
.p2align 6
.amdhsa_kernel sequential_preLN__grouped_kv_mqa__dense_activation_silu__prompt_kernel
  .amdhsa_next_free_vgpr 256
  .amdhsa_next_free_sgpr 100
  .amdhsa_accum_offset 256
  .amdhsa_group_segment_fixed_size 0
  .amdhsa_kernarg_size 88
  .amdhsa_user_sgpr_count 2
  .amdhsa_user_sgpr_kernarg_segment_ptr 1
  .amdhsa_system_sgpr_workgroup_id_x 1
.end_amdhsa_kernel
```
